```python
import torch

def _softmax(x, axis=-1):
    return torch.softmax(x, dim=axis)
def _gelu(x):
    return torch.nn.functional.gelu(x, approximate="tanh")
def _silu(x):
    return torch.nn.functional.silu(x)
def _sigmoid(x):
    return torch.sigmoid(x)
def _layernorm(x, axis=-1, eps=1e-5):
    m = x.mean(dim=axis, keepdim=True)
    v = x.var(dim=axis, keepdim=True, unbiased=False)
    return (x - m) / torch.sqrt(v + eps)
def _scatter_add(tgt, idx, src, axis=0):
    return tgt.clone().index_add_(axis, idx, src)
def _segment_sum(src, seg, n):
    out = torch.zeros((n,) + src.shape[1:], dtype=src.dtype)
    return out.index_add_(0, seg, src)
def _pad(x, pw):
    flat = tuple(v for pair in reversed(pw) for v in pair)
    return torch.nn.functional.pad(x, flat)

kernel_name = 'sequential_preLN__sliding_block__glu_gated_reglu__prompt'

def setup_inputs():

    _w = (lambda a: (lambda t: t.to(torch.bfloat16) if t.is_floating_point() else t)(torch.as_tensor(a)))
    def _A_setup():
        B, S, D = 1, 2048, 640
        return {
            "x": _w((lambda *s: torch.randn(*s, dtype=torch.bfloat16) * 0.05)(B, S, D)),
            "wqkv": _w((lambda *s: torch.randn(*s, dtype=torch.bfloat16) * 0.05)(D, 3 * D)),
            "wo": _w((lambda *s: torch.randn(*s, dtype=torch.bfloat16) * 0.05)(D, D)),
        }
    _A_in = _A_setup()

    def _B_setup():
        B, S, D, F = 1, 2048, 640, 1728
        return {
            "x": _w((lambda *s: torch.randn(*s, dtype=torch.bfloat16) * 0.05)(B, S, D)),
            "W_gate": _w((lambda *s: torch.randn(*s, dtype=torch.bfloat16) * 0.8)(D, F) * (2.0 / D) ** 0.5),
            "W_up": _w((lambda *s: torch.randn(*s, dtype=torch.bfloat16) * 0.8)(D, F) * (2.0 / D) ** 0.5),
            "W_down": _w((lambda *s: torch.randn(*s, dtype=torch.bfloat16) * 0.8)(F, D) * (1.0 / F) ** 0.5),
        }
    _B_in = _B_setup()

    return {
        "A_x": _A_in["x"],
        "A_wqkv": _A_in["wqkv"],
        "A_wo": _A_in["wo"],
        "B_x": _B_in["x"],
        "B_W_gate": _B_in["W_gate"],
        "B_W_up": _B_in["W_up"],
        "B_W_down": _B_in["W_down"],
    }

def reference(A_x, A_wqkv, A_wo, B_x, B_W_gate, B_W_up, B_W_down):
    def _A_ref(x, wqkv, wo):
        B, S, D = x.shape
        H = 32; Dh = D // H; W = 256
        qkv = (lambda x, *d: x.permute(*d))((x @ wqkv).reshape(B, S, 3, H, Dh), 2, 0, 3, 1, 4)
        q, k, v = qkv[0], qkv[1], qkv[2]
        scores = torch.einsum("bhqd,bhkd->bhqk", q, k) * (Dh ** -0.5)
        idx = torch.arange(S)
        mask = (idx[:, None] - idx[None, :] >= 0) & (idx[:, None] - idx[None, :] < W)
        scores = torch.where(mask[None, None], scores, -1e9)
        p = _softmax(scores, axis=-1)
        o = torch.einsum("bhqk,bhkd->bhqd", p, v)
        return (lambda x, *d: x.permute(*d))(o, 0, 2, 1, 3).reshape(B, S, D) @ wo

    def _B_ref(x, W_gate, W_up, W_down):
        gate = torch.einsum("bsd,df->bsf", x, W_gate)
        up = torch.einsum("bsd,df->bsf", x, W_up)
        gate = gate * (lambda x, dt: x.to(dt))(gate > 0, gate.dtype)
        h = gate * up
        return torch.einsum("bsf,fd->bsd", h, W_down)

    x = A_x
    h = x + _A_ref(_layernorm(x, axis=-1), A_wqkv, A_wo)
    h2 = h + _B_ref(_layernorm(h, axis=-1), B_W_gate, B_W_up, B_W_down)
    return h2
```

```asm
; @launch grid=(256,1,1) block=(512,1,1) lds=163840
.amdgcn_target "amdgcn-amd-amdhsa--gfx950"
.text
.globl sequential_preLN__sliding_block__glu_gated_reglu__prompt_kernel
.p2align 8
.type sequential_preLN__sliding_block__glu_gated_reglu__prompt_kernel,@function
sequential_preLN__sliding_block__glu_gated_reglu__prompt_kernel:
L_start:
    s_load_dwordx4 s[40:43], s[0:1], 0
    s_load_dwordx2 s[44:45], s[0:1], 72
    s_getpc_b64 s[56:57]
    s_cmp_ge_u32 s2, 256
    s_cbranch_scc1 L_end
    v_lshrrev_b32 v1, 6, v0
    v_and_b32 v2, 63, v0
    s_lshr_b32 s25, s2, 3
    v_readfirstlane_b32 s3, v1
    s_lshl_b32 s46, s25, 11
    v_lshlrev_b32 v3, 8, v1
    v_lshl_add_u32 v3, v2, 7, v3
    v_add_u32 v3, s46, v3
    v_min_u32 v3, L_end-L_start-64, v3
    s_mov_b64 exec, 3
    global_load_dword v255, v3, s[56:57]
    s_mov_b64 exec, -1
    s_load_dwordx2 s[30:31], s[0:1], 16
    s_load_dwordx8 s[32:39], s[0:1], 32
    s_and_b32 s24, s2, 7
    s_and_b32 s46, s25, 1
    s_lshr_b32 s47, s25, 1
    s_and_b32 s48, s3, 3
    s_mov_b32 s49, s24
    s_lshl_b32 s50, s24, 8
    s_lshl_b32 s51, s46, 7
    s_add_u32 s50, s50, s51
    s_lshl_b32 s51, s48, 5
    s_add_u32 s50, s50, s51
    s_mul_i32 s50, s50, 1280
    s_lshl_b32 s51, s49, 7
    s_and_b32 s52, s48, 1
    s_mul_i32 s52, s52, 122880
    s_lshl_b32 s53, s47, 8
    s_add_u32 s52, s52, s53
    s_lshr_b32 s53, s48, 1
    s_lshl_b32 s53, s53, 7
    s_add_u32 s52, s52, s53
    s_mul_i32 s53, s49, 245760
    s_lshl_b32 s54, s48, 12
    s_add_u32 s54, s54, 65536
    v_lshrrev_b32 v3, 3, v2
    v_and_b32 v12, 7, v2
    v_lshrrev_b32 v13, 1, v3
    v_xor_b32 v14, v12, v13
    v_xor_b32 v15, 4, v14
    v_mul_u32_u24 v16, 1280, v3
    v_lshl_add_u32 v4, v14, 4, v16
    v_lshl_add_u32 v5, v15, 4, v16
    v_add_u32 v6, 18432, v4
    v_add_u32 v7, 27648, v5
    v_add_u32 v5, 9216, v5
    v_and_b32 v13, 2, v3
    v_xor_b32 v14, v12, v13
    v_xor_b32 v15, 4, v14
    v_mul_u32_u24 v16, 3840, v3
    v_lshl_add_u32 v8, v14, 4, v16
    v_lshl_add_u32 v9, v15, 4, v16
    v_add_u32 v10, 59392, v8
    v_add_u32 v11, 89088, v9
    v_add_u32 v9, 29696, v9
    s_getreg_b32 s28, hwreg(HW_REG_XCC_ID)
    s_and_b32 s28, s28, 15
    s_mov_b32 s27, 1
    s_mov_b32 s6, 2621440
    s_mov_b32 s7, 0x20000
    s_mov_b32 s10, 2457600
    s_mov_b32 s11, 0x20000
    s_mov_b32 s14, 67108864
    s_mov_b32 s15, 0x20000
    s_mov_b32 s18, 2621440
    s_mov_b32 s19, 0x20000
    s_mov_b32 s22, 819200
    s_mov_b32 s23, 0x20000
    s_mov_b32 s56, 0
    s_cmp_ge_u32 s25, 30
    s_cselect_b32 s57, 0, s3
    s_waitcnt lgkmcnt(0)
    s_load_dword s26, s[44:45], 0
    s_mov_b32 s4, s40
    s_and_b32 s5, s41, 0xffff
    s_mov_b32 s8, s42
    s_and_b32 s9, s43, 0xffff
    s_mov_b32 s12, s44
    s_and_b32 s13, s45, 0xffff
    s_mov_b32 s16, s38
    s_and_b32 s17, s39, 0xffff
    s_mov_b32 s20, s30
    s_and_b32 s21, s31, 0xffff
    s_cmp_lt_u32 s57, 4
    s_cbranch_scc1 comp_2
    v_and_b32 v20, 31, v2
    v_lshlrev_b32 v20, 2, v20
    v_lshlrev_b32 v28, 4, v2
ldl_6:
    s_mov_b32 m0, s54
    s_add_u32 s55, s50, s51
    buffer_load_dwordx4 v4, s[4:7], s55 offen offset:0 lds
    buffer_load_dwordx4 v5, s[4:7], s55 offen offset:1024 lds
    buffer_load_dwordx4 v6, s[4:7], s55 offen offset:2048 lds
    buffer_load_dwordx4 v7, s[4:7], s55 offen offset:3072 lds
    s_add_u32 m0, s54, 16384
    s_add_u32 s55, s52, s53
    buffer_load_dwordx4 v8, s[8:11], s55 offen offset:0 lds
    buffer_load_dwordx4 v9, s[8:11], s55 offen offset:1024 lds
    buffer_load_dwordx4 v10, s[8:11], s55 offen offset:2048 lds
    buffer_load_dwordx4 v11, s[8:11], s55 offen offset:3072 lds
L_skipdma:
    s_add_u32 s51, s51, 128
    s_add_u32 s53, s53, 245760
    s_cmp_ge_u32 s51, 1280
    s_cselect_b32 s51, 0, s51
    s_cselect_b32 s53, 0, s53
    s_add_u32 s54, s54, 32768
    s_and_b32 s54, s54, 0x1ffff
    s_add_u32 s56, s56, 1
    s_cmp_lt_u32 s56, 2
    s_cbranch_scc1 ldl_6
    s_cmp_eq_u32 s56, 10
    s_cbranch_scc1 ldnb_7
    s_cmp_lg_u32 s56, 2
    s_cbranch_scc1 L_l_t
    s_waitcnt lgkmcnt(0)
L_l_t:
    s_cmp_lg_u32 s3, 6
    s_cbranch_scc1 L_l_ns
    s_sub_u32 s60, s56, 99
    s_cmp_le_u32 s60, 1
    s_cbranch_scc1 L_l_rf
    s_sub_u32 s60, s56, 2
    s_cmp_gt_u32 s60, 1
    s_cbranch_scc1 L_l_ns
    s_cmp_eq_u32 s60, 1
    s_cbranch_scc1 L_l_w16
    s_mov_b64 s[40:41], s[50:51]
    s_mov_b64 s[42:43], s[52:53]
    s_mov_b32 s60, s54
    s_mov_b32 s47, 131072
    s_add_u32 s29, s2, 376
    s_call_b64 s[0:1], L_rissue
    s_mov_b64 s[50:51], s[40:41]
    s_mov_b64 s[52:53], s[42:43]
    s_mov_b32 s54, s60
    s_mov_b32 s56, 2
L_l_w16:
    s_waitcnt vmcnt(16)
    s_barrier
    s_branch ldl_6
L_l_rf:
    s_cmp_eq_u32 s60, 1
    s_cbranch_scc1 L_l_w17
    s_mov_b64 s[40:41], s[50:51]
    s_mov_b64 s[42:43], s[52:53]
    s_mov_b32 s60, s54
    s_call_b64 s[0:1], L_rfinish
    s_mov_b64 s[50:51], s[40:41]
    s_mov_b64 s[52:53], s[42:43]
    s_mov_b32 s54, s60
    s_mov_b32 s56, 99
L_l_w17:
    s_waitcnt vmcnt(17)
    s_branch L_l_b
L_l_ns:
    s_waitcnt vmcnt(8)
L_l_b:
    s_barrier
    s_cmp_lg_u32 s56, 9
    s_cbranch_scc1 ldl_6
    s_add_u32 s26, s26, 1
    s_mul_i32 s26, s26, 2654435761
    s_lshl_b32 s40, s24, 7
    s_add_u32 s40, s40, 1024
    buffer_load_dword v21, v20, s[12:15], s40 offen sc1
    s_lshl_b32 s42, s24, 11
    s_lshl_b32 s43, s46, 10
    s_add_u32 s42, s42, s43
    s_add_u32 s42, s42, 49152
    s_cmp_lg_u32 s3, 7
    s_cbranch_scc1 ldl_6
    buffer_load_dwordx4 v[24:27], v28, s[12:15], s42 offen sc1
    s_branch ldl_6
ldnb_7:
    s_waitcnt vmcnt(8)
    s_barrier
    s_add_u32 s56, s56, 1
    s_mov_b32 s41, 30000
    s_branch mc_9
ml_8:
    buffer_load_dword v21, v20, s[12:15], s40 offen sc1
    s_waitcnt vmcnt(0)
mc_9:
    v_subrev_u32 v21, s26, v21
    v_cmp_lt_u32 vcc, 15, v21
    s_nop 0
    s_cmp_eq_u64 vcc, 0
    s_cbranch_scc1 md_10
    s_sleep 1
    s_sub_u32 s41, s41, 1
    s_cbranch_scc0 ml_8
md_10:
    v_cmp_ne_u32 vcc, s28, v21
    s_nop 0
    s_cmp_lg_u64 vcc, 0
    s_cselect_b32 s27, 1, 0
    v_mov_b32 v22, s27
    v_mov_b32 v23, 0
    v_mov_b32 v20, 160768
    ds_write_b64 v20, v[22:23]
    v_mov_b32 v22, 0
    ds_write_b32 v20, v23 offset:8
    ds_write2_b64 v20, v[22:23], v[22:23] offset0:2 offset1:3
    s_cmp_lg_u32 s3, 7
    s_cbranch_scc1 L_l_ng
    s_mov_b32 s41, 30000
L_l_gl:
    v_xor_b32 v25, s26, v25
    v_xor_b32 v27, s26, v27
    v_or_b32 v25, v25, v27
    v_cmp_ne_u32 vcc, 0, v25
    s_nop 0
    s_cmp_eq_u64 vcc, 0
    s_cbranch_scc1 L_l_gd
    buffer_load_dwordx4 v[24:27], v28, s[12:15], s42 offen sc1
    s_waitcnt vmcnt(0)
    s_sub_u32 s41, s41, 1
    s_cbranch_scc0 L_l_gl
L_l_gd:
    v_mov_b32 v25, v26
    v_lshlrev_b32 v17, 3, v2
    v_add_u32 v17, 161280, v17
    ds_write_b64 v17, v[24:25]
L_l_ng:
    s_waitcnt vmcnt(0) lgkmcnt(0)
L_l_b10:
    s_barrier
    s_cmp_lg_u32 s3, 6
    s_cbranch_scc1 L_l_wo
    s_call_b64 s[0:1], L_rfinish
L_l_wo:
    s_branch L_j1
comp_2:
    s_cmp_ge_u32 s3, 4
    s_cbranch_scc1 sp2_11
    s_lshl_b32 s40, s24, 8
    s_lshl_b32 s41, s25, 3
    s_add_u32 s40, s40, s41
    s_lshl_b32 s41, s3, 1
    s_add_u32 s40, s40, s41
    s_mul_i32 s41, s40, 1280
    v_lshrrev_b32 v210, 5, v2
    v_and_b32 v211, 31, v2
    v_mul_u32_u24 v212, 1280, v210
    v_lshl_add_u32 v213, v211, 4, v212
    v_lshl_add_u32 v212, v211, 3, v212
    buffer_load_dwordx4 v[200:203], v213, s[4:7], s41 offen
    buffer_load_dwordx4 v[204:207], v213, s[4:7], s41 offen offset:512
    buffer_load_dwordx2 v[208:209], v212, s[4:7], s41 offen offset:1024
    v_mov_b32 v214, 0x3f803f80
    v_mov_b64 v[216:217], 0
    s_cmp_ge_u32 s25, 30
    s_cbranch_scc1 sp2_11
    v_mov_b32 v16, 0x3f803f80
    v_mov_b32 v17, 0x3f803f80
    v_mov_b32 v18, 0x3f803f80
    v_mov_b32 v19, 0x3f803f80
    v_mov_b64 v[32:33], 0
    v_mov_b64 v[34:35], 0
    v_mov_b64 v[36:37], 0
    v_mov_b64 v[38:39], 0
    v_mov_b64 v[40:41], 0
    v_mov_b64 v[42:43], 0
    v_mov_b64 v[44:45], 0
    v_mov_b64 v[46:47], 0
    v_mov_b64 v[48:49], 0
    v_mov_b64 v[50:51], 0
    v_mov_b64 v[52:53], 0
    v_mov_b64 v[54:55], 0
    v_mov_b64 v[56:57], 0
    v_mov_b64 v[58:59], 0
    v_mov_b64 v[60:61], 0
    v_mov_b64 v[62:63], 0
    v_mov_b64 v[64:65], 0
    v_mov_b64 v[66:67], 0
    v_mov_b64 v[68:69], 0
    v_mov_b64 v[70:71], 0
    v_mov_b64 v[72:73], 0
    v_mov_b64 v[74:75], 0
    v_mov_b64 v[76:77], 0
    v_mov_b64 v[78:79], 0
    v_mov_b64 v[80:81], 0
    v_mov_b64 v[82:83], 0
    v_mov_b64 v[84:85], 0
    v_mov_b64 v[86:87], 0
    v_mov_b64 v[88:89], 0
    v_mov_b64 v[90:91], 0
    v_mov_b64 v[92:93], 0
    v_mov_b64 v[94:95], 0
    v_mov_b64 v[96:97], 0
    v_mov_b64 v[98:99], 0
    v_mov_b64 v[100:101], 0
    v_mov_b64 v[102:103], 0
    s_mov_b32 s43, s49
    s_lshr_b32 s49, s3, 1
    s_and_b32 s50, s3, 1
    v_and_b32 v3, 15, v2
    v_lshrrev_b32 v4, 4, v2
    v_lshrrev_b32 v5, 1, v3
    v_xor_b32 v5, v5, v4
    v_lshlrev_b32 v6, 7, v3
    s_lshl_b32 s51, s49, 13
    s_add_u32 s51, s51, 65536
    v_add_u32 v6, s51, v6
    v_lshl_add_u32 v8, v5, 4, v6
    v_xor_b32 v9, 64, v8
    v_bfe_u32 v5, v2, 2, 2
    v_lshl_add_u32 v6, v4, 3, v5
    v_lshlrev_b32 v6, 7, v6
    v_and_b32 v7, 1, v2
    v_lshl_add_u32 v6, v7, 3, v6
    s_lshl_b32 s51, s50, 13
    s_add_u32 s51, s51, 81920
    v_add_u32 v6, s51, v6
    v_and_b32 v5, 2, v5
    v_and_b32 v7, 1, v4
    v_lshl_add_u32 v5, v7, 2, v5
    v_bfe_u32 v7, v2, 1, 1
    v_xor_b32 v5, v5, v7
    s_lshl_b32 s51, s49, 2
    v_xor_b32 v5, s51, v5
    v_lshl_add_u32 v10, v5, 4, v6
    v_xor_b32 v11, 32, v10
    v_xor_b32 v12, 64, v10
    v_xor_b32 v13, 96, v10
    s_waitcnt vmcnt(0)
    v_dot2c_f32_bf16 v216, v214, v200
    v_dot2c_f32_bf16 v217, v200, v200
    v_dot2c_f32_bf16 v216, v214, v201
    v_dot2c_f32_bf16 v217, v201, v201
    v_dot2c_f32_bf16 v216, v214, v202
    v_dot2c_f32_bf16 v217, v202, v202
    v_dot2c_f32_bf16 v216, v214, v203
    v_dot2c_f32_bf16 v217, v203, v203
    v_dot2c_f32_bf16 v216, v214, v204
    v_dot2c_f32_bf16 v217, v204, v204
    v_dot2c_f32_bf16 v216, v214, v205
    v_dot2c_f32_bf16 v217, v205, v205
    v_dot2c_f32_bf16 v216, v214, v206
    v_dot2c_f32_bf16 v217, v206, v206
    v_dot2c_f32_bf16 v216, v214, v207
    v_dot2c_f32_bf16 v217, v207, v207
    v_dot2c_f32_bf16 v216, v214, v208
    v_dot2c_f32_bf16 v217, v208, v208
    v_dot2c_f32_bf16 v216, v214, v209
    v_dot2c_f32_bf16 v217, v209, v209
    s_nop 1
    v_add_f32_dpp v216, v216, v216 row_ror:8 row_mask:0xf bank_mask:0xf
    v_add_f32_dpp v217, v217, v217 row_ror:8 row_mask:0xf bank_mask:0xf
    s_nop 0
    v_add_f32_dpp v216, v216, v216 row_ror:4 row_mask:0xf bank_mask:0xf
    v_add_f32_dpp v217, v217, v217 row_ror:4 row_mask:0xf bank_mask:0xf
    s_nop 0
    v_add_f32_dpp v216, v216, v216 row_ror:2 row_mask:0xf bank_mask:0xf
    v_add_f32_dpp v217, v217, v217 row_ror:2 row_mask:0xf bank_mask:0xf
    s_nop 0
    v_add_f32_dpp v216, v216, v216 row_ror:1 row_mask:0xf bank_mask:0xf
    v_add_f32_dpp v217, v217, v217 row_ror:1 row_mask:0xf bank_mask:0xf
    v_mov_b64 v[218:219], v[216:217]
    s_nop 1
    v_permlane16_swap_b32 v216, v218
    v_permlane16_swap_b32 v217, v219
    v_add_f32 v200, v216, v218
    v_add_f32 v202, v217, v219
    v_mul_f32 v200, 986500301, v200
    v_mul_f32 v202, 986500301, v202
    v_fma_f32 v202, -v200, v200, v202
    v_max_f32 v202, 0, v202
    v_cvt_pk_bf16_f32 v202, v202, v202
    v_and_b32 v202, 0xffff0000, v202
    v_add_f32 v202, 925353388, v202
    v_cvt_pk_bf16_f32 v202, v202, v202
    v_and_b32 v202, 0xffff0000, v202
    v_sqrt_f32 v202, v202
    s_nop 0
    v_cvt_pk_bf16_f32 v204, -v200, v202
    v_lshlrev_b32 v206, 3, v210
    s_lshl_b32 s41, s40, 3
    s_add_u32 s41, s41, 49152
    s_waitcnt lgkmcnt(0)
    s_add_u32 s26, s26, 1
    s_mul_i32 s26, s26, 2654435761
    v_mov_b32 v205, s26
    s_mov_b32 exec_lo, 1
    s_mov_b32 exec_hi, 1
    buffer_store_dwordx2 v[204:205], v206, s[12:15], s41 offen sc1
    s_mov_b64 exec, -1
    s_lshl_b32 s51, s24, 2
    s_lshl_b32 s52, s46, 1
    s_add_u32 s52, s52, s49
    s_add_u32 s51, s51, s52
    s_lshl_b32 s53, s49, 8
    s_add_u32 s53, s53, 161280
    v_lshl_add_u32 v15, v3, 2, s53
    v_lshlrev_b32 v20, 4, v4
    s_lshl_b32 s56, s49, 1
    s_add_u32 s56, s56, s50
    s_lshl_b32 s56, s56, 7
    s_lshl_b32 s62, s56, 1
    s_add_u32 s56, s56, 159744
    v_add_u32 v21, s56, v20
    v_xor_b32 v22, 256, v21
    v_lshlrev_b32 v14, 1, v4
    v_and_b32 v14, 2, v14
    v_lshrrev_b32 v20, 1, v4
    v_or_b32 v14, v14, v20
    v_lshlrev_b32 v14, 10, v14
    v_lshl_add_u32 v14, v3, 4, v14
    s_lshl_b32 s54, s47, 1
    s_add_u32 s54, s54, s50
    s_lshl_b32 s55, s54, 2
    s_add_u32 s55, s55, s52
    s_lshl_b32 s55, s55, 2
    s_lshl_b32 s56, s24, 9
    s_add_u32 s55, s55, s56
    s_add_u32 s55, s55, 2048
    s_lshl_b32 s54, s54, 13
    s_lshl_b32 s56, s49, 12
    s_add_u32 s54, s54, s56
    s_xor_b32 s56, s54, 4096
    s_mul_i32 s57, s51, 655360
    s_add_u32 s57, s57, 1048576
    s_add_u32 s60, s54, s57
    s_add_u32 s61, s56, s57
    s_mov_b32 s59, 1051011932
    s_cmp_lt_u32 s47, 5
    s_cselect_b32 s59, s59, 1.0
    v_mov_b32 v184, 160768
    s_lshl_b32 s44, s3, 2
    s_add_u32 s44, s44, 160784
    v_mov_b32 v186, s44
    s_mov_b32 s44, 4
    s_barrier
    ds_read_b64_tr_b16 v[128:129], v10 offset:0
    ds_read_b64_tr_b16 v[130:131], v10 offset:512
    ds_read_b128 v[112:115], v8 offset:0
    ds_read_b64_tr_b16 v[132:133], v11 offset:0
    ds_read_b64_tr_b16 v[134:135], v11 offset:512
    ds_read_b128 v[116:119], v8 offset:2048
    ds_read_b64_tr_b16 v[136:137], v12 offset:0
    ds_read_b64_tr_b16 v[138:139], v12 offset:512
    ds_read_b128 v[120:123], v8 offset:4096
    ds_read_b64_tr_b16 v[140:141], v13 offset:0
    ds_read_b64_tr_b16 v[142:143], v13 offset:512
    ds_read_b128 v[124:127], v8 offset:6144
    s_cmp_lg_u32 s3, 0
    s_cbranch_scc1 nohello_13
    s_add_u32 s41, s26, s28
    v_mov_b32 v207, s41
    s_lshl_b32 s41, s24, 7
    s_lshl_b32 s42, s25, 2
    s_add_u32 s41, s41, s42
    s_add_u32 s41, s41, 1024
    s_mov_b64 exec, 1
    buffer_store_dword v207, off, s[12:15], s41 sc1
    s_mov_b64 exec, -1
nohello_13:
    v_lshlrev_b32 v187, 7, v2
    s_min_u32 s58, s60, s61
    s_mul_i32 s45, s3, 0
    s_add_u32 s45, s45, 0
    v_min_u32 v187, 21, v2
    s_mul_i32 s58, s25, 22
    v_add_u32 v187, s58, v187
    v_min_u32 v187, 639, v187
    v_lshlrev_b32 v187, 7, v187
    s_lshl_b32 s58, s24, 2
    s_add_u32 s58, s58, s3
    s_mul_i32 s58, s58, 655360
    s_add_u32 s58, s58, 1048576
k1loop_14:
    s_waitcnt lgkmcnt(6)
    v_mfma_f32_16x16x32_bf16 v[32:35], v[128:131], v[112:115], v[32:35]
    ds_read_b64_tr_b16 v[160:161], v10 offset:4096
    s_nop 1
    v_mfma_f32_16x16x32_bf16 v[96:99], v[128:131], v[16:19], v[96:99]
    ds_read_b64_tr_b16 v[162:163], v10 offset:4608
    s_nop 1
    v_mfma_f32_16x16x32_bf16 v[48:51], v[132:135], v[112:115], v[48:51]
    ds_read_b128 v[144:147], v9 offset:0
    s_nop 1
    v_mfma_f32_16x16x32_bf16 v[36:39], v[128:131], v[116:119], v[36:39]
    ds_read_b64_tr_b16 v[164:165], v11 offset:4096
    s_nop 1
    v_mfma_f32_16x16x32_bf16 v[52:55], v[132:135], v[116:119], v[52:55]
    ds_read_b64_tr_b16 v[166:167], v11 offset:4608
    s_nop 1
    v_mfma_f32_16x16x32_bf16 v[100:103], v[132:135], v[16:19], v[100:103]
    ds_read_b128 v[148:151], v9 offset:2048
    s_nop 1
    s_waitcnt lgkmcnt(9)
    v_mfma_f32_16x16x32_bf16 v[64:67], v[136:139], v[112:115], v[64:67]
    ds_read_b64_tr_b16 v[168:169], v12 offset:4096
    s_nop 1
    v_mfma_f32_16x16x32_bf16 v[68:71], v[136:139], v[116:119], v[68:71]
    ds_read_b64_tr_b16 v[170:171], v12 offset:4608
    s_nop 1
    v_mfma_f32_16x16x32_bf16 v[40:43], v[128:131], v[120:123], v[40:43]
    ds_read_b128 v[152:155], v9 offset:4096
    s_nop 1
    v_mfma_f32_16x16x32_bf16 v[56:59], v[132:135], v[120:123], v[56:59]
    ds_read_b64_tr_b16 v[172:173], v13 offset:4096
    s_nop 1
    v_mfma_f32_16x16x32_bf16 v[72:75], v[136:139], v[120:123], v[72:75]
    ds_read_b64_tr_b16 v[174:175], v13 offset:4608
    s_nop 1
    s_waitcnt lgkmcnt(11)
    v_mfma_f32_16x16x32_bf16 v[80:83], v[140:143], v[112:115], v[80:83]
    ds_read_b128 v[156:159], v9 offset:6144
    s_nop 1
    v_mfma_f32_16x16x32_bf16 v[84:87], v[140:143], v[116:119], v[84:87]
    s_nop 1
    v_mfma_f32_16x16x32_bf16 v[88:91], v[140:143], v[120:123], v[88:91]
    s_nop 1
    v_mfma_f32_16x16x32_bf16 v[44:47], v[128:131], v[124:127], v[44:47]
    s_nop 1
    v_mfma_f32_16x16x32_bf16 v[60:63], v[132:135], v[124:127], v[60:63]
    s_nop 1
    v_mfma_f32_16x16x32_bf16 v[76:79], v[136:139], v[124:127], v[76:79]
    s_nop 1
    v_mfma_f32_16x16x32_bf16 v[92:95], v[140:143], v[124:127], v[92:95]
    s_nop 1
    s_waitcnt lgkmcnt(6)
    v_mfma_f32_16x16x32_bf16 v[32:35], v[160:163], v[144:147], v[32:35]
    s_barrier
    ds_read_b64_tr_b16 v[128:129], v10 offset:32768
    s_nop 1
    v_mfma_f32_16x16x32_bf16 v[96:99], v[160:163], v[16:19], v[96:99]
    ds_read_b64_tr_b16 v[130:131], v10 offset:33280
    s_nop 1
    v_mfma_f32_16x16x32_bf16 v[48:51], v[164:167], v[144:147], v[48:51]
    ds_read_b128 v[112:115], v8 offset:32768
    s_nop 1
    v_mfma_f32_16x16x32_bf16 v[36:39], v[160:163], v[148:151], v[36:39]
    ds_read_b64_tr_b16 v[132:133], v11 offset:32768
    s_nop 1
    v_mfma_f32_16x16x32_bf16 v[52:55], v[164:167], v[148:151], v[52:55]
    ds_read_b64_tr_b16 v[134:135], v11 offset:33280
    s_nop 1
    v_mfma_f32_16x16x32_bf16 v[100:103], v[164:167], v[16:19], v[100:103]
    ds_read_b128 v[116:119], v8 offset:34816
    s_nop 1
    s_waitcnt lgkmcnt(9)
    v_mfma_f32_16x16x32_bf16 v[64:67], v[168:171], v[144:147], v[64:67]
    ds_read_b64_tr_b16 v[136:137], v12 offset:32768
    s_nop 1
    v_mfma_f32_16x16x32_bf16 v[68:71], v[168:171], v[148:151], v[68:71]
    ds_read_b64_tr_b16 v[138:139], v12 offset:33280
    s_nop 1
    v_mfma_f32_16x16x32_bf16 v[40:43], v[160:163], v[152:155], v[40:43]
    ds_read_b128 v[120:123], v8 offset:36864
    s_nop 1
    v_mfma_f32_16x16x32_bf16 v[56:59], v[164:167], v[152:155], v[56:59]
    ds_read_b64_tr_b16 v[140:141], v13 offset:32768
    s_nop 1
    v_mfma_f32_16x16x32_bf16 v[72:75], v[168:171], v[152:155], v[72:75]
    ds_read_b64_tr_b16 v[142:143], v13 offset:33280
    s_nop 1
    s_waitcnt lgkmcnt(11)
    v_mfma_f32_16x16x32_bf16 v[80:83], v[172:175], v[144:147], v[80:83]
    ds_read_b128 v[124:127], v8 offset:38912
    s_nop 1
    v_mfma_f32_16x16x32_bf16 v[84:87], v[172:175], v[148:151], v[84:87]
    s_nop 1
    v_mfma_f32_16x16x32_bf16 v[88:91], v[172:175], v[152:155], v[88:91]
    s_sub_u32 s45, s45, 1
    s_cbranch_scc0 tq_15
    buffer_load_dword v254, v187, s[12:15], s58 offen sc1
tq_15:
    s_nop 1
    v_mfma_f32_16x16x32_bf16 v[44:47], v[160:163], v[156:159], v[44:47]
    s_nop 1
    v_mfma_f32_16x16x32_bf16 v[60:63], v[164:167], v[156:159], v[60:63]
    s_nop 1
    v_mfma_f32_16x16x32_bf16 v[76:79], v[168:171], v[156:159], v[76:79]
    s_nop 1
    v_mfma_f32_16x16x32_bf16 v[92:95], v[172:175], v[156:159], v[92:95]
    s_nop 1
    s_waitcnt lgkmcnt(6)
    v_mfma_f32_16x16x32_bf16 v[32:35], v[128:131], v[112:115], v[32:35]
    ds_read_b64_tr_b16 v[160:161], v10 offset:36864
    s_nop 1
    v_mfma_f32_16x16x32_bf16 v[96:99], v[128:131], v[16:19], v[96:99]
    ds_read_b64_tr_b16 v[162:163], v10 offset:37376
    s_nop 1
    v_mfma_f32_16x16x32_bf16 v[48:51], v[132:135], v[112:115], v[48:51]
    ds_read_b128 v[144:147], v9 offset:32768
    v_xor_b32 v10, 0x10000, v10
    s_nop 1
    v_mfma_f32_16x16x32_bf16 v[36:39], v[128:131], v[116:119], v[36:39]
    ds_read_b64_tr_b16 v[164:165], v11 offset:36864
    v_xor_b32 v8, 0x10000, v8
    s_nop 1
    v_mfma_f32_16x16x32_bf16 v[52:55], v[132:135], v[116:119], v[52:55]
    ds_read_b64_tr_b16 v[166:167], v11 offset:37376
    s_nop 1
    v_mfma_f32_16x16x32_bf16 v[100:103], v[132:135], v[16:19], v[100:103]
    ds_read_b128 v[148:151], v9 offset:34816
    v_xor_b32 v11, 0x10000, v11
    s_nop 1
    s_waitcnt lgkmcnt(9)
    v_mfma_f32_16x16x32_bf16 v[64:67], v[136:139], v[112:115], v[64:67]
    ds_read_b64_tr_b16 v[168:169], v12 offset:36864
    s_nop 1
    v_mfma_f32_16x16x32_bf16 v[68:71], v[136:139], v[116:119], v[68:71]
    ds_read_b64_tr_b16 v[170:171], v12 offset:37376
    s_nop 1
    v_mfma_f32_16x16x32_bf16 v[40:43], v[128:131], v[120:123], v[40:43]
    ds_read_b128 v[152:155], v9 offset:36864
    v_xor_b32 v12, 0x10000, v12
    s_nop 1
    v_mfma_f32_16x16x32_bf16 v[56:59], v[132:135], v[120:123], v[56:59]
    ds_read_b64_tr_b16 v[172:173], v13 offset:36864
    s_nop 1
    v_mfma_f32_16x16x32_bf16 v[72:75], v[136:139], v[120:123], v[72:75]
    ds_read_b64_tr_b16 v[174:175], v13 offset:37376
    s_nop 1
    s_waitcnt lgkmcnt(11)
    v_mfma_f32_16x16x32_bf16 v[80:83], v[140:143], v[112:115], v[80:83]
    ds_read_b128 v[156:159], v9 offset:38912
    s_nop 1
    v_mfma_f32_16x16x32_bf16 v[84:87], v[140:143], v[116:119], v[84:87]
    v_xor_b32 v13, 0x10000, v13
    s_nop 1
    v_mfma_f32_16x16x32_bf16 v[88:91], v[140:143], v[120:123], v[88:91]
    v_xor_b32 v9, 0x10000, v9
    s_nop 1
    v_mfma_f32_16x16x32_bf16 v[44:47], v[128:131], v[124:127], v[44:47]
    s_nop 1
    v_mfma_f32_16x16x32_bf16 v[60:63], v[132:135], v[124:127], v[60:63]
    s_nop 1
    v_mfma_f32_16x16x32_bf16 v[76:79], v[136:139], v[124:127], v[76:79]
    s_nop 1
    v_mfma_f32_16x16x32_bf16 v[92:95], v[140:143], v[124:127], v[92:95]
    s_nop 1
    s_waitcnt lgkmcnt(6)
    v_mfma_f32_16x16x32_bf16 v[32:35], v[160:163], v[144:147], v[32:35]
    s_barrier
    ds_read_b64_tr_b16 v[128:129], v10 offset:0
    s_nop 1
    v_mfma_f32_16x16x32_bf16 v[96:99], v[160:163], v[16:19], v[96:99]
    ds_read_b64_tr_b16 v[130:131], v10 offset:512
    s_nop 1
    v_mfma_f32_16x16x32_bf16 v[48:51], v[164:167], v[144:147], v[48:51]
    ds_read_b128 v[112:115], v8 offset:0
    s_nop 1
    v_mfma_f32_16x16x32_bf16 v[36:39], v[160:163], v[148:151], v[36:39]
    ds_read_b64_tr_b16 v[132:133], v11 offset:0
    s_nop 1
    v_mfma_f32_16x16x32_bf16 v[52:55], v[164:167], v[148:151], v[52:55]
    ds_read_b64_tr_b16 v[134:135], v11 offset:512
    s_nop 1
    v_mfma_f32_16x16x32_bf16 v[100:103], v[164:167], v[16:19], v[100:103]
    ds_read_b128 v[116:119], v8 offset:2048
    s_nop 1
    s_waitcnt lgkmcnt(9)
    v_mfma_f32_16x16x32_bf16 v[64:67], v[168:171], v[144:147], v[64:67]
    ds_read_b64_tr_b16 v[136:137], v12 offset:0
    s_nop 1
    v_mfma_f32_16x16x32_bf16 v[68:71], v[168:171], v[148:151], v[68:71]
    ds_read_b64_tr_b16 v[138:139], v12 offset:512
    s_nop 1
    v_mfma_f32_16x16x32_bf16 v[40:43], v[160:163], v[152:155], v[40:43]
    ds_read_b128 v[120:123], v8 offset:4096
    s_nop 1
    v_mfma_f32_16x16x32_bf16 v[56:59], v[164:167], v[152:155], v[56:59]
    ds_read_b64_tr_b16 v[140:141], v13 offset:0
    s_nop 1
    v_mfma_f32_16x16x32_bf16 v[72:75], v[168:171], v[152:155], v[72:75]
    ds_read_b64_tr_b16 v[142:143], v13 offset:512
    s_nop 1
    s_waitcnt lgkmcnt(11)
    v_mfma_f32_16x16x32_bf16 v[80:83], v[172:175], v[144:147], v[80:83]
    ds_read_b128 v[124:127], v8 offset:6144
    s_nop 1
    v_mfma_f32_16x16x32_bf16 v[84:87], v[172:175], v[148:151], v[84:87]
    s_nop 1
    v_mfma_f32_16x16x32_bf16 v[88:91], v[172:175], v[152:155], v[88:91]
    s_sub_u32 s45, s45, 1
    s_cbranch_scc0 tq_16
    buffer_load_dword v254, v187, s[12:15], s58 offen sc1
tq_16:
    s_nop 1
    v_mfma_f32_16x16x32_bf16 v[44:47], v[160:163], v[156:159], v[44:47]
    s_sub_u32 s44, s44, 1
    s_cmp_lg_u32 s44, 0
    s_nop 1
    v_mfma_f32_16x16x32_bf16 v[60:63], v[164:167], v[156:159], v[60:63]
    s_nop 1
    v_mfma_f32_16x16x32_bf16 v[76:79], v[168:171], v[156:159], v[76:79]
    s_nop 1
    v_mfma_f32_16x16x32_bf16 v[92:95], v[172:175], v[156:159], v[92:95]
    s_nop 1
    s_cbranch_scc1 k1loop_14
    s_waitcnt lgkmcnt(6)
    v_mfma_f32_16x16x32_bf16 v[32:35], v[128:131], v[112:115], v[32:35]
    ds_read_b64_tr_b16 v[160:161], v10 offset:4096
    v_mfma_f32_16x16x32_bf16 v[96:99], v[128:131], v[16:19], v[96:99]
    ds_read_b64_tr_b16 v[162:163], v10 offset:4608
    v_mfma_f32_16x16x32_bf16 v[48:51], v[132:135], v[112:115], v[48:51]
    ds_read_b128 v[144:147], v9 offset:0
    v_mfma_f32_16x16x32_bf16 v[100:103], v[132:135], v[16:19], v[100:103]
    ds_read_b64_tr_b16 v[164:165], v11 offset:4096
    v_mfma_f32_16x16x32_bf16 v[36:39], v[128:131], v[116:119], v[36:39]
    ds_read_b64_tr_b16 v[166:167], v11 offset:4608
    v_mfma_f32_16x16x32_bf16 v[52:55], v[132:135], v[116:119], v[52:55]
    ds_read_b128 v[148:151], v9 offset:2048
    s_waitcnt lgkmcnt(9)
    v_mfma_f32_16x16x32_bf16 v[64:67], v[136:139], v[112:115], v[64:67]
    ds_read_b64_tr_b16 v[168:169], v12 offset:4096
    v_mfma_f32_16x16x32_bf16 v[68:71], v[136:139], v[116:119], v[68:71]
    ds_read_b64_tr_b16 v[170:171], v12 offset:4608
    v_mfma_f32_16x16x32_bf16 v[40:43], v[128:131], v[120:123], v[40:43]
    ds_read_b128 v[152:155], v9 offset:4096
    v_mfma_f32_16x16x32_bf16 v[56:59], v[132:135], v[120:123], v[56:59]
    ds_read_b64_tr_b16 v[172:173], v13 offset:4096
    v_mfma_f32_16x16x32_bf16 v[72:75], v[136:139], v[120:123], v[72:75]
    ds_read_b64_tr_b16 v[174:175], v13 offset:4608
    s_waitcnt lgkmcnt(11)
    v_mfma_f32_16x16x32_bf16 v[80:83], v[140:143], v[112:115], v[80:83]
    ds_read_b128 v[156:159], v9 offset:6144
    v_mfma_f32_16x16x32_bf16 v[84:87], v[140:143], v[116:119], v[84:87]
    ds_write_b128 v21, v[96:99]
    v_mfma_f32_16x16x32_bf16 v[88:91], v[140:143], v[120:123], v[88:91]
    ds_write_b128 v21, v[100:103] offset:64
    v_mfma_f32_16x16x32_bf16 v[44:47], v[128:131], v[124:127], v[44:47]
    v_mfma_f32_16x16x32_bf16 v[60:63], v[132:135], v[124:127], v[60:63]
    v_mfma_f32_16x16x32_bf16 v[76:79], v[136:139], v[124:127], v[76:79]
    v_mfma_f32_16x16x32_bf16 v[92:95], v[140:143], v[124:127], v[92:95]
    s_waitcnt lgkmcnt(8)
    v_mfma_f32_16x16x32_bf16 v[32:35], v[160:163], v[144:147], v[32:35]
    s_waitcnt lgkmcnt(0)
    s_barrier
    ds_read_b64_tr_b16 v[128:129], v10 offset:32768
    v_mfma_f32_16x16x32_bf16 v[96:99], v[160:163], v[16:19], v[96:99]
    ds_read_b64_tr_b16 v[130:131], v10 offset:33280
    s_sub_u32 s45, s45, 1
    s_cbranch_scc0 tq_17
    buffer_load_dword v254, v187, s[12:15], s58 offen sc1
tq_17:
    v_mfma_f32_16x16x32_bf16 v[48:51], v[164:167], v[144:147], v[48:51]
    ds_read_b128 v[112:115], v8 offset:32768
    v_mfma_f32_16x16x32_bf16 v[36:39], v[160:163], v[148:151], v[36:39]
    ds_read_b64_tr_b16 v[132:133], v11 offset:32768
    v_mfma_f32_16x16x32_bf16 v[52:55], v[164:167], v[148:151], v[52:55]
    ds_read_b64_tr_b16 v[134:135], v11 offset:33280
    v_mfma_f32_16x16x32_bf16 v[100:103], v[164:167], v[16:19], v[100:103]
    ds_read_b128 v[116:119], v8 offset:34816
    v_mfma_f32_16x16x32_bf16 v[64:67], v[168:171], v[144:147], v[64:67]
    ds_read_b128 v[104:107], v22
    v_mfma_f32_16x16x32_bf16 v[68:71], v[168:171], v[148:151], v[68:71]
    ds_read_b128 v[108:111], v22 offset:64
    v_mfma_f32_16x16x32_bf16 v[40:43], v[160:163], v[152:155], v[40:43]
    ds_read_b64_tr_b16 v[136:137], v12 offset:32768
    v_mfma_f32_16x16x32_bf16 v[56:59], v[164:167], v[152:155], v[56:59]
    ds_read_b64_tr_b16 v[138:139], v12 offset:33280
    v_mfma_f32_16x16x32_bf16 v[72:75], v[168:171], v[152:155], v[72:75]
    ds_read_b128 v[120:123], v8 offset:36864
    v_mfma_f32_16x16x32_bf16 v[80:83], v[172:175], v[144:147], v[80:83]
    ds_read_b64_tr_b16 v[140:141], v13 offset:32768
    v_mfma_f32_16x16x32_bf16 v[84:87], v[172:175], v[148:151], v[84:87]
    ds_read_b64_tr_b16 v[142:143], v13 offset:33280
    v_mfma_f32_16x16x32_bf16 v[88:91], v[172:175], v[152:155], v[88:91]
    ds_read_b128 v[124:127], v8 offset:38912
    v_mfma_f32_16x16x32_bf16 v[44:47], v[160:163], v[156:159], v[44:47]
    ds_read_b32 v176, v15 offset:0
    v_mfma_f32_16x16x32_bf16 v[60:63], v[164:167], v[156:159], v[60:63]
    ds_read_b32 v178, v15 offset:64
    v_mfma_f32_16x16x32_bf16 v[76:79], v[168:171], v[156:159], v[76:79]
    ds_read_b32 v180, v15 offset:128
    v_mfma_f32_16x16x32_bf16 v[92:95], v[172:175], v[156:159], v[92:95]
    ds_read_b32 v182, v15 offset:192
    s_waitcnt lgkmcnt(10)
    v_mfma_f32_16x16x32_bf16 v[104:107], v[168:171], v[16:19], v[104:107]
    ds_read_b32 v185, v184
    v_mfma_f32_16x16x32_bf16 v[108:111], v[172:175], v[16:19], v[108:111]
    v_mfma_f32_16x16x32_bf16 v[32:35], v[128:131], v[112:115], v[32:35]
    ds_read_b64_tr_b16 v[160:161], v10 offset:36864
    v_mfma_f32_16x16x32_bf16 v[96:99], v[128:131], v[16:19], v[96:99]
    ds_read_b64_tr_b16 v[162:163], v10 offset:37376
    v_mfma_f32_16x16x32_bf16 v[48:51], v[132:135], v[112:115], v[48:51]
    ds_read_b128 v[144:147], v9 offset:32768
    v_mfma_f32_16x16x32_bf16 v[36:39], v[128:131], v[116:119], v[36:39]
    ds_read_b64_tr_b16 v[164:165], v11 offset:36864
    v_mfma_f32_16x16x32_bf16 v[52:55], v[132:135], v[116:119], v[52:55]
    ds_read_b64_tr_b16 v[166:167], v11 offset:37376
    v_mfma_f32_16x16x32_bf16 v[100:103], v[132:135], v[16:19], v[100:103]
    ds_read_b128 v[148:151], v9 offset:34816
    s_waitcnt lgkmcnt(6)
    v_mfma_f32_16x16x32_bf16 v[64:67], v[136:139], v[112:115], v[64:67]
    ds_read_b64_tr_b16 v[168:169], v12 offset:36864
    v_and_b32 v177, 0xffff0000, v176
    v_mfma_f32_16x16x32_bf16 v[68:71], v[136:139], v[116:119], v[68:71]
    ds_read_b64_tr_b16 v[170:171], v12 offset:37376
    v_and_b32 v179, 0xffff0000, v178
    v_mfma_f32_16x16x32_bf16 v[40:43], v[128:131], v[120:123], v[40:43]
    ds_read_b128 v[152:155], v9 offset:36864
    v_and_b32 v181, 0xffff0000, v180
    v_mfma_f32_16x16x32_bf16 v[56:59], v[132:135], v[120:123], v[56:59]
    ds_read_b64_tr_b16 v[172:173], v13 offset:36864
    v_and_b32 v183, 0xffff0000, v182
    v_mfma_f32_16x16x32_bf16 v[72:75], v[136:139], v[120:123], v[72:75]
    ds_read_b64_tr_b16 v[174:175], v13 offset:37376
    v_rcp_f32 v177, v177
    v_mfma_f32_16x16x32_bf16 v[104:107], v[136:139], v[16:19], v[104:107]
    ds_read_b128 v[156:159], v9 offset:38912
    v_lshlrev_b32 v224, 16, v176
    v_mfma_f32_16x16x32_bf16 v[80:83], v[140:143], v[112:115], v[80:83]
    v_lshlrev_b32 v225, 16, v176
    v_rcp_f32 v179, v179
    v_lshlrev_b32 v228, 16, v178
    v_mfma_f32_16x16x32_bf16 v[84:87], v[140:143], v[116:119], v[84:87]
    v_lshlrev_b32 v229, 16, v178
    v_rcp_f32 v181, v181
    v_lshlrev_b32 v232, 16, v180
    v_mfma_f32_16x16x32_bf16 v[88:91], v[140:143], v[120:123], v[88:91]
    v_lshlrev_b32 v233, 16, v180
    v_rcp_f32 v183, v183
    v_lshlrev_b32 v236, 16, v182
    v_mfma_f32_16x16x32_bf16 v[44:47], v[128:131], v[124:127], v[44:47]
    v_lshlrev_b32 v237, 16, v182
    v_mul_f32 v226, s59, v177
    v_mfma_f32_16x16x32_bf16 v[60:63], v[132:135], v[124:127], v[60:63]
    v_mul_f32 v227, s59, v177
    v_mul_f32 v230, s59, v179
    v_mfma_f32_16x16x32_bf16 v[76:79], v[136:139], v[124:127], v[76:79]
    v_mul_f32 v231, s59, v179
    v_mul_f32 v234, s59, v181
    v_mfma_f32_16x16x32_bf16 v[92:95], v[140:143], v[124:127], v[92:95]
    v_mul_f32 v235, s59, v181
    v_mul_f32 v238, s59, v183
    v_mfma_f32_16x16x32_bf16 v[108:111], v[140:143], v[16:19], v[108:111]
    v_mul_f32 v239, s59, v183
    v_readfirstlane_b32 s27, v185
    s_waitcnt lgkmcnt(0)
    v_mfma_f32_16x16x32_bf16 v[96:99], v[160:163], v[16:19], v[96:99]
    v_mfma_f32_16x16x32_bf16 v[100:103], v[164:167], v[16:19], v[100:103]
    v_mfma_f32_16x16x32_bf16 v[104:107], v[168:171], v[16:19], v[104:107]
    v_mfma_f32_16x16x32_bf16 v[108:111], v[172:175], v[16:19], v[108:111]
    s_lshl_b32 s44, s27, 5
    s_add_u32 s44, s44, s25
    s_cmp_lt_u32 s44, 10
    v_mfma_f32_16x16x32_bf16 v[32:35], v[160:163], v[144:147], v[32:35]
    v_mfma_f32_16x16x32_bf16 v[48:51], v[164:167], v[144:147], v[48:51]
    v_mfma_f32_16x16x32_bf16 v[36:39], v[160:163], v[148:151], v[36:39]
    v_mfma_f32_16x16x32_bf16 v[52:55], v[164:167], v[148:151], v[52:55]
    v_mfma_f32_16x16x32_bf16 v[40:43], v[160:163], v[152:155], v[40:43]
    v_mfma_f32_16x16x32_bf16 v[56:59], v[164:167], v[152:155], v[56:59]
    v_mfma_f32_16x16x32_bf16 v[44:47], v[160:163], v[156:159], v[44:47]
    v_mfma_f32_16x16x32_bf16 v[60:63], v[164:167], v[156:159], v[60:63]
    v_mfma_f32_16x16x32_bf16 v[64:67], v[168:171], v[144:147], v[64:67]
    v_pk_fma_f32 v[32:33], v[96:97], v[224:225], v[32:33]
    v_pk_fma_f32 v[34:35], v[98:99], v[224:225], v[34:35]
    v_pk_fma_f32 v[48:49], v[100:101], v[224:225], v[48:49]
    v_pk_fma_f32 v[50:51], v[102:103], v[224:225], v[50:51]
    v_pk_mul_f32 v[32:33], v[32:33], v[226:227]
    v_pk_mul_f32 v[34:35], v[34:35], v[226:227]
    v_mfma_f32_16x16x32_bf16 v[80:83], v[172:175], v[144:147], v[80:83]
    v_pk_mul_f32 v[48:49], v[48:49], v[226:227]
    v_pk_mul_f32 v[50:51], v[50:51], v[226:227]
    v_cvt_pk_bf16_f32 v192, v32, v33
    v_cvt_pk_bf16_f32 v193, v34, v35
    v_cvt_pk_bf16_f32 v194, v48, v49
    v_cvt_pk_bf16_f32 v195, v50, v51
    v_mfma_f32_16x16x32_bf16 v[68:71], v[168:171], v[148:151], v[68:71]
    v_pk_fma_f32 v[36:37], v[96:97], v[228:229], v[36:37]
    v_pk_fma_f32 v[38:39], v[98:99], v[228:229], v[38:39]
    v_permlane16_swap_b32 v192, v194
    v_permlane16_swap_b32 v193, v195
    v_pk_fma_f32 v[52:53], v[100:101], v[228:229], v[52:53]
    v_pk_fma_f32 v[54:55], v[102:103], v[228:229], v[54:55]
    v_mfma_f32_16x16x32_bf16 v[84:87], v[172:175], v[148:151], v[84:87]
    s_cbranch_scc1 L_sp0
    buffer_store_dwordx4 v[192:195], v14, s[12:15], s60 offen offset:0 sc1
    s_branch L_sq0
L_sp0:
    buffer_store_dwordx4 v[192:195], v14, s[12:15], s60 offen offset:0
L_sq0:
    v_pk_mul_f32 v[36:37], v[36:37], v[230:231]
    v_pk_mul_f32 v[38:39], v[38:39], v[230:231]
    v_pk_mul_f32 v[52:53], v[52:53], v[230:231]
    v_pk_mul_f32 v[54:55], v[54:55], v[230:231]
    v_cvt_pk_bf16_f32 v196, v36, v37
    v_cvt_pk_bf16_f32 v197, v38, v39
    v_cvt_pk_bf16_f32 v198, v52, v53
    v_cvt_pk_bf16_f32 v199, v54, v55
    v_mfma_f32_16x16x32_bf16 v[72:75], v[168:171], v[152:155], v[72:75]
    v_pk_fma_f32 v[40:41], v[96:97], v[232:233], v[40:41]
    v_pk_fma_f32 v[42:43], v[98:99], v[232:233], v[42:43]
    v_permlane16_swap_b32 v196, v198
    v_permlane16_swap_b32 v197, v199
    v_pk_fma_f32 v[56:57], v[100:101], v[232:233], v[56:57]
    v_pk_fma_f32 v[58:59], v[102:103], v[232:233], v[58:59]
    v_mfma_f32_16x16x32_bf16 v[88:91], v[172:175], v[152:155], v[88:91]
    s_cbranch_scc1 L_sp1
    buffer_store_dwordx4 v[196:199], v14, s[12:15], s60 offen offset:256 sc1
    s_branch L_sq1
L_sp1:
    buffer_store_dwordx4 v[196:199], v14, s[12:15], s60 offen offset:256
L_sq1:
    v_pk_mul_f32 v[40:41], v[40:41], v[234:235]
    v_pk_mul_f32 v[42:43], v[42:43], v[234:235]
    v_pk_mul_f32 v[56:57], v[56:57], v[234:235]
    v_pk_mul_f32 v[58:59], v[58:59], v[234:235]
    v_cvt_pk_bf16_f32 v200, v40, v41
    v_cvt_pk_bf16_f32 v201, v42, v43
    v_cvt_pk_bf16_f32 v202, v56, v57
    v_cvt_pk_bf16_f32 v203, v58, v59
    v_mfma_f32_16x16x32_bf16 v[76:79], v[168:171], v[156:159], v[76:79]
    v_pk_fma_f32 v[44:45], v[96:97], v[236:237], v[44:45]
    v_pk_fma_f32 v[46:47], v[98:99], v[236:237], v[46:47]
    v_permlane16_swap_b32 v200, v202
    v_permlane16_swap_b32 v201, v203
    v_pk_fma_f32 v[60:61], v[100:101], v[236:237], v[60:61]
    v_pk_fma_f32 v[62:63], v[102:103], v[236:237], v[62:63]
    v_mfma_f32_16x16x32_bf16 v[92:95], v[172:175], v[156:159], v[92:95]
    s_cbranch_scc1 L_sp2
    buffer_store_dwordx4 v[200:203], v14, s[12:15], s60 offen offset:512 sc1
    s_branch L_sq2
L_sp2:
    buffer_store_dwordx4 v[200:203], v14, s[12:15], s60 offen offset:512
L_sq2:
    v_pk_mul_f32 v[44:45], v[44:45], v[238:239]
    v_pk_mul_f32 v[46:47], v[46:47], v[238:239]
    v_pk_mul_f32 v[60:61], v[60:61], v[238:239]
    v_pk_mul_f32 v[62:63], v[62:63], v[238:239]
    v_cvt_pk_bf16_f32 v204, v44, v45
    v_cvt_pk_bf16_f32 v205, v46, v47
    v_cvt_pk_bf16_f32 v206, v60, v61
    v_cvt_pk_bf16_f32 v207, v62, v63
    v_pk_fma_f32 v[64:65], v[104:105], v[224:225], v[64:65]
    v_pk_fma_f32 v[66:67], v[106:107], v[224:225], v[66:67]
    v_permlane16_swap_b32 v204, v206
    v_permlane16_swap_b32 v205, v207
    v_pk_fma_f32 v[80:81], v[108:109], v[224:225], v[80:81]
    v_pk_fma_f32 v[82:83], v[110:111], v[224:225], v[82:83]
    s_cbranch_scc1 L_sp3
    buffer_store_dwordx4 v[204:207], v14, s[12:15], s60 offen offset:768 sc1
    s_branch L_sq3
L_sp3:
    buffer_store_dwordx4 v[204:207], v14, s[12:15], s60 offen offset:768
L_sq3:
    v_pk_mul_f32 v[64:65], v[64:65], v[226:227]
    v_pk_mul_f32 v[66:67], v[66:67], v[226:227]
    v_pk_mul_f32 v[80:81], v[80:81], v[226:227]
    v_pk_mul_f32 v[82:83], v[82:83], v[226:227]
    v_cvt_pk_bf16_f32 v208, v64, v65
    v_cvt_pk_bf16_f32 v209, v66, v67
    v_cvt_pk_bf16_f32 v210, v80, v81
    v_cvt_pk_bf16_f32 v211, v82, v83
    v_pk_fma_f32 v[68:69], v[104:105], v[228:229], v[68:69]
    v_pk_fma_f32 v[70:71], v[106:107], v[228:229], v[70:71]
    v_permlane16_swap_b32 v208, v210
    v_permlane16_swap_b32 v209, v211
    v_pk_fma_f32 v[84:85], v[108:109], v[228:229], v[84:85]
    v_pk_fma_f32 v[86:87], v[110:111], v[228:229], v[86:87]
    s_cbranch_scc1 L_sp4
    buffer_store_dwordx4 v[208:211], v14, s[12:15], s61 offen offset:0 sc1
    s_branch L_sq4
L_sp4:
    buffer_store_dwordx4 v[208:211], v14, s[12:15], s61 offen offset:0
L_sq4:
    v_pk_mul_f32 v[68:69], v[68:69], v[230:231]
    v_pk_mul_f32 v[70:71], v[70:71], v[230:231]
    v_pk_mul_f32 v[84:85], v[84:85], v[230:231]
    v_pk_mul_f32 v[86:87], v[86:87], v[230:231]
    v_cvt_pk_bf16_f32 v212, v68, v69
    v_cvt_pk_bf16_f32 v213, v70, v71
    v_cvt_pk_bf16_f32 v214, v84, v85
    v_cvt_pk_bf16_f32 v215, v86, v87
    v_pk_fma_f32 v[72:73], v[104:105], v[232:233], v[72:73]
    v_pk_fma_f32 v[74:75], v[106:107], v[232:233], v[74:75]
    v_permlane16_swap_b32 v212, v214
    v_permlane16_swap_b32 v213, v215
    v_pk_fma_f32 v[88:89], v[108:109], v[232:233], v[88:89]
    v_pk_fma_f32 v[90:91], v[110:111], v[232:233], v[90:91]
    s_cbranch_scc1 L_sp5
    buffer_store_dwordx4 v[212:215], v14, s[12:15], s61 offen offset:256 sc1
    s_branch L_sq5
L_sp5:
    buffer_store_dwordx4 v[212:215], v14, s[12:15], s61 offen offset:256
L_sq5:
    v_pk_mul_f32 v[72:73], v[72:73], v[234:235]
    v_pk_mul_f32 v[74:75], v[74:75], v[234:235]
    v_pk_mul_f32 v[88:89], v[88:89], v[234:235]
    v_pk_mul_f32 v[90:91], v[90:91], v[234:235]
    v_cvt_pk_bf16_f32 v216, v72, v73
    v_cvt_pk_bf16_f32 v217, v74, v75
    v_cvt_pk_bf16_f32 v218, v88, v89
    v_cvt_pk_bf16_f32 v219, v90, v91
    v_pk_fma_f32 v[76:77], v[104:105], v[236:237], v[76:77]
    v_pk_fma_f32 v[78:79], v[106:107], v[236:237], v[78:79]
    v_permlane16_swap_b32 v216, v218
    v_permlane16_swap_b32 v217, v219
    v_pk_fma_f32 v[92:93], v[108:109], v[236:237], v[92:93]
    v_pk_fma_f32 v[94:95], v[110:111], v[236:237], v[94:95]
    s_cbranch_scc1 L_sp6
    buffer_store_dwordx4 v[216:219], v14, s[12:15], s61 offen offset:512 sc1
    s_branch L_sq6
L_sp6:
    buffer_store_dwordx4 v[216:219], v14, s[12:15], s61 offen offset:512
L_sq6:
    v_pk_mul_f32 v[76:77], v[76:77], v[238:239]
    v_pk_mul_f32 v[78:79], v[78:79], v[238:239]
    v_pk_mul_f32 v[92:93], v[92:93], v[238:239]
    v_pk_mul_f32 v[94:95], v[94:95], v[238:239]
    v_cvt_pk_bf16_f32 v220, v76, v77
    v_cvt_pk_bf16_f32 v221, v78, v79
    v_cvt_pk_bf16_f32 v222, v92, v93
    v_cvt_pk_bf16_f32 v223, v94, v95
    s_nop 0
    v_permlane16_swap_b32 v220, v222
    v_permlane16_swap_b32 v221, v223
    s_cbranch_scc1 L_sp7
    buffer_store_dwordx4 v[220:223], v14, s[12:15], s61 offen offset:768 sc1
    s_branch L_sq7
L_sp7:
    buffer_store_dwordx4 v[220:223], v14, s[12:15], s61 offen offset:768
L_sq7:
    s_branch L_j1
sp2_11:
    s_lshl_b32 s46, s24, 1
    s_add_u32 s46, s46, s25
    s_sub_u32 s46, s46, 30
    s_sub_u32 s44, 7, s3
    s_lshl_b32 s44, s44, 4
    s_add_u32 s44, s44, s46
    s_add_u32 s43, s44, 216
    s_cmp_lt_u32 s44, 80
    s_cselect_b32 s44, s44, s43
    s_mul_i32 s62, s3, 20480
    s_cmp_lt_u32 s3, 3
    s_cbranch_scc1 L_sp_ni
    s_mov_b32 s29, s44
    s_add_u32 s47, s62, 0
    s_call_b64 s[0:1], L_rissue
L_sp_ni:
    s_lshl_b32 s48, s24, 2
    s_add_u32 s48, s48, s3
    s_mul_i32 s48, s48, 655360
    s_add_u32 s48, s48, -933888
    s_movk_i32 s49, 8191
    s_lshl_b32 s50, s24, 9
    s_add_u32 s50, s50, 2048
    s_cmp_eq_u32 s3, 0
    s_cselect_b32 s48, s50, s48
    s_cselect_b32 s49, 511, s49
    s_lshl_b32 s50, s24, 10
    s_add_u32 s50, s50, 12288
    s_cmp_eq_u32 s3, 1
    s_cselect_b32 s48, s50, s48
    s_cselect_b32 s49, 1023, s49
    s_lshl_b32 s50, s24, 9
    s_add_u32 s50, s50, 20480
    s_cmp_eq_u32 s3, 2
    s_cselect_b32 s48, s50, s48
    s_cselect_b32 s49, 511, s49
    s_lshl_b32 s50, s24, 11
    s_add_u32 s50, s50, 24576
    s_cmp_eq_u32 s3, 3
    s_cselect_b32 s48, s50, s48
    s_cselect_b32 s49, 2047, s49
    v_lshlrev_b32 v26, 7, v2
    v_and_b32 v26, s49, v26
    buffer_load_dword v25, v26, s[12:15], s48 offen sc1
    s_cmp_lg_u32 s3, 7
    s_cbranch_scc1 L_nft2
    v_lshlrev_b32 v26, 7, v2
    v_mov_b32 v24, 8192
    v_mov_b32 v23, 44032
    v_cmp_lt_u32 vcc, 7, v2
    s_nop 1
    v_cndmask_b32 v24, v24, v23, vcc
    v_mov_b32 v23, 38912
    v_cmp_lt_u32 vcc, 15, v2
    s_nop 1
    v_cndmask_b32 v24, v24, v23, vcc
    v_mov_b32 v23, 65536
    v_cmp_lt_u32 vcc, 31, v2
    s_nop 1
    v_cndmask_b32 v24, v24, v23, vcc
    v_add_u32 v26, v26, v24
    buffer_load_dword v24, v26, s[12:15], 0 offen sc1
    v_and_b32 v26, 31, v2
    v_lshlrev_b32 v26, 7, v26
    s_lshl_b32 s48, s24, 12
    s_add_u32 s48, s48, 81920
    buffer_load_dword v23, v26, s[12:15], s48 offen sc1
L_nft2:
    s_waitcnt lgkmcnt(0)
    s_barrier
    s_cmp_ge_u32 s3, 4
    s_cbranch_scc1 L_sp_t
    s_waitcnt vmcnt(1)
    v_dot2c_f32_bf16 v216, v214, v200
    v_dot2c_f32_bf16 v217, v200, v200
    v_dot2c_f32_bf16 v216, v214, v201
    v_dot2c_f32_bf16 v217, v201, v201
    v_dot2c_f32_bf16 v216, v214, v202
    v_dot2c_f32_bf16 v217, v202, v202
    v_dot2c_f32_bf16 v216, v214, v203
    v_dot2c_f32_bf16 v217, v203, v203
    v_dot2c_f32_bf16 v216, v214, v204
    v_dot2c_f32_bf16 v217, v204, v204
    v_dot2c_f32_bf16 v216, v214, v205
    v_dot2c_f32_bf16 v217, v205, v205
    v_dot2c_f32_bf16 v216, v214, v206
    v_dot2c_f32_bf16 v217, v206, v206
    v_dot2c_f32_bf16 v216, v214, v207
    v_dot2c_f32_bf16 v217, v207, v207
    v_dot2c_f32_bf16 v216, v214, v208
    v_dot2c_f32_bf16 v217, v208, v208
    v_dot2c_f32_bf16 v216, v214, v209
    v_dot2c_f32_bf16 v217, v209, v209
    s_nop 1
    v_add_f32_dpp v216, v216, v216 row_ror:8 row_mask:0xf bank_mask:0xf
    v_add_f32_dpp v217, v217, v217 row_ror:8 row_mask:0xf bank_mask:0xf
    s_nop 0
    v_add_f32_dpp v216, v216, v216 row_ror:4 row_mask:0xf bank_mask:0xf
    v_add_f32_dpp v217, v217, v217 row_ror:4 row_mask:0xf bank_mask:0xf
    s_nop 0
    v_add_f32_dpp v216, v216, v216 row_ror:2 row_mask:0xf bank_mask:0xf
    v_add_f32_dpp v217, v217, v217 row_ror:2 row_mask:0xf bank_mask:0xf
    s_nop 0
    v_add_f32_dpp v216, v216, v216 row_ror:1 row_mask:0xf bank_mask:0xf
    v_add_f32_dpp v217, v217, v217 row_ror:1 row_mask:0xf bank_mask:0xf
    v_mov_b64 v[218:219], v[216:217]
    s_nop 1
    v_permlane16_swap_b32 v216, v218
    v_permlane16_swap_b32 v217, v219
    v_add_f32 v200, v216, v218
    v_add_f32 v202, v217, v219
    v_mul_f32 v200, 986500301, v200
    v_mul_f32 v202, 986500301, v202
    v_fma_f32 v202, -v200, v200, v202
    v_max_f32 v202, 0, v202
    v_cvt_pk_bf16_f32 v202, v202, v202
    v_and_b32 v202, 0xffff0000, v202
    v_add_f32 v202, 925353388, v202
    v_cvt_pk_bf16_f32 v202, v202, v202
    v_and_b32 v202, 0xffff0000, v202
    v_sqrt_f32 v202, v202
    s_nop 0
    v_cvt_pk_bf16_f32 v204, -v200, v202
    v_lshlrev_b32 v206, 3, v210
    s_lshl_b32 s41, s40, 3
    s_add_u32 s41, s41, 49152
    s_waitcnt lgkmcnt(0)
    s_add_u32 s26, s26, 1
    s_mul_i32 s26, s26, 2654435761
    v_mov_b32 v205, s26
    s_mov_b32 exec_lo, 1
    s_mov_b32 exec_hi, 1
    buffer_store_dwordx2 v[204:205], v206, s[12:15], s41 offen sc1
    s_mov_b64 exec, -1
    s_cmp_lg_u32 s3, 0
    s_cbranch_scc1 nohello_18
    s_add_u32 s41, s26, s28
    v_mov_b32 v207, s41
    s_lshl_b32 s41, s24, 7
    s_lshl_b32 s42, s25, 2
    s_add_u32 s41, s41, s42
    s_add_u32 s41, s41, 1024
    s_mov_b64 exec, 1
    buffer_store_dword v207, off, s[12:15], s41 sc1
    s_mov_b64 exec, -1
nohello_18:
    s_branch L_sp_u
L_sp_t:
    s_waitcnt lgkmcnt(0)
    s_add_u32 s26, s26, 1
    s_mul_i32 s26, s26, 2654435761
L_sp_u:
    s_lshl_b32 s45, s3, 4
    s_add_u32 s43, s46, s45
    s_cmp_lt_u32 s43, 32
    s_cselect_b32 s45, 0, 536
    s_add_u32 s43, s43, s45
    s_add_u32 s43, s43, 216
    s_cmp_ge_u32 s3, 3
    s_cbranch_scc1 L_sp_1
    s_barrier
    s_mov_b32 s29, s44
    s_add_u32 s47, s62, 0
    s_call_b64 s[0:1], L_rissue
    s_add_u32 s29, s43, 128
    s_add_u32 s47, s62, 10240
    s_call_b64 s[0:1], L_rissue
    s_mov_b32 s29, s44
    s_add_u32 s47, s62, 0
    s_waitcnt vmcnt(8)
    s_call_b64 s[0:1], L_rfinish
    s_mov_b32 s60, s29
    s_add_u32 s29, s43, 128
    s_add_u32 s47, s62, 10240
    s_waitcnt vmcnt(9)
    s_call_b64 s[0:1], L_rfinish
    s_mov_b32 s61, s29
    v_mov_b32 v27, s26
    s_waitcnt vmcnt(0)
    s_mov_b64 exec, 1
    buffer_store_dword v27, off, s[12:15], s60 sc1
    s_mov_b64 exec, -1
    v_mov_b32 v27, s26
    s_waitcnt vmcnt(0)
    s_mov_b64 exec, 1
    buffer_store_dword v27, off, s[12:15], s61 sc1
    s_mov_b64 exec, -1
    s_branch L_sp_d
L_sp_1:
    s_mov_b32 s29, s44
    s_add_u32 s47, s62, 0
    s_waitcnt vmcnt(0)
    s_call_b64 s[0:1], L_rfinish
    s_mov_b32 s60, s29
    s_barrier
    v_mov_b32 v27, s26
    s_waitcnt vmcnt(0)
    s_mov_b64 exec, 1
    buffer_store_dword v27, off, s[12:15], s60 sc1
    s_mov_b64 exec, -1
    s_cmp_ge_u32 s43, 808
    s_cbranch_scc1 L_sp_d
    s_add_u32 s29, s43, 128
    s_add_u32 s47, s62, 10240
    s_call_b64 s[0:1], L_rissue
    s_add_u32 s29, s43, 128
    s_add_u32 s47, s62, 10240
    s_waitcnt vmcnt(0)
    s_call_b64 s[0:1], L_rfinish
    s_mov_b32 s61, s29
    v_mov_b32 v27, s26
    s_waitcnt vmcnt(0)
    s_mov_b64 exec, 1
    buffer_store_dword v27, off, s[12:15], s61 sc1
    s_mov_b64 exec, -1
L_sp_d:
    v_and_b32 v20, 31, v2
    v_lshlrev_b32 v20, 2, v20
    s_lshl_b32 s40, s24, 7
    s_add_u32 s40, s40, 1024
    s_mov_b32 s41, 30000
ml_19:
    buffer_load_dword v21, v20, s[12:15], s40 offen sc1
mc_20:
    s_waitcnt vmcnt(0)
    v_subrev_u32 v21, s26, v21
    v_cmp_lt_u32 vcc, 15, v21
    s_nop 0
    s_cmp_eq_u64 vcc, 0
    s_cbranch_scc1 md_21
    s_sleep 1
    s_sub_u32 s41, s41, 1
    s_cbranch_scc0 ml_19
md_21:
    v_cmp_ne_u32 vcc, s28, v21
    s_nop 0
    s_cmp_lg_u64 vcc, 0
    s_cselect_b32 s27, 1, 0
    v_mov_b32 v23, 0
    v_mov_b32 v20, 160768
    ds_write_b32 v20, v23 offset:4
    ds_write_b32 v20, v23 offset:8
    v_mov_b32 v22, 0
    v_mov_b32 v23, v22
    ds_write2_b64 v20, v[22:23], v[22:23] offset0:2 offset1:3
    s_waitcnt lgkmcnt(0)
    s_barrier
L_j1:
    s_cmp_ge_u32 s3, 4
    s_cbranch_scc1 L_a_nres
    s_call_b64 s[0:1], L_pref_c
L_a_nres:
    s_sub_u32 s40, 7, s3
    s_sub_u32 s59, s3, 4
    s_cmp_lt_u32 s3, 4
    s_cselect_b32 s40, s40, s59
    s_and_b32 s59, s3, 3
    s_sub_u32 s63, s3, 0
    s_cmp_lt_u32 s63, 4
    s_cselect_b32 s63, 2, 8
    v_mov_b32 v6, s59
    s_and_b32 s59, s25, 1
    s_lshl_b32 s41, s59, 3
    s_lshr_b32 s60, s25, 1
    s_mul_i32 s60, s60, 5
    s_mul_i32 s61, s59, 3
    s_add_u32 s61, s61, s60
    s_add_u32 s62, s60, 2
    s_lshl_b32 s59, s59, 1
    s_add_u32 s42, s60, s59
    s_lshl_b32 s61, s61, 10
    s_lshl_b32 s62, s62, 10
    v_min_u32 v3, s63, v2
    s_lshr_b32 s63, s40, 1
    v_mov_b32 v7, s63
    v_mul_u32_u24 v4, 86, v3
    v_lshrrev_b32 v4, 8, v4
    v_mul_u32_u24 v5, 77, v4
    v_add3_u32 v5, v5, v3, s42
    v_lshrrev_b32 v5, 3, v5
    v_cmp_eq_u32 vcc, 0, v4
    s_nop 1
    v_cndmask_b32 v6, v6, v7, vcc
    v_lshl_add_u32 v5, v5, 2, v6
    v_lshlrev_b32 v224, 2, v5
    s_cmp_lg_u32 s3, 4
    s_mov_b32 s45, 0
    v_mov_b32 v30, 0
    s_cbranch_scc1 L_a_nm
    v_and_b32 v3, 31, v2
    v_min_u32 v4, 23, v3
    v_mul_u32_u24 v5, 43, v4
    v_lshrrev_b32 v5, 8, v5
    v_mul_u32_u24 v6, 6, v5
    v_sub_u32 v4, v4, v6
    v_mul_u32_u24 v6, 86, v4
    v_lshrrev_b32 v6, 8, v6
    v_mul_u32_u24 v6, 77, v6
    v_add3_u32 v4, v4, v6, s42
    v_add_u32 v4, 80, v4
    v_bfe_u32 v6, v4, 3, 1
    v_lshrrev_b32 v4, 4, v4
    v_lshrrev_b32 v7, 1, v5
    v_lshl_add_u32 v4, v4, 1, v7
    v_and_b32 v5, 1, v5
    v_lshl_add_u32 v5, v5, 1, v6
    v_lshlrev_b32 v5, 2, v5
    v_lshl_add_u32 v4, v4, 7, v5
    s_lshl_b32 s63, s24, 12
    s_add_u32 s63, s63, 77824
    v_add_u32 v4, s63, v4
    v_min_u32 v3, 19, v3
    s_lshr_b32 s63, s25, 1
    s_lshl_b32 s63, s63, 8
    s_add_u32 s63, s63, 69632
    v_lshl_add_u32 v30, v3, 2, s63
    s_cmp_eq_u32 s24, 0
    s_cselect_b32 vcc_lo, 0, -1
    s_mov_b32 vcc_hi, 0
    v_cndmask_b32 v30, v30, v4, vcc
L_a_nm:
    v_and_b32 v4, 31, v2
    v_lshrrev_b32 v5, 5, v2
    v_lshlrev_b32 v3, 4, v2
    v_xor_b32 v31, 512, v3
    v_lshlrev_b32 v6, 4, v4
    v_lshl_add_u32 v7, v5, 10, v6
    s_and_b32 s59, s3, 3
    s_lshl_b32 s60, s24, 2
    s_add_u32 s63, s60, s59
    s_mul_i32 s63, s63, 655360
    s_add_u32 s63, s63, 1130496
    s_add_u32 s38, s63, s61
    s_add_u32 s39, s63, s62
    s_lshl_b32 s59, s59, 10
    s_sub_u32 s8, 3072, s59
    s_lshr_b32 s59, s40, 1
    s_add_u32 s60, s60, s59
    s_and_b32 s59, s40, 1
    s_lshl_b32 s59, s59, 9
    s_mul_i32 s63, s60, 655360
    s_add_u32 s63, s63, s59
    s_add_u32 s63, s63, 1048576
    s_add_u32 s11, s63, s61
    s_add_u32 s63, s63, s62
    s_add_u32 s63, s63, s41
    s_mul_i32 s44, s60, 655360
    s_add_u32 s44, s44, s59
    s_add_u32 s44, s44, 1048576
    s_lshr_b32 s46, s25, 2
    s_mul_i32 s46, s46, 102400
    s_add_u32 s9, s46, 28311552
    s_lshr_b32 s54, s25, 1
    s_mul_i32 s54, s54, 286720
    s_and_b32 s46, s3, 3
    s_lshl_b32 s46, s46, 10
    s_add_u32 s54, s54, s46
    s_lshr_b32 s46, s3, 2
    s_mul_i32 s46, s46, 57344
    s_add_u32 s54, s54, s46
    s_add_u32 s54, s54, 32505856
    v_add_u32 v0, 4096, v3
    s_cmp_ge_u32 s25, 30
    s_cselect_b32 s46, 4, s3
    s_cmp_lt_u32 s46, 4
    s_cbranch_scc1 L_a_pub
    s_cmp_lg_u32 s46, 6
    s_cbranch_scc1 a_np_22
    v_mov_b32 v226, s26
    s_waitcnt vmcnt(0)
    s_mov_b64 exec, 1
    buffer_store_dword v226, off, s[12:15], s29 sc1
    s_mov_b64 exec, -1
    s_branch a_np_22
L_a_pub:
    v_mov_b32 v226, s26
    s_lshl_b32 s56, s24, 5
    s_add_u32 s56, s56, s25
    s_lshl_b32 s56, s56, 5
    s_add_u32 s56, s56, s3
    s_lshl_b32 s56, s56, 2
    s_add_u32 s56, s56, 81920
    s_cmp_eq_u32 s27, 0
    s_waitcnt vmcnt(3)
    s_mov_b64 exec, 1
    s_cbranch_scc1 L_a_pf
    buffer_store_dword v226, off, s[12:15], s55 sc1
    s_branch L_a_pd
L_a_pf:
    buffer_store_dword v226, off, s[12:15], s55
L_a_pd:
    s_cmp_lt_u32 s25, 10
    s_cbranch_scc1 L_a_pe
    buffer_store_dword v226, off, s[12:15], s56 sc1
L_a_pe:
    s_mov_b64 exec, -1
a_np_22:
    v_mov_b32 v228, 0x3f803f80
    v_mov_b32 v229, 0x3f803f80
    v_mov_b32 v230, 0x3f803f80
    v_mov_b32 v231, 0x3f803f80
    s_lshl_b32 s59, s3, 10
    s_min_u32 s59, s59, 4096
    v_add_u32 v19, s59, v3
    s_sub_u32 s60, 7, s40
    s_lshl_b32 s60, s60, 9
    v_mul_u32_u24 v14, 8256, v5
    v_add3_u32 v14, v14, v6, s60
    s_add_u32 s59, s41, 16512
    s_add_u32 s59, s59, s60
    v_mov_b32 v15, s59
    v_mov_b32 v26, 49536
    s_mov_b32 s42, 0
    s_mov_b32 s43, -1
    v_cndmask_b32_e64 v15, v15, v26, s[42:43]
    v_add_u32 v15, v15, v6
    v_bfe_u32 v23, v2, 2, 2
    v_lshl_add_u32 v23, v5, 2, v23
    v_lshlrev_b32 v23, 4, v23
    v_and_b32 v24, 1, v2
    v_mul_u32_u24 v24, 8256, v24
    v_bfe_u32 v25, v2, 1, 1
    v_lshl_add_u32 v24, v25, 3, v24
    s_add_u32 s59, s60, 24768
    v_add_u32 v24, s59, v24
    s_add_u32 s59, s41, 41280
    s_add_u32 s59, s59, s60
    v_mov_b32 v22, s59
    v_and_b32 v25, 16, v2
    v_cmp_eq_u32 vcc, 0, v25
    v_and_b32 v25, 19, v2
    s_nop 0
    v_cndmask_b32 v22, v22, v24, vcc
    v_cmp_lt_u32 vcc, 16, v25
    s_nop 1
    v_cndmask_b32 v26, v22, v26, vcc
    v_add_u32 v26, v26, v23
    v_lshlrev_b32 v24, 2, v5
    v_sub_u32 v24, v4, v24
    v_mov_b32 v25, 4048155338
    v_cmp_le_i32 s[46:47], 0, v24
    v_cmp_le_i32 s[48:49], 1, v24
    v_cmp_le_i32 s[50:51], 2, v24
    v_cmp_le_i32 s[52:53], 3, v24
    v_cndmask_b32_e64 v32, v25, 0, s[46:47]
    v_cndmask_b32_e64 v33, v25, 0, s[48:49]
    v_cndmask_b32_e64 v34, v25, 0, s[50:51]
    v_cndmask_b32_e64 v35, v25, 0, s[52:53]
    v_cndmask_b32_e64 v64, 0, v25, s[46:47]
    v_cndmask_b32_e64 v65, 0, v25, s[48:49]
    v_cndmask_b32_e64 v66, 0, v25, s[50:51]
    v_cndmask_b32_e64 v67, 0, v25, s[52:53]
    v_cmp_le_i32 s[46:47], 8, v24
    v_cmp_le_i32 s[48:49], 9, v24
    v_cmp_le_i32 s[50:51], 10, v24
    v_cmp_le_i32 s[52:53], 11, v24
    v_cndmask_b32_e64 v36, v25, 0, s[46:47]
    v_cndmask_b32_e64 v37, v25, 0, s[48:49]
    v_cndmask_b32_e64 v38, v25, 0, s[50:51]
    v_cndmask_b32_e64 v39, v25, 0, s[52:53]
    v_cndmask_b32_e64 v68, 0, v25, s[46:47]
    v_cndmask_b32_e64 v69, 0, v25, s[48:49]
    v_cndmask_b32_e64 v70, 0, v25, s[50:51]
    v_cndmask_b32_e64 v71, 0, v25, s[52:53]
    v_cmp_le_i32 s[46:47], 16, v24
    v_cmp_le_i32 s[48:49], 17, v24
    v_cmp_le_i32 s[50:51], 18, v24
    v_cmp_le_i32 s[52:53], 19, v24
    v_cndmask_b32_e64 v40, v25, 0, s[46:47]
    v_cndmask_b32_e64 v41, v25, 0, s[48:49]
    v_cndmask_b32_e64 v42, v25, 0, s[50:51]
    v_cndmask_b32_e64 v43, v25, 0, s[52:53]
    v_cndmask_b32_e64 v72, 0, v25, s[46:47]
    v_cndmask_b32_e64 v73, 0, v25, s[48:49]
    v_cndmask_b32_e64 v74, 0, v25, s[50:51]
    v_cndmask_b32_e64 v75, 0, v25, s[52:53]
    v_cmp_le_i32 s[46:47], 24, v24
    v_cmp_le_i32 s[48:49], 25, v24
    v_cmp_le_i32 s[50:51], 26, v24
    v_cmp_le_i32 s[52:53], 27, v24
    v_cndmask_b32_e64 v44, v25, 0, s[46:47]
    v_cndmask_b32_e64 v45, v25, 0, s[48:49]
    v_cndmask_b32_e64 v46, v25, 0, s[50:51]
    v_cndmask_b32_e64 v47, v25, 0, s[52:53]
    v_cndmask_b32_e64 v76, 0, v25, s[46:47]
    v_cndmask_b32_e64 v77, 0, v25, s[48:49]
    v_cndmask_b32_e64 v78, 0, v25, s[50:51]
    v_cndmask_b32_e64 v79, 0, v25, s[52:53]
    v_mov_b64 v[184:185], 0
    v_mov_b64 v[186:187], 0
    v_mov_b64 v[188:189], 0
    v_mov_b64 v[190:191], 0
    v_mov_b64 v[192:193], 0
    v_mov_b64 v[194:195], 0
    v_mov_b64 v[196:197], 0
    v_mov_b64 v[198:199], 0
    v_mov_b32 v27, 0
    v_mov_b32 v20, 160768
    v_mov_b32 v227, 0
    s_lshl_b32 s46, s24, 9
    s_add_u32 s46, s46, 2048
    s_cmp_lg_u32 s3, 7
    s_cbranch_scc1 L_a_nw
    v_min_u32 v227, 19, v2
    v_lshlrev_b32 v227, 2, v227
    s_lshr_b32 s48, s25, 3
    s_lshl_b32 s48, s48, 7
    s_add_u32 s48, s48, 40960
    s_mov_b32 s47, 30000
pl_23:
    buffer_load_dword v236, v227, s[12:15], s48 offen sc1
    s_waitcnt vmcnt(0)
pc_24:
    v_cmp_ne_u32 vcc, s26, v236
    s_nop 0
    s_cmp_eq_u64 vcc, 0
    s_cbranch_scc1 pdn_25
    s_sleep 1
    s_sub_u32 s47, s47, 1
    s_cbranch_scc0 pl_23
pdn_25:
L_a_nw:
    s_mov_b32 s47, 30000
pl_26:
    buffer_load_dword v226, v224, s[12:15], s46 offen sc1
    s_waitcnt vmcnt(0)
pc_27:
    v_cmp_ne_u32 vcc, s26, v226
    s_nop 0
    s_cmp_eq_u64 vcc, 0
    s_cbranch_scc1 pdn_28
    s_sleep 1
    s_sub_u32 s47, s47, 1
    s_cbranch_scc0 pl_26
pdn_28:
    buffer_load_dwordx4 v[8:11], v7, s[12:15], s11 offen sc1
    buffer_load_dwordx2 v[12:13], v6, s[12:15], s63 offen sc1
    ds_write_b128 v19, v[228:231] offset:49536
    s_mov_b32 s11, 0
    s_sub_u32 s48, s3, 0
    s_cmp_lt_u32 s48, 4
    s_cbranch_scc1 L_a_c
    s_add_u32 m0, s8, 0
    s_nop 0
    buffer_load_dwordx4 v31, s[12:15], s38 offen sc1 lds
    s_add_u32 m0, s8, 7232
    s_nop 0
    buffer_load_dwordx4 v31, s[12:15], s38 offen offset:1024 sc1 lds
    s_add_u32 m0, s8, 16512
    s_nop 0
    buffer_load_dwordx4 v31, s[12:15], s39 offen sc1 lds
    s_add_u32 s38, s38, 81920
    s_add_u32 s39, s39, 81920
    s_add_u32 m0, s8, 24768
    s_nop 0
    buffer_load_dwordx4 v31, s[12:15], s38 offen sc1 lds
    s_add_u32 m0, s8, 32000
    s_nop 0
    buffer_load_dwordx4 v31, s[12:15], s38 offen offset:1024 sc1 lds
    s_add_u32 m0, s8, 41280
    s_nop 0
    buffer_load_dwordx4 v31, s[12:15], s39 offen sc1 lds
    s_setprio 1
    s_cmp_eq_u32 s3, 4
    s_cselect_b32 s11, s24, 0
    s_cbranch_scc0 L_a_n5
    buffer_load_dword v29, v30, s[12:15], s45 offen sc1
    s_waitcnt vmcnt(0)
    v_cmp_ne_u32 vcc, s26, v29
    s_nop 0
    s_cmp_eq_u64 vcc, 0
    s_cselect_b32 s48, s11, 0
    s_cmp_eq_u32 s48, 0
    s_cbranch_scc1 L_a_n5
    s_mov_b32 s45, 1
    s_mul_i32 s63, s24, 2621440
    s_add_u32 s63, s63, -1490944
    s_add_u32 s56, s63, s61
    s_add_u32 s57, s63, s62
    s_add_u32 s63, s56, 1966080
    s_mov_b32 m0, 4096
    s_add_u32 s60, s57, 1966080
    buffer_load_dwordx4 v31, s[12:15], s63 offen sc1 lds
    s_mov_b32 m0, 11328
    s_nop 0
    buffer_load_dwordx4 v31, s[12:15], s63 offen offset:1024 sc1 lds
    s_mov_b32 m0, 20608
    s_nop 0
    buffer_load_dwordx4 v31, s[12:15], s60 offen sc1 lds
    s_add_u32 s63, s56, 2048000
    s_mov_b32 m0, 28864
    s_add_u32 s60, s57, 2048000
    buffer_load_dwordx4 v31, s[12:15], s63 offen sc1 lds
    s_mov_b32 m0, 36096
    s_nop 0
    buffer_load_dwordx4 v31, s[12:15], s63 offen offset:1024 sc1 lds
    s_mov_b32 m0, 45376
    s_nop 0
    buffer_load_dwordx4 v31, s[12:15], s60 offen sc1 lds
    s_add_u32 s63, s56, 1310720
    s_mov_b32 m0, 5120
    s_add_u32 s60, s57, 1310720
    buffer_load_dwordx4 v31, s[12:15], s63 offen sc1 lds
    s_mov_b32 m0, 12352
    s_nop 0
    buffer_load_dwordx4 v31, s[12:15], s63 offen offset:1024 sc1 lds
    s_mov_b32 m0, 21632
    s_nop 0
    buffer_load_dwordx4 v31, s[12:15], s60 offen sc1 lds
    s_add_u32 s63, s56, 1392640
    s_mov_b32 m0, 29888
    s_add_u32 s60, s57, 1392640
    buffer_load_dwordx4 v31, s[12:15], s63 offen sc1 lds
    s_mov_b32 m0, 37120
    s_nop 0
    buffer_load_dwordx4 v31, s[12:15], s63 offen offset:1024 sc1 lds
    s_mov_b32 m0, 46400
    s_nop 0
    buffer_load_dwordx4 v31, s[12:15], s60 offen sc1 lds
    s_add_u32 s63, s56, 655360
    s_mov_b32 m0, 6144
    s_add_u32 s60, s57, 655360
    buffer_load_dwordx4 v31, s[12:15], s63 offen sc1 lds
    s_mov_b32 m0, 13376
    s_nop 0
    buffer_load_dwordx4 v31, s[12:15], s63 offen offset:1024 sc1 lds
    s_mov_b32 m0, 22656
    s_nop 0
    buffer_load_dwordx4 v31, s[12:15], s60 offen sc1 lds
    s_add_u32 s63, s56, 737280
    s_mov_b32 m0, 30912
    s_add_u32 s60, s57, 737280
    buffer_load_dwordx4 v31, s[12:15], s63 offen sc1 lds
    s_mov_b32 m0, 38144
    s_nop 0
    buffer_load_dwordx4 v31, s[12:15], s63 offen offset:1024 sc1 lds
    s_mov_b32 m0, 47424
    s_nop 0
    buffer_load_dwordx4 v31, s[12:15], s60 offen sc1 lds
    s_add_u32 s63, s56, 0
    s_mov_b32 m0, 7168
    s_add_u32 s60, s57, 0
    buffer_load_dwordx4 v31, s[12:15], s63 offen sc1 lds
    s_mov_b32 m0, 14400
    s_nop 0
    buffer_load_dwordx4 v31, s[12:15], s63 offen offset:1024 sc1 lds
    s_mov_b32 m0, 23680
    s_nop 0
    buffer_load_dwordx4 v31, s[12:15], s60 offen sc1 lds
    s_add_u32 s63, s56, 81920
    s_mov_b32 m0, 31936
    s_add_u32 s60, s57, 81920
    buffer_load_dwordx4 v31, s[12:15], s63 offen sc1 lds
    s_mov_b32 m0, 39168
    s_nop 0
    buffer_load_dwordx4 v31, s[12:15], s63 offen offset:1024 sc1 lds
    s_mov_b32 m0, 48448
    s_nop 0
    buffer_load_dwordx4 v31, s[12:15], s60 offen sc1 lds
    s_branch L_a_n6
L_a_c:
L_a_n5:
    s_waitcnt vmcnt(0)
L_a_n6:
    v_cndmask_b32_e64 v12, v12, 0, s[42:43]
    v_cndmask_b32_e64 v13, v13, 0, s[42:43]
    s_waitcnt lgkmcnt(0)
    s_barrier
    s_cmp_lg_u32 s3, 4
    s_cbranch_scc1 a_nh_29
    s_cmp_lg_u32 s45, 0
    s_cbranch_scc1 L_a_hd
    s_mov_b32 s63, 30000
    s_waitcnt vmcnt(0)
    s_branch pc_31
pl_30:
    buffer_load_dword v29, v30, s[12:15], s45 offen sc1
    s_waitcnt vmcnt(0)
pc_31:
    v_cmp_ne_u32 vcc, s26, v29
    s_nop 0
    s_cmp_eq_u64 vcc, 0
    s_cbranch_scc1 pdn_32
    s_sleep 1
    s_sub_u32 s63, s63, 1
    s_cbranch_scc0 pl_30
pdn_32:
    s_cmp_eq_u32 s11, 0
    s_cbranch_scc1 L_a_hd
    s_mul_i32 s63, s24, 2621440
    s_add_u32 s63, s63, -1490944
    s_add_u32 s56, s63, s61
    s_add_u32 s57, s63, s62
    s_add_u32 s63, s56, 1966080
    s_mov_b32 m0, 4096
    s_add_u32 s60, s57, 1966080
    buffer_load_dwordx4 v31, s[12:15], s63 offen sc1 lds
    s_mov_b32 m0, 11328
    s_nop 0
    buffer_load_dwordx4 v31, s[12:15], s63 offen offset:1024 sc1 lds
    s_mov_b32 m0, 20608
    s_nop 0
    buffer_load_dwordx4 v31, s[12:15], s60 offen sc1 lds
    s_add_u32 s63, s56, 2048000
    s_mov_b32 m0, 28864
    s_add_u32 s60, s57, 2048000
    buffer_load_dwordx4 v31, s[12:15], s63 offen sc1 lds
    s_mov_b32 m0, 36096
    s_nop 0
    buffer_load_dwordx4 v31, s[12:15], s63 offen offset:1024 sc1 lds
    s_mov_b32 m0, 45376
    s_nop 0
    buffer_load_dwordx4 v31, s[12:15], s60 offen sc1 lds
    s_add_u32 s63, s56, 1310720
    s_mov_b32 m0, 5120
    s_add_u32 s60, s57, 1310720
    buffer_load_dwordx4 v31, s[12:15], s63 offen sc1 lds
    s_mov_b32 m0, 12352
    s_nop 0
    buffer_load_dwordx4 v31, s[12:15], s63 offen offset:1024 sc1 lds
    s_mov_b32 m0, 21632
    s_nop 0
    buffer_load_dwordx4 v31, s[12:15], s60 offen sc1 lds
    s_add_u32 s63, s56, 1392640
    s_mov_b32 m0, 29888
    s_add_u32 s60, s57, 1392640
    buffer_load_dwordx4 v31, s[12:15], s63 offen sc1 lds
    s_mov_b32 m0, 37120
    s_nop 0
    buffer_load_dwordx4 v31, s[12:15], s63 offen offset:1024 sc1 lds
    s_mov_b32 m0, 46400
    s_nop 0
    buffer_load_dwordx4 v31, s[12:15], s60 offen sc1 lds
    s_add_u32 s63, s56, 655360
    s_mov_b32 m0, 6144
    s_add_u32 s60, s57, 655360
    buffer_load_dwordx4 v31, s[12:15], s63 offen sc1 lds
    s_mov_b32 m0, 13376
    s_nop 0
    buffer_load_dwordx4 v31, s[12:15], s63 offen offset:1024 sc1 lds
    s_mov_b32 m0, 22656
    s_nop 0
    buffer_load_dwordx4 v31, s[12:15], s60 offen sc1 lds
    s_add_u32 s63, s56, 737280
    s_mov_b32 m0, 30912
    s_add_u32 s60, s57, 737280
    buffer_load_dwordx4 v31, s[12:15], s63 offen sc1 lds
    s_mov_b32 m0, 38144
    s_nop 0
    buffer_load_dwordx4 v31, s[12:15], s63 offen offset:1024 sc1 lds
    s_mov_b32 m0, 47424
    s_nop 0
    buffer_load_dwordx4 v31, s[12:15], s60 offen sc1 lds
    s_add_u32 s63, s56, 0
    s_mov_b32 m0, 7168
    s_add_u32 s60, s57, 0
    buffer_load_dwordx4 v31, s[12:15], s63 offen sc1 lds
    s_mov_b32 m0, 14400
    s_nop 0
    buffer_load_dwordx4 v31, s[12:15], s63 offen offset:1024 sc1 lds
    s_mov_b32 m0, 23680
    s_nop 0
    buffer_load_dwordx4 v31, s[12:15], s60 offen sc1 lds
    s_add_u32 s63, s56, 81920
    s_mov_b32 m0, 31936
    s_add_u32 s60, s57, 81920
    buffer_load_dwordx4 v31, s[12:15], s63 offen sc1 lds
    s_mov_b32 m0, 39168
    s_nop 0
    buffer_load_dwordx4 v31, s[12:15], s63 offen offset:1024 sc1 lds
    s_mov_b32 m0, 48448
    s_nop 0
    buffer_load_dwordx4 v31, s[12:15], s60 offen sc1 lds
L_a_hd:
    s_add_u32 s55, s54, 0
    buffer_load_dwordx4 v[200:203], v3, s[12:15], s55 offen sc1
    buffer_load_dwordx4 v[204:207], v0, s[12:15], s55 offen sc1
    s_add_u32 s55, s54, 8192
    buffer_load_dwordx4 v[208:211], v3, s[12:15], s55 offen sc1
    buffer_load_dwordx4 v[212:215], v0, s[12:15], s55 offen sc1
    v_mov_b32 v16, 160768
    v_mov_b32 v17, 1
    ds_write_b32 v16, v17 offset:8
a_nh_29:
    s_mov_b32 s29, 9999
    ds_read_b128 v[80:83], v14 offset:0
    ds_read_b64 v[84:85], v15 offset:0
    ds_read_b64_tr_b16 v[160:161], v26 offset:0
    ds_read_b64_tr_b16 v[162:163], v26 offset:128
    ds_read_b64_tr_b16 v[164:165], v26 offset:256
    ds_read_b64_tr_b16 v[166:167], v26 offset:384
    ds_read_b128 v[86:89], v14 offset:512
    ds_read_b64 v[90:91], v15 offset:512
    s_waitcnt lgkmcnt(6)
    v_mfma_f32_32x32x16_bf16 v[128:143], v[80:83], v[8:11], v[32:47]
    v_mfma_f32_32x32x8_bf16 v[128:143], v[84:85], v[12:13], v[128:143]
    s_mul_i32 s48, s3, 0
    s_mul_i32 s49, s3, 18432
    s_add_u32 s49, s49, 4294893568
    s_cmp_lt_u32 s3, 4
    s_cselect_b32 s48, s48, s49
    s_mov_b32 s8, 75776
    s_cselect_b32 s8, 57344, s8
    s_add_u32 s8, s8, s48
    s_add_u32 s9, s9, s48
    s_add_u32 s10, s48, 57344
    s_nop 1
    v_max3_f32 v28, v128, v129, v130
    v_max3_f32 v29, v131, v132, v133
    v_max3_f32 v28, v134, v135, v28
    v_max3_f32 v29, v136, v137, v29
    v_max3_f32 v28, v138, v139, v28
    v_max3_f32 v29, v140, v141, v29
    v_max3_f32 v28, v142, v143, v28
    v_max_f32 v28, v28, v29
    v_mov_b32 v29, v28
    s_nop 1
    v_permlane32_swap_b32 v28, v29
    v_max_f32 v28, v28, v29
    v_sub_f32 v28, v27, v28
    v_cvt_pk_bf16_f32 v16, v28, v28
    v_and_b32 v17, 0xffff0000, v16
    v_sub_f32 v28, v28, v17
    v_cvt_pk_bf16_f32 v16, v17, v28
    v_and_b32 v28, 0xffff0000, v16
    v_add_f32 v17, v17, v28
    v_sub_f32 v18, v17, v27
    v_sub_f32 v19, v17, v27
    v_cndmask_b32_e64 v12, v12, v16, s[42:43]
    v_mov_b32 v27, v17
    v_pk_add_f32 v[128:129], v[128:129], v[18:19]
    v_pk_add_f32 v[130:131], v[130:131], v[18:19]
    v_pk_add_f32 v[132:133], v[132:133], v[18:19]
    v_pk_add_f32 v[134:135], v[134:135], v[18:19]
    v_pk_add_f32 v[136:137], v[136:137], v[18:19]
    v_pk_add_f32 v[138:139], v[138:139], v[18:19]
    v_pk_add_f32 v[140:141], v[140:141], v[18:19]
    v_pk_add_f32 v[142:143], v[142:143], v[18:19]
    s_cmp_eq_u32 s24, 0
    s_cselect_b32 s48, 4, s3
    s_cmp_ge_u32 s48, 4
    s_cbranch_scc1 L_walk_l
    v_exp_f32 v128, v128
    v_exp_f32 v129, v129
    v_exp_f32 v130, v130
    v_exp_f32 v131, v131
    v_cvt_pk_bf16_f32 v176, v128, v129
    v_exp_f32 v132, v132
    v_cvt_pk_bf16_f32 v177, v130, v131
    v_exp_f32 v133, v133
    s_waitcnt lgkmcnt(0)
    v_mfma_f32_32x32x16_bf16 v[144:159], v[86:89], v[8:11], 0
    ds_read_b64_tr_b16 v[168:169], v26 offset:512
    ds_read_b64_tr_b16 v[170:171], v26 offset:640
    v_exp_f32 v134, v134
    v_exp_f32 v135, v135
    v_cvt_pk_bf16_f32 v178, v132, v133
    v_exp_f32 v136, v136
    v_cvt_pk_bf16_f32 v179, v134, v135
    v_mfma_f32_32x32x8_bf16 v[144:159], v[90:91], v[12:13], v[144:159]
    ds_read_b64_tr_b16 v[172:173], v26 offset:768
    ds_read_b64_tr_b16 v[174:175], v26 offset:896
    v_exp_f32 v137, v137
    v_exp_f32 v138, v138
    v_exp_f32 v139, v139
    v_mfma_f32_32x32x16_bf16 v[184:199], v[160:163], v[176:179], v[184:199]
    v_cvt_pk_bf16_f32 v180, v136, v137
    v_exp_f32 v140, v140
    v_cvt_pk_bf16_f32 v181, v138, v139
    v_exp_f32 v141, v141
    v_exp_f32 v142, v142
    v_exp_f32 v143, v143
    v_max3_f32 v28, v144, v145, v146
    v_cvt_pk_bf16_f32 v182, v140, v141
    v_max3_f32 v29, v147, v148, v149
    v_cvt_pk_bf16_f32 v183, v142, v143
    ds_read_b128 v[80:83], v14 offset:1024
    ds_read_b64 v[84:85], v15 offset:1024
    v_max3_f32 v28, v150, v151, v28
    v_max3_f32 v29, v152, v153, v29
    v_mfma_f32_32x32x16_bf16 v[184:199], v[164:167], v[180:183], v[184:199]
    v_max3_f32 v28, v154, v155, v28
    v_max3_f32 v29, v156, v157, v29
    v_max3_f32 v28, v158, v159, v28
    v_max_f32 v28, v28, v29
    v_cmp_lt_f32 vcc, 1090519040, v28
    s_cbranch_vccnz a_r_33
a_b_34:
    v_exp_f32 v144, v144
    v_exp_f32 v145, v145
    v_exp_f32 v146, v146
    v_exp_f32 v147, v147
    v_cvt_pk_bf16_f32 v176, v144, v145
    v_exp_f32 v148, v148
    v_cvt_pk_bf16_f32 v177, v146, v147
    v_exp_f32 v149, v149
    s_waitcnt lgkmcnt(0)
    v_mfma_f32_32x32x16_bf16 v[128:143], v[80:83], v[8:11], 0
    ds_read_b64_tr_b16 v[160:161], v26 offset:1024
    ds_read_b64_tr_b16 v[162:163], v26 offset:1152
    v_exp_f32 v150, v150
    v_exp_f32 v151, v151
    v_cvt_pk_bf16_f32 v178, v148, v149
    v_exp_f32 v152, v152
    v_cvt_pk_bf16_f32 v179, v150, v151
    v_mfma_f32_32x32x8_bf16 v[128:143], v[84:85], v[12:13], v[128:143]
    ds_read_b64_tr_b16 v[164:165], v26 offset:1280
    ds_read_b64_tr_b16 v[166:167], v26 offset:1408
    v_exp_f32 v153, v153
    v_exp_f32 v154, v154
    v_exp_f32 v155, v155
    v_mfma_f32_32x32x16_bf16 v[184:199], v[168:171], v[176:179], v[184:199]
    v_cvt_pk_bf16_f32 v180, v152, v153
    v_exp_f32 v156, v156
    v_cvt_pk_bf16_f32 v181, v154, v155
    v_exp_f32 v157, v157
    v_exp_f32 v158, v158
    v_exp_f32 v159, v159
    v_max3_f32 v28, v128, v129, v130
    v_cvt_pk_bf16_f32 v182, v156, v157
    v_max3_f32 v29, v131, v132, v133
    v_cvt_pk_bf16_f32 v183, v158, v159
    ds_read_b128 v[86:89], v14 offset:1536
    ds_read_b64 v[90:91], v15 offset:1536
    v_max3_f32 v28, v134, v135, v28
    v_max3_f32 v29, v136, v137, v29
    v_mfma_f32_32x32x16_bf16 v[184:199], v[172:175], v[180:183], v[184:199]
    v_max3_f32 v28, v138, v139, v28
    v_max3_f32 v29, v140, v141, v29
    v_max3_f32 v28, v142, v143, v28
    v_max_f32 v28, v28, v29
    v_cmp_lt_f32 vcc, 1090519040, v28
    s_cbranch_vccnz a_r_35
a_b_36:
    v_exp_f32 v128, v128
    v_exp_f32 v129, v129
    v_exp_f32 v130, v130
    v_exp_f32 v131, v131
    v_cvt_pk_bf16_f32 v176, v128, v129
    v_exp_f32 v132, v132
    v_cvt_pk_bf16_f32 v177, v130, v131
    v_exp_f32 v133, v133
    s_waitcnt lgkmcnt(0)
    v_mfma_f32_32x32x16_bf16 v[144:159], v[86:89], v[8:11], 0
    ds_read_b64_tr_b16 v[168:169], v26 offset:1536
    ds_read_b64_tr_b16 v[170:171], v26 offset:1664
    v_exp_f32 v134, v134
    v_exp_f32 v135, v135
    v_cvt_pk_bf16_f32 v178, v132, v133
    v_exp_f32 v136, v136
    v_cvt_pk_bf16_f32 v179, v134, v135
    v_mfma_f32_32x32x8_bf16 v[144:159], v[90:91], v[12:13], v[144:159]
    ds_read_b64_tr_b16 v[172:173], v26 offset:1792
    ds_read_b64_tr_b16 v[174:175], v26 offset:1920
    v_exp_f32 v137, v137
    v_exp_f32 v138, v138
    v_exp_f32 v139, v139
    v_mfma_f32_32x32x16_bf16 v[184:199], v[160:163], v[176:179], v[184:199]
    v_cvt_pk_bf16_f32 v180, v136, v137
    v_exp_f32 v140, v140
    v_cvt_pk_bf16_f32 v181, v138, v139
    v_exp_f32 v141, v141
    v_exp_f32 v142, v142
    v_exp_f32 v143, v143
    v_max3_f32 v28, v144, v145, v146
    v_cvt_pk_bf16_f32 v182, v140, v141
    v_max3_f32 v29, v147, v148, v149
    v_cvt_pk_bf16_f32 v183, v142, v143
    ds_read_b128 v[80:83], v14 offset:2048
    ds_read_b64 v[84:85], v15 offset:2048
    v_max3_f32 v28, v150, v151, v28
    v_max3_f32 v29, v152, v153, v29
    v_mfma_f32_32x32x16_bf16 v[184:199], v[164:167], v[180:183], v[184:199]
    v_max3_f32 v28, v154, v155, v28
    v_max3_f32 v29, v156, v157, v29
    v_max3_f32 v28, v158, v159, v28
    v_max_f32 v28, v28, v29
    v_cmp_lt_f32 vcc, 1090519040, v28
    s_cbranch_vccnz a_r_37
a_b_38:
    v_exp_f32 v144, v144
    v_exp_f32 v145, v145
    v_exp_f32 v146, v146
    v_exp_f32 v147, v147
    v_cvt_pk_bf16_f32 v176, v144, v145
    v_exp_f32 v148, v148
    v_cvt_pk_bf16_f32 v177, v146, v147
    v_exp_f32 v149, v149
    s_waitcnt lgkmcnt(0)
    v_mfma_f32_32x32x16_bf16 v[128:143], v[80:83], v[8:11], 0
    ds_read_b64_tr_b16 v[160:161], v26 offset:2048
    ds_read_b64_tr_b16 v[162:163], v26 offset:2176
    v_exp_f32 v150, v150
    v_exp_f32 v151, v151
    v_cvt_pk_bf16_f32 v178, v148, v149
    v_exp_f32 v152, v152
    v_cvt_pk_bf16_f32 v179, v150, v151
    v_mfma_f32_32x32x8_bf16 v[128:143], v[84:85], v[12:13], v[128:143]
    ds_read_b64_tr_b16 v[164:165], v26 offset:2304
    ds_read_b64_tr_b16 v[166:167], v26 offset:2432
    v_exp_f32 v153, v153
    v_exp_f32 v154, v154
    v_exp_f32 v155, v155
    v_mfma_f32_32x32x16_bf16 v[184:199], v[168:171], v[176:179], v[184:199]
    ds_read_b32 v17, v20 offset:4
    v_cvt_pk_bf16_f32 v180, v152, v153
    v_exp_f32 v156, v156
    v_cvt_pk_bf16_f32 v181, v154, v155
    v_exp_f32 v157, v157
    v_exp_f32 v158, v158
    v_exp_f32 v159, v159
    v_max3_f32 v28, v128, v129, v130
    v_cvt_pk_bf16_f32 v182, v156, v157
    s_waitcnt lgkmcnt(0)
    v_cmp_eq_u32 vcc, 0, v17
    v_max3_f32 v29, v131, v132, v133
    v_cvt_pk_bf16_f32 v183, v158, v159
    s_cbranch_vccnz L_trc
L_tbc:
    ds_read_b128 v[86:89], v14 offset:2560
    ds_read_b64 v[90:91], v15 offset:2560
    v_max3_f32 v28, v134, v135, v28
    v_max3_f32 v29, v136, v137, v29
    v_mfma_f32_32x32x16_bf16 v[184:199], v[172:175], v[180:183], v[184:199]
    v_max3_f32 v28, v138, v139, v28
    v_max3_f32 v29, v140, v141, v29
    v_max3_f32 v28, v142, v143, v28
    v_max_f32 v28, v28, v29
    v_cmp_lt_f32 vcc, 1090519040, v28
    s_cbranch_vccnz a_r_39
a_b_40:
    v_exp_f32 v128, v128
    v_exp_f32 v129, v129
    v_exp_f32 v130, v130
    v_exp_f32 v131, v131
    v_cvt_pk_bf16_f32 v176, v128, v129
    v_exp_f32 v132, v132
    v_cvt_pk_bf16_f32 v177, v130, v131
    v_exp_f32 v133, v133
    s_waitcnt lgkmcnt(0)
    v_mfma_f32_32x32x16_bf16 v[144:159], v[86:89], v[8:11], 0
    ds_read_b64_tr_b16 v[168:169], v26 offset:2560
    ds_read_b64_tr_b16 v[170:171], v26 offset:2688
    v_exp_f32 v134, v134
    v_exp_f32 v135, v135
    v_cvt_pk_bf16_f32 v178, v132, v133
    v_exp_f32 v136, v136
    v_cvt_pk_bf16_f32 v179, v134, v135
    v_mfma_f32_32x32x8_bf16 v[144:159], v[90:91], v[12:13], v[144:159]
    ds_read_b64_tr_b16 v[172:173], v26 offset:2816
    ds_read_b64_tr_b16 v[174:175], v26 offset:2944
    v_exp_f32 v137, v137
    v_exp_f32 v138, v138
    v_exp_f32 v139, v139
    v_mfma_f32_32x32x16_bf16 v[184:199], v[160:163], v[176:179], v[184:199]
    v_cvt_pk_bf16_f32 v180, v136, v137
    v_exp_f32 v140, v140
    v_cvt_pk_bf16_f32 v181, v138, v139
    v_exp_f32 v141, v141
    v_exp_f32 v142, v142
    v_exp_f32 v143, v143
    v_max3_f32 v28, v144, v145, v146
    v_cvt_pk_bf16_f32 v182, v140, v141
    v_max3_f32 v29, v147, v148, v149
    v_cvt_pk_bf16_f32 v183, v142, v143
    ds_read_b128 v[80:83], v14 offset:3072
    ds_read_b64 v[84:85], v15 offset:3072
    v_max3_f32 v28, v150, v151, v28
    v_max3_f32 v29, v152, v153, v29
    v_mfma_f32_32x32x16_bf16 v[184:199], v[164:167], v[180:183], v[184:199]
    v_max3_f32 v28, v154, v155, v28
    v_max3_f32 v29, v156, v157, v29
    v_max3_f32 v28, v158, v159, v28
    v_max_f32 v28, v28, v29
    v_cmp_lt_f32 vcc, 1090519040, v28
    s_cbranch_vccnz a_r_41
a_b_42:
    v_exp_f32 v144, v144
    v_exp_f32 v145, v145
    v_exp_f32 v146, v146
    v_exp_f32 v147, v147
    v_cvt_pk_bf16_f32 v176, v144, v145
    v_exp_f32 v148, v148
    v_cvt_pk_bf16_f32 v177, v146, v147
    v_exp_f32 v149, v149
    s_waitcnt lgkmcnt(0)
    v_mfma_f32_32x32x16_bf16 v[128:143], v[80:83], v[8:11], 0
    ds_read_b64_tr_b16 v[160:161], v26 offset:3072
    ds_read_b64_tr_b16 v[162:163], v26 offset:3200
    v_exp_f32 v150, v150
    v_exp_f32 v151, v151
    v_cvt_pk_bf16_f32 v178, v148, v149
    v_exp_f32 v152, v152
    v_cvt_pk_bf16_f32 v179, v150, v151
    v_mfma_f32_32x32x8_bf16 v[128:143], v[84:85], v[12:13], v[128:143]
    ds_read_b64_tr_b16 v[164:165], v26 offset:3328
    ds_read_b64_tr_b16 v[166:167], v26 offset:3456
    v_exp_f32 v153, v153
    v_exp_f32 v154, v154
    v_exp_f32 v155, v155
    v_mfma_f32_32x32x16_bf16 v[184:199], v[168:171], v[176:179], v[184:199]
    v_cvt_pk_bf16_f32 v180, v152, v153
    v_exp_f32 v156, v156
    v_cvt_pk_bf16_f32 v181, v154, v155
    v_exp_f32 v157, v157
    v_exp_f32 v158, v158
    v_exp_f32 v159, v159
    v_max3_f32 v28, v128, v129, v130
    v_cvt_pk_bf16_f32 v182, v156, v157
    v_max3_f32 v29, v131, v132, v133
    v_cvt_pk_bf16_f32 v183, v158, v159
    ds_read_b128 v[86:89], v14 offset:3584
    ds_read_b64 v[90:91], v15 offset:3584
    v_max3_f32 v28, v134, v135, v28
    v_max3_f32 v29, v136, v137, v29
    v_mfma_f32_32x32x16_bf16 v[184:199], v[172:175], v[180:183], v[184:199]
    v_max3_f32 v28, v138, v139, v28
    v_max3_f32 v29, v140, v141, v29
    v_max3_f32 v28, v142, v143, v28
    v_max_f32 v28, v28, v29
    v_cmp_lt_f32 vcc, 1090519040, v28
    s_cbranch_vccnz a_r_43
a_b_44:
    v_exp_f32 v128, v128
    v_exp_f32 v129, v129
    v_exp_f32 v130, v130
    v_exp_f32 v131, v131
    v_cvt_pk_bf16_f32 v176, v128, v129
    v_exp_f32 v132, v132
    v_cvt_pk_bf16_f32 v177, v130, v131
    v_exp_f32 v133, v133
    s_waitcnt lgkmcnt(0)
    v_mfma_f32_32x32x16_bf16 v[144:159], v[86:89], v[8:11], 0
    ds_read_b64_tr_b16 v[168:169], v26 offset:3584
    ds_read_b64_tr_b16 v[170:171], v26 offset:3712
    v_exp_f32 v134, v134
    v_exp_f32 v135, v135
    v_cvt_pk_bf16_f32 v178, v132, v133
    v_exp_f32 v136, v136
    v_cvt_pk_bf16_f32 v179, v134, v135
    v_mfma_f32_32x32x8_bf16 v[144:159], v[90:91], v[12:13], v[144:159]
    ds_read_b64_tr_b16 v[172:173], v26 offset:3840
    ds_read_b64_tr_b16 v[174:175], v26 offset:3968
    v_exp_f32 v137, v137
    v_exp_f32 v138, v138
    v_exp_f32 v139, v139
    v_mfma_f32_32x32x16_bf16 v[184:199], v[160:163], v[176:179], v[184:199]
    v_cvt_pk_bf16_f32 v180, v136, v137
    v_exp_f32 v140, v140
    v_cvt_pk_bf16_f32 v181, v138, v139
    v_exp_f32 v141, v141
    v_exp_f32 v142, v142
    v_exp_f32 v143, v143
    v_max3_f32 v28, v144, v145, v146
    v_cvt_pk_bf16_f32 v182, v140, v141
    v_max3_f32 v29, v147, v148, v149
    v_cvt_pk_bf16_f32 v183, v142, v143
    ds_read_b128 v[80:83], v14 offset:4096
    ds_read_b64 v[84:85], v15 offset:4096
    v_max3_f32 v28, v150, v151, v28
    v_max3_f32 v29, v152, v153, v29
    v_mfma_f32_32x32x16_bf16 v[184:199], v[164:167], v[180:183], v[184:199]
    v_max3_f32 v28, v154, v155, v28
    v_max3_f32 v29, v156, v157, v29
    v_max3_f32 v28, v158, v159, v28
    v_max_f32 v28, v28, v29
    v_cmp_lt_f32 vcc, 1090519040, v28
    s_cbranch_vccnz a_r_45
a_b_46:
    v_exp_f32 v144, v144
    v_exp_f32 v145, v145
    v_exp_f32 v146, v146
    v_exp_f32 v147, v147
    v_cvt_pk_bf16_f32 v176, v144, v145
    v_exp_f32 v148, v148
    v_cvt_pk_bf16_f32 v177, v146, v147
    v_exp_f32 v149, v149
    s_waitcnt lgkmcnt(0)
    v_mfma_f32_32x32x16_bf16 v[128:143], v[80:83], v[8:11], v[64:79]
    ds_read_b64_tr_b16 v[160:161], v26 offset:4096
    ds_read_b64_tr_b16 v[162:163], v26 offset:4224
    v_exp_f32 v150, v150
    v_exp_f32 v151, v151
    v_cvt_pk_bf16_f32 v178, v148, v149
    v_exp_f32 v152, v152
    v_cvt_pk_bf16_f32 v179, v150, v151
    v_mfma_f32_32x32x8_bf16 v[128:143], v[84:85], v[12:13], v[128:143]
    ds_read_b64_tr_b16 v[164:165], v26 offset:4352
    ds_read_b64_tr_b16 v[166:167], v26 offset:4480
    v_exp_f32 v153, v153
    v_exp_f32 v154, v154
    v_exp_f32 v155, v155
    v_mfma_f32_32x32x16_bf16 v[184:199], v[168:171], v[176:179], v[184:199]
    v_cvt_pk_bf16_f32 v180, v152, v153
    v_exp_f32 v156, v156
    v_cvt_pk_bf16_f32 v181, v154, v155
    v_exp_f32 v157, v157
    v_exp_f32 v158, v158
    v_exp_f32 v159, v159
    v_max3_f32 v28, v128, v129, v130
    v_cvt_pk_bf16_f32 v182, v156, v157
    v_max3_f32 v29, v131, v132, v133
    v_cvt_pk_bf16_f32 v183, v158, v159
    v_max3_f32 v28, v134, v135, v28
    v_max3_f32 v29, v136, v137, v29
    v_mfma_f32_32x32x16_bf16 v[184:199], v[172:175], v[180:183], v[184:199]
    v_max3_f32 v28, v138, v139, v28
    v_max3_f32 v29, v140, v141, v29
    v_max3_f32 v28, v142, v143, v28
    v_max_f32 v28, v28, v29
    v_cmp_lt_f32 vcc, 1090519040, v28
    s_cbranch_vccnz a_r_47
a_b_48:
L_last0:
    v_exp_f32 v128, v128
    v_exp_f32 v129, v129
    v_exp_f32 v130, v130
    v_exp_f32 v131, v131
    v_cvt_pk_bf16_f32 v176, v128, v129
    v_exp_f32 v132, v132
    v_cvt_pk_bf16_f32 v177, v130, v131
    v_exp_f32 v133, v133
    v_exp_f32 v134, v134
    v_exp_f32 v135, v135
    v_cvt_pk_bf16_f32 v178, v132, v133
    v_exp_f32 v136, v136
    v_cvt_pk_bf16_f32 v179, v134, v135
    v_exp_f32 v137, v137
    s_waitcnt lgkmcnt(0)
    v_mfma_f32_32x32x16_bf16 v[184:199], v[160:163], v[176:179], v[184:199]
    v_exp_f32 v138, v138
    v_exp_f32 v139, v139
    v_cvt_pk_bf16_f32 v180, v136, v137
    v_exp_f32 v140, v140
    v_cvt_pk_bf16_f32 v181, v138, v139
    v_exp_f32 v141, v141
    v_exp_f32 v142, v142
    v_exp_f32 v143, v143
    v_cvt_pk_bf16_f32 v182, v140, v141
    v_cvt_pk_bf16_f32 v183, v142, v143
    s_nop 1
    v_mfma_f32_32x32x16_bf16 v[184:199], v[164:167], v[180:183], v[184:199]
a_done_49:
    s_add_u32 s56, s44, s61
    s_add_u32 s57, s44, s62
    s_add_u32 s57, s57, s41
    s_lshl_b32 s59, s24, 10
    s_lshr_b32 s60, s40, 1
    s_lshl_b32 s60, s60, 8
    s_add_u32 s59, s59, s60
    s_lshl_b32 s60, s25, 3
    s_add_u32 s59, s59, s60
    s_and_b32 s60, s40, 1
    s_lshl_b32 s60, s60, 2
    s_add_u32 s59, s59, s60
    s_add_u32 s59, s59, 12288
    v_rcp_f32 v28, v196
    v_rcp_f32 v29, v196
    s_nop 0
    v_pk_mul_f32 v[184:185], v[184:185], v[28:29]
    v_pk_mul_f32 v[186:187], v[186:187], v[28:29]
    v_pk_mul_f32 v[188:189], v[188:189], v[28:29]
    v_pk_mul_f32 v[190:191], v[190:191], v[28:29]
    v_pk_mul_f32 v[192:193], v[192:193], v[28:29]
    v_pk_mul_f32 v[194:195], v[194:195], v[28:29]
    v_cvt_pk_bf16_f32 v176, v184, v185
    v_cvt_pk_bf16_f32 v177, v186, v187
    v_cvt_pk_bf16_f32 v178, v188, v189
    v_cvt_pk_bf16_f32 v179, v190, v191
    v_cvt_pk_bf16_f32 v180, v192, v193
    v_cvt_pk_bf16_f32 v181, v194, v195
    buffer_store_dwordx4 v[176:179], v7, s[12:15], s56 offen
    s_mov_b32 exec_hi, 0
    buffer_store_dwordx2 v[180:181], v6, s[12:15], s57 offen
    s_mov_b32 exec_hi, -1
    v_mov_b32 v28, s26
    s_waitcnt vmcnt(0)
    s_mov_b64 exec, 1
    s_cmp_eq_u32 s27, 0
    s_cbranch_scc1 pf_70
    s_waitcnt vmcnt(0)
    buffer_wbl2 sc1
    s_waitcnt vmcnt(0)
    buffer_store_dword v28, off, s[12:15], s59 sc1
    s_branch pd_71
pf_70:
    buffer_store_dword v28, off, s[12:15], s59
pd_71:
    s_mov_b64 exec, -1
    s_setprio 0
    s_cmp_lg_u32 s24, 0
    s_cbranch_scc1 a_wd_73
    s_cmp_ge_u32 s29, 9999
    s_cbranch_scc1 L_a_g0
    s_mov_b32 s46, s54
    s_call_b64 s[0:1], L_rfinish
    s_mov_b32 s54, s46
    s_sub_u32 s48, s3, 5
    s_mul_i32 s48, s48, 10240
    s_lshr_b32 s49, s25, 2
    s_mul_i32 s49, s49, 102400
    s_add_u32 s49, s49, s48
    s_add_u32 s49, s49, 28385280
    s_add_u32 s48, s48, 131072
    s_add_u32 m0, s48, 0
    s_add_u32 s50, s49, 0
    buffer_load_dwordx4 v3, s[12:15], s50 offen offset:0 sc1 lds
    buffer_load_dwordx4 v3, s[12:15], s50 offen offset:1024 sc1 lds
    buffer_load_dwordx4 v3, s[12:15], s50 offen offset:2048 sc1 lds
    buffer_load_dwordx4 v3, s[12:15], s50 offen offset:3072 sc1 lds
    s_add_u32 m0, s48, 4096
    s_add_u32 s50, s49, 4096
    buffer_load_dwordx4 v3, s[12:15], s50 offen offset:0 sc1 lds
    buffer_load_dwordx4 v3, s[12:15], s50 offen offset:1024 sc1 lds
    buffer_load_dwordx4 v3, s[12:15], s50 offen offset:2048 sc1 lds
    buffer_load_dwordx4 v3, s[12:15], s50 offen offset:3072 sc1 lds
    s_add_u32 m0, s48, 8192
    s_add_u32 s50, s49, 8192
    buffer_load_dwordx4 v3, s[12:15], s50 offen offset:0 sc1 lds
    buffer_load_dwordx4 v3, s[12:15], s50 offen offset:1024 sc1 lds
    v_mov_b32 v28, s26
    s_waitcnt vmcnt(10)
    s_mov_b64 exec, 1
    buffer_store_dword v28, off, s[12:15], s29 sc1
    s_mov_b64 exec, -1
    s_mov_b32 s29, 9999
L_a_g0:
    s_cmp_lt_u32 s3, 4
    s_cbranch_scc1 a_wl_72
    s_lshl_b32 s46, s2, 3
    s_or_b32 s46, s46, s3
    s_cmp_lg_u32 s46, 4
    s_cbranch_scc1 a_wl_72
    s_mov_b32 s46, 1024
    s_mov_b32 s47, 30000
L_ep_l:
    buffer_load_dwordx4 v[4:7], v3, s[12:15], s46 offen sc1
    s_waitcnt vmcnt(0)
    v_subrev_u32 v4, s26, v4
    v_subrev_u32 v5, s26, v5
    v_subrev_u32 v6, s26, v6
    v_subrev_u32 v7, s26, v7
    v_or3_b32 v4, v4, v5, v6
    v_or_b32 v4, v4, v7
    v_cmp_lt_u32 vcc, 15, v4
    s_nop 0
    s_cmp_eq_u64 vcc, 0
    s_cbranch_scc1 L_ep_d
    s_sub_u32 s47, s47, 1
    s_cbranch_scc0 L_ep_l
L_ep_d:
    s_mul_i32 s46, s26, 244002641
    v_mov_b32 v4, s46
    s_mov_b32 s46, 0
    s_mov_b64 exec, 1
    buffer_store_dword v4, off, s[12:15], s46 sc1
    s_mov_b64 exec, -1
a_wl_72:
    s_cmp_ge_u32 s10, s8
    s_cbranch_scc1 L_a_wx
    s_mov_b32 m0, s10
    s_add_u32 s10, s10, 1024
    buffer_load_dwordx4 v3, s[12:15], s9 offen offset:0 sc1 lds
    s_add_u32 s9, s9, 1024
    s_branch a_wl_72
L_a_wx:
    s_waitcnt vmcnt(0)
a_wd_73:
    s_cmp_ge_u32 s29, 9999
    s_cbranch_scc1 L_a_end
    s_call_b64 s[0:1], L_rfinish
    s_sub_u32 s48, s3, 5
    s_mul_i32 s48, s48, 10240
    s_lshr_b32 s49, s25, 2
    s_mul_i32 s49, s49, 102400
    s_add_u32 s49, s49, s48
    s_add_u32 s49, s49, 28385280
    s_add_u32 s48, s48, 131072
    s_add_u32 m0, s48, 0
    s_add_u32 s50, s49, 0
    buffer_load_dwordx4 v3, s[12:15], s50 offen offset:0 sc1 lds
    buffer_load_dwordx4 v3, s[12:15], s50 offen offset:1024 sc1 lds
    buffer_load_dwordx4 v3, s[12:15], s50 offen offset:2048 sc1 lds
    buffer_load_dwordx4 v3, s[12:15], s50 offen offset:3072 sc1 lds
    s_add_u32 m0, s48, 4096
    s_add_u32 s50, s49, 4096
    buffer_load_dwordx4 v3, s[12:15], s50 offen offset:0 sc1 lds
    buffer_load_dwordx4 v3, s[12:15], s50 offen offset:1024 sc1 lds
    buffer_load_dwordx4 v3, s[12:15], s50 offen offset:2048 sc1 lds
    buffer_load_dwordx4 v3, s[12:15], s50 offen offset:3072 sc1 lds
    s_add_u32 m0, s48, 8192
    s_add_u32 s50, s49, 8192
    buffer_load_dwordx4 v3, s[12:15], s50 offen offset:0 sc1 lds
    buffer_load_dwordx4 v3, s[12:15], s50 offen offset:1024 sc1 lds
L_a_end:
L_p3:
    s_cmp_ge_u32 s3, 4
    s_cbranch_scc1 L_loader45
    s_and_b32 s40, s25, 3
    s_lshr_b32 s41, s25, 2
    s_lshl_b32 s44, s24, 2
    s_add_u32 s44, s44, s40
    s_mul_i32 s45, s44, 655360
    s_lshl_b32 s46, s3, 8
    s_add_u32 s45, s45, s46
    s_add_u32 s45, s45, 1048576
    s_add_u32 s46, s45, 0
    v_and_b32 v4, 15, v2
    v_lshrrev_b32 v5, 4, v2
    v_lshlrev_b32 v6, 4, v4
    v_lshl_add_u32 v6, v5, 10, v6
    v_add_u32 v8, 57344, v3
    v_add_u32 v9, 122880, v3
    s_lshl_b32 s47, s3, 10
    v_add_u32 v10, s47, v3
    v_and_b32 v11, 31, v2
    v_lshlrev_b32 v11, 3, v11
    s_lshl_b32 s47, s44, 8
    s_lshr_b32 s48, s3, 1
    s_lshl_b32 s48, s48, 2
    s_add_u32 s47, s47, s48
    s_add_u32 s47, s47, 12288
    s_barrier
    buffer_load_dword v13, v11, s[12:15], s47 offen sc1
    ds_read_b128 v[64:67], v8 offset:0
    ds_read_b128 v[68:71], v8 offset:2048
    ds_read_b128 v[72:75], v8 offset:4096
    ds_read_b128 v[76:79], v8 offset:6144
    ds_read_b128 v[80:83], v8 offset:8192
    ds_read_b128 v[84:87], v8 offset:1024
    ds_read_b128 v[88:91], v8 offset:3072
    ds_read_b128 v[92:95], v8 offset:5120
    ds_read_b128 v[176:179], v8 offset:7168
    ds_read_b128 v[180:183], v8 offset:9216
    ds_read_b128 v[184:187], v8 offset:10240
    ds_read_b128 v[188:191], v8 offset:12288
    ds_read_b128 v[192:195], v8 offset:14336
    ds_read_b128 v[196:199], v8 offset:16384
    ds_read_b128 v[200:203], v8 offset:18432
    ds_read_b128 v[204:207], v8 offset:11264
    ds_read_b128 v[208:211], v8 offset:13312
    ds_read_b128 v[212:215], v8 offset:15360
    ds_read_b128 v[216:219], v8 offset:17408
    ds_read_b128 v[220:223], v8 offset:19456
    ds_read_b128 v[224:227], v8 offset:20480
    ds_read_b128 v[228:231], v8 offset:22528
    ds_read_b128 v[232:235], v8 offset:24576
    ds_read_b128 v[236:239], v8 offset:26624
    ds_read_b128 v[240:243], v8 offset:28672
    ds_read_b128 v[244:247], v8 offset:21504
    ds_read_b128 v[248:251], v8 offset:23552
    v_lshlrev_b32 v16, 16, v48
    v_and_b32 v17, 0xffff0000, v48
    v_lshlrev_b32 v18, 16, v49
    v_and_b32 v19, 0xffff0000, v49
    v_lshlrev_b32 v20, 16, v50
    v_and_b32 v21, 0xffff0000, v50
    v_lshlrev_b32 v22, 16, v51
    v_and_b32 v23, 0xffff0000, v51
    v_lshlrev_b32 v24, 16, v52
    v_and_b32 v25, 0xffff0000, v52
    v_lshlrev_b32 v26, 16, v53
    v_and_b32 v27, 0xffff0000, v53
    v_lshlrev_b32 v28, 16, v54
    v_and_b32 v29, 0xffff0000, v54
    v_lshlrev_b32 v30, 16, v55
    v_and_b32 v31, 0xffff0000, v55
    v_lshlrev_b32 v32, 16, v56
    v_and_b32 v33, 0xffff0000, v56
    v_lshlrev_b32 v34, 16, v57
    v_and_b32 v35, 0xffff0000, v57
    v_lshrrev_b32 v7, 1, v5
    v_lshlrev_b32 v7, 10, v7
    v_lshl_add_u32 v7, v4, 4, v7
    v_and_b32 v12, 1, v5
    v_lshl_add_u32 v7, v12, 3, v7
    s_mul_i32 s48, s41, 10240
    s_add_u32 s48, s48, s45
    s_add_u32 s48, s48, 81920
    s_add_u32 s49, s48, 4096
    s_add_u32 s50, s48, 8192
    s_mul_i32 s51, s3, 1792
    s_add_u32 s51, s51, s45
    s_and_b32 s52, s41, 1
    s_lshl_b32 s52, s52, 10
    s_add_u32 s51, s51, s52
    s_lshr_b32 s52, s41, 1
    s_lshl_b32 s52, s52, 8
    s_add_u32 s51, s51, s52
    s_lshl_b32 s52, s41, 3
    s_add_u32 s51, s51, 638976
    s_lshl_b32 s53, s44, 7
    s_add_u32 s52, s52, s53
    s_lshr_b32 s53, s3, 1
    s_lshl_b32 s53, s53, 6
    s_add_u32 s52, s52, s53
    s_and_b32 s53, s3, 1
    s_lshl_b32 s53, s53, 2
    s_add_u32 s52, s52, s53
    s_add_u32 s52, s52, 20480
    s_mov_b32 s53, 30000
    s_waitcnt vmcnt(0)
    s_branch pc_75
pl_74:
    buffer_load_dword v13, v11, s[12:15], s47 offen sc1
    s_waitcnt vmcnt(0)
pc_75:
    v_cmp_ne_u32 vcc, s26, v13
    s_nop 0
    s_cmp_eq_u64 vcc, 0
    s_cbranch_scc1 pdn_76
    s_sleep 1
    s_sub_u32 s53, s53, 1
    s_cbranch_scc0 pl_74
pdn_76:
    s_cmp_eq_u32 s27, 0
    s_cbranch_scc1 pi_77
    buffer_inv sc1
    s_waitcnt vmcnt(0)
pi_77:
    buffer_load_dwordx4 v[96:99], v6, s[12:15], s46 offen sc1
    s_add_u32 s46, s46, 4096
    v_and_b32 v11, 3, v2
    v_lshlrev_b32 v11, 2, v11
    s_add_u32 s53, s24, 1
    s_min_u32 s53, s53, 7
    s_lshl_b32 s53, s53, 7
    s_lshl_b32 s54, s41, 4
    s_add_u32 s53, s53, s54
    s_add_u32 s53, s53, 45056
    buffer_load_dwordx4 v[100:103], v6, s[12:15], s46 offen sc1
    s_add_u32 s46, s46, 4096
    buffer_load_dwordx4 v[104:107], v6, s[12:15], s46 offen sc1
    s_add_u32 s46, s46, 4096
    buffer_load_dwordx4 v[108:111], v6, s[12:15], s46 offen sc1
    s_add_u32 s46, s46, 4096
    buffer_load_dwordx4 v[112:115], v6, s[12:15], s46 offen sc1
    s_add_u32 s46, s46, 4096
    buffer_load_dwordx4 v[116:119], v6, s[12:15], s46 offen sc1
    s_add_u32 s46, s46, 4096
    buffer_load_dwordx4 v[120:123], v6, s[12:15], s46 offen sc1
    s_add_u32 s46, s46, 4096
    buffer_load_dwordx4 v[124:127], v6, s[12:15], s46 offen sc1
    s_add_u32 s46, s46, 4096
    buffer_load_dwordx4 v[128:131], v6, s[12:15], s46 offen sc1
    s_add_u32 s46, s46, 4096
    buffer_load_dwordx4 v[132:135], v6, s[12:15], s46 offen sc1
    s_add_u32 s46, s46, 4096
    buffer_load_dwordx4 v[136:139], v6, s[12:15], s46 offen sc1
    s_add_u32 s46, s46, 4096
    buffer_load_dwordx4 v[140:143], v6, s[12:15], s46 offen sc1
    s_add_u32 s46, s46, 4096
    s_waitcnt lgkmcnt(0)
    s_waitcnt vmcnt(11)
    v_mfma_f32_16x16x32_bf16 v[16:19], v[64:67], v[96:99], v[16:19]
    ds_read_b128 v[252:255], v8 offset:25600
    buffer_load_dwordx4 v[144:147], v6, s[12:15], s46 offen sc1
    s_add_u32 s46, s46, 4096
    v_mfma_f32_16x16x32_bf16 v[20:23], v[68:71], v[96:99], v[20:23]
    ds_read_b128 v[64:67], v8 offset:27648
    v_mfma_f32_16x16x32_bf16 v[24:27], v[72:75], v[96:99], v[24:27]
    ds_read_b128 v[68:71], v8 offset:29696
    v_mfma_f32_16x16x32_bf16 v[28:31], v[76:79], v[96:99], v[28:31]
    s_barrier
    ds_read_b128 v[72:75], v8 offset:30720
    v_mfma_f32_16x16x32_bf16 v[32:35], v[80:83], v[96:99], v[32:35]
    ds_read_b128 v[76:79], v8 offset:32768
    s_waitcnt vmcnt(11)
    v_mfma_f32_16x16x32_bf16 v[16:19], v[84:87], v[100:103], v[16:19]
    ds_read_b128 v[80:83], v8 offset:34816
    buffer_load_dwordx4 v[148:151], v6, s[12:15], s46 offen sc1
    s_add_u32 s46, s46, 4096
    v_mfma_f32_16x16x32_bf16 v[20:23], v[88:91], v[100:103], v[20:23]
    ds_read_b128 v[84:87], v8 offset:36864
    v_mfma_f32_16x16x32_bf16 v[24:27], v[92:95], v[100:103], v[24:27]
    ds_read_b128 v[88:91], v8 offset:38912
    v_mfma_f32_16x16x32_bf16 v[28:31], v[176:179], v[100:103], v[28:31]
    ds_read_b128 v[92:95], v8 offset:31744
    v_mfma_f32_16x16x32_bf16 v[32:35], v[180:183], v[100:103], v[32:35]
    ds_read_b128 v[176:179], v8 offset:33792
    s_waitcnt vmcnt(11)
    v_mfma_f32_16x16x32_bf16 v[16:19], v[184:187], v[104:107], v[16:19]
    ds_read_b128 v[180:183], v8 offset:35840
    buffer_load_dwordx4 v[152:155], v6, s[12:15], s46 offen sc1
    s_add_u32 s46, s46, 4096
    v_mfma_f32_16x16x32_bf16 v[20:23], v[188:191], v[104:107], v[20:23]
    ds_read_b128 v[184:187], v8 offset:37888
    v_mfma_f32_16x16x32_bf16 v[24:27], v[192:195], v[104:107], v[24:27]
    ds_read_b128 v[188:191], v8 offset:39936
    v_mfma_f32_16x16x32_bf16 v[28:31], v[196:199], v[104:107], v[28:31]
    ds_read_b128 v[192:195], v8 offset:40960
    v_mfma_f32_16x16x32_bf16 v[32:35], v[200:203], v[104:107], v[32:35]
    ds_read_b128 v[196:199], v8 offset:43008
    s_waitcnt vmcnt(11)
    v_mfma_f32_16x16x32_bf16 v[16:19], v[204:207], v[108:111], v[16:19]
    ds_read_b128 v[200:203], v8 offset:45056
    buffer_load_dwordx4 v[156:159], v6, s[12:15], s46 offen sc1
    s_add_u32 s46, s46, 4096
    v_mfma_f32_16x16x32_bf16 v[20:23], v[208:211], v[108:111], v[20:23]
    ds_read_b128 v[204:207], v8 offset:47104
    v_mfma_f32_16x16x32_bf16 v[24:27], v[212:215], v[108:111], v[24:27]
    ds_read_b128 v[208:211], v8 offset:49152
    v_mfma_f32_16x16x32_bf16 v[28:31], v[216:219], v[108:111], v[28:31]
    ds_read_b128 v[212:215], v8 offset:41984
    v_mfma_f32_16x16x32_bf16 v[32:35], v[220:223], v[108:111], v[32:35]
    ds_read_b128 v[216:219], v8 offset:44032
    s_waitcnt vmcnt(11)
    s_waitcnt lgkmcnt(15)
    v_mfma_f32_16x16x32_bf16 v[16:19], v[224:227], v[112:115], v[16:19]
    ds_read_b128 v[220:223], v8 offset:46080
    buffer_load_dwordx4 v[160:163], v6, s[12:15], s46 offen sc1
    s_add_u32 s46, s46, 4096
    v_mfma_f32_16x16x32_bf16 v[20:23], v[228:231], v[112:115], v[20:23]
    ds_read_b128 v[224:227], v8 offset:48128
    v_mfma_f32_16x16x32_bf16 v[24:27], v[232:235], v[112:115], v[24:27]
    ds_read_b128 v[228:231], v8 offset:50176
    v_mfma_f32_16x16x32_bf16 v[28:31], v[236:239], v[112:115], v[28:31]
    ds_read_b128 v[232:235], v8 offset:51200
    v_mfma_f32_16x16x32_bf16 v[32:35], v[240:243], v[112:115], v[32:35]
    ds_read_b128 v[236:239], v8 offset:53248
    s_waitcnt vmcnt(11)
    s_waitcnt lgkmcnt(15)
    v_mfma_f32_16x16x32_bf16 v[16:19], v[244:247], v[116:119], v[16:19]
    ds_read_b128 v[240:243], v8 offset:55296
    buffer_load_dwordx4 v[164:167], v6, s[12:15], s46 offen sc1
    s_add_u32 s46, s46, 4096
    v_mfma_f32_16x16x32_bf16 v[20:23], v[248:251], v[116:119], v[20:23]
    ds_read_b128 v[244:247], v8 offset:57344
    v_mfma_f32_16x16x32_bf16 v[24:27], v[252:255], v[116:119], v[24:27]
    ds_read_b128 v[248:251], v8 offset:59392
    v_mfma_f32_16x16x32_bf16 v[28:31], v[64:67], v[116:119], v[28:31]
    ds_read_b128 v[252:255], v8 offset:52224
    v_mfma_f32_16x16x32_bf16 v[32:35], v[68:71], v[116:119], v[32:35]
    ds_read_b128 v[64:67], v8 offset:54272
    s_waitcnt vmcnt(11)
    s_waitcnt lgkmcnt(15)
    v_mfma_f32_16x16x32_bf16 v[16:19], v[72:75], v[120:123], v[16:19]
    ds_read_b128 v[68:71], v8 offset:56320
    buffer_load_dwordx4 v[168:171], v6, s[12:15], s46 offen sc1
    s_add_u32 s46, s46, 4096
    v_mfma_f32_16x16x32_bf16 v[20:23], v[76:79], v[120:123], v[20:23]
    ds_read_b128 v[72:75], v8 offset:58368
    v_mfma_f32_16x16x32_bf16 v[24:27], v[80:83], v[120:123], v[24:27]
    ds_read_b128 v[76:79], v8 offset:60416
    v_mfma_f32_16x16x32_bf16 v[28:31], v[84:87], v[120:123], v[28:31]
    ds_read_b128 v[80:83], v8 offset:61440
    v_mfma_f32_16x16x32_bf16 v[32:35], v[88:91], v[120:123], v[32:35]
    ds_read_b128 v[84:87], v8 offset:63488
    s_waitcnt vmcnt(11)
    s_waitcnt lgkmcnt(15)
    v_mfma_f32_16x16x32_bf16 v[16:19], v[92:95], v[124:127], v[16:19]
    ds_read_b128 v[88:91], v9 offset:0
    buffer_load_dwordx4 v[172:175], v6, s[12:15], s46 offen sc1
    buffer_load_dword v13, v11, s[12:15], s53 offen sc1
    v_mfma_f32_16x16x32_bf16 v[20:23], v[176:179], v[124:127], v[20:23]
    ds_read_b128 v[92:95], v9 offset:2048
    v_mfma_f32_16x16x32_bf16 v[24:27], v[180:183], v[124:127], v[24:27]
    ds_read_b128 v[176:179], v9 offset:4096
    v_mfma_f32_16x16x32_bf16 v[28:31], v[184:187], v[124:127], v[28:31]
    ds_read_b128 v[180:183], v8 offset:62464
    v_mfma_f32_16x16x32_bf16 v[32:35], v[188:191], v[124:127], v[32:35]
    ds_read_b128 v[184:187], v8 offset:64512
    s_waitcnt vmcnt(12)
    s_waitcnt lgkmcnt(15)
    v_mfma_f32_16x16x32_bf16 v[16:19], v[192:195], v[128:131], v[16:19]
    ds_read_b128 v[188:191], v9 offset:1024
    v_mfma_f32_16x16x32_bf16 v[20:23], v[196:199], v[128:131], v[20:23]
    ds_read_b128 v[192:195], v9 offset:3072
    v_mfma_f32_16x16x32_bf16 v[24:27], v[200:203], v[128:131], v[24:27]
    ds_read_b128 v[196:199], v9 offset:5120
    v_mfma_f32_16x16x32_bf16 v[28:31], v[204:207], v[128:131], v[28:31]
    ds_read_b128 v[200:203], v9 offset:6144
    v_mfma_f32_16x16x32_bf16 v[32:35], v[208:211], v[128:131], v[32:35]
    ds_read_b128 v[204:207], v9 offset:8192
    s_waitcnt vmcnt(11)
    s_waitcnt lgkmcnt(15)
    v_mfma_f32_16x16x32_bf16 v[16:19], v[212:215], v[132:135], v[16:19]
    ds_read_b128 v[208:211], v9 offset:10240
    v_mfma_f32_16x16x32_bf16 v[20:23], v[216:219], v[132:135], v[20:23]
    ds_read_b128 v[212:215], v9 offset:12288
    v_mfma_f32_16x16x32_bf16 v[24:27], v[220:223], v[132:135], v[24:27]
    ds_read_b128 v[216:219], v9 offset:14336
    v_mfma_f32_16x16x32_bf16 v[28:31], v[224:227], v[132:135], v[28:31]
    ds_read_b128 v[220:223], v9 offset:7168
    v_mfma_f32_16x16x32_bf16 v[32:35], v[228:231], v[132:135], v[32:35]
    ds_read_b128 v[224:227], v9 offset:9216
    s_waitcnt vmcnt(10)
    s_waitcnt lgkmcnt(15)
    v_mfma_f32_16x16x32_bf16 v[16:19], v[232:235], v[136:139], v[16:19]
    ds_read_b128 v[228:231], v9 offset:11264
    v_mfma_f32_16x16x32_bf16 v[20:23], v[236:239], v[136:139], v[20:23]
    ds_read_b128 v[232:235], v9 offset:13312
    v_mfma_f32_16x16x32_bf16 v[24:27], v[240:243], v[136:139], v[24:27]
    ds_read_b128 v[236:239], v9 offset:15360
    v_mfma_f32_16x16x32_bf16 v[28:31], v[244:247], v[136:139], v[28:31]
    ds_read_b128 v[240:243], v9 offset:16384
    v_mfma_f32_16x16x32_bf16 v[32:35], v[248:251], v[136:139], v[32:35]
    ds_read_b128 v[244:247], v9 offset:18432
    s_waitcnt vmcnt(9)
    s_waitcnt lgkmcnt(15)
    v_mfma_f32_16x16x32_bf16 v[16:19], v[252:255], v[140:143], v[16:19]
    ds_read_b128 v[248:251], v9 offset:20480
    v_mfma_f32_16x16x32_bf16 v[20:23], v[64:67], v[140:143], v[20:23]
    ds_read_b128 v[252:255], v9 offset:22528
    v_mfma_f32_16x16x32_bf16 v[24:27], v[68:71], v[140:143], v[24:27]
    ds_read_b128 v[64:67], v9 offset:24576
    v_mfma_f32_16x16x32_bf16 v[28:31], v[72:75], v[140:143], v[28:31]
    ds_read_b128 v[68:71], v9 offset:17408
    v_mfma_f32_16x16x32_bf16 v[32:35], v[76:79], v[140:143], v[32:35]
    ds_read_b128 v[72:75], v9 offset:19456
    s_waitcnt vmcnt(8)
    s_waitcnt lgkmcnt(15)
    v_mfma_f32_16x16x32_bf16 v[16:19], v[80:83], v[144:147], v[16:19]
    ds_read_b128 v[76:79], v9 offset:21504
    v_mfma_f32_16x16x32_bf16 v[20:23], v[84:87], v[144:147], v[20:23]
    ds_read_b128 v[80:83], v9 offset:23552
    v_mfma_f32_16x16x32_bf16 v[24:27], v[88:91], v[144:147], v[24:27]
    ds_read_b128 v[84:87], v9 offset:25600
    v_mfma_f32_16x16x32_bf16 v[28:31], v[92:95], v[144:147], v[28:31]
    ds_read_b128 v[88:91], v9 offset:26624
    v_mfma_f32_16x16x32_bf16 v[32:35], v[176:179], v[144:147], v[32:35]
    ds_read_b128 v[92:95], v9 offset:28672
    s_waitcnt vmcnt(7)
    s_waitcnt lgkmcnt(15)
    v_mfma_f32_16x16x32_bf16 v[16:19], v[180:183], v[148:151], v[16:19]
    ds_read_b128 v[176:179], v9 offset:30720
    v_mfma_f32_16x16x32_bf16 v[20:23], v[184:187], v[148:151], v[20:23]
    ds_read_b128 v[180:183], v9 offset:32768
    v_mfma_f32_16x16x32_bf16 v[24:27], v[188:191], v[148:151], v[24:27]
    ds_read_b128 v[184:187], v9 offset:34816
    v_mfma_f32_16x16x32_bf16 v[28:31], v[192:195], v[148:151], v[28:31]
    ds_read_b128 v[188:191], v9 offset:27648
    v_mfma_f32_16x16x32_bf16 v[32:35], v[196:199], v[148:151], v[32:35]
    ds_read_b128 v[192:195], v9 offset:29696
    s_waitcnt vmcnt(6)
    s_waitcnt lgkmcnt(15)
    v_mfma_f32_16x16x32_bf16 v[16:19], v[200:203], v[152:155], v[16:19]
    ds_read_b128 v[196:199], v9 offset:31744
    v_mfma_f32_16x16x32_bf16 v[20:23], v[204:207], v[152:155], v[20:23]
    ds_read_b128 v[200:203], v9 offset:33792
    v_mfma_f32_16x16x32_bf16 v[24:27], v[208:211], v[152:155], v[24:27]
    ds_read_b128 v[204:207], v9 offset:35840
    v_mfma_f32_16x16x32_bf16 v[28:31], v[212:215], v[152:155], v[28:31]
    v_mfma_f32_16x16x32_bf16 v[32:35], v[216:219], v[152:155], v[32:35]
    s_waitcnt vmcnt(5)
    s_waitcnt lgkmcnt(15)
    v_mfma_f32_16x16x32_bf16 v[16:19], v[220:223], v[156:159], v[16:19]
    v_mfma_f32_16x16x32_bf16 v[20:23], v[224:227], v[156:159], v[20:23]
    v_mfma_f32_16x16x32_bf16 v[24:27], v[228:231], v[156:159], v[24:27]
    v_mfma_f32_16x16x32_bf16 v[28:31], v[232:235], v[156:159], v[28:31]
    v_mfma_f32_16x16x32_bf16 v[32:35], v[236:239], v[156:159], v[32:35]
    s_waitcnt vmcnt(4)
    s_waitcnt lgkmcnt(15)
    v_mfma_f32_16x16x32_bf16 v[16:19], v[240:243], v[160:163], v[16:19]
    v_mfma_f32_16x16x32_bf16 v[20:23], v[244:247], v[160:163], v[20:23]
    v_mfma_f32_16x16x32_bf16 v[24:27], v[248:251], v[160:163], v[24:27]
    v_mfma_f32_16x16x32_bf16 v[28:31], v[252:255], v[160:163], v[28:31]
    s_waitcnt lgkmcnt(15)
    v_mfma_f32_16x16x32_bf16 v[32:35], v[64:67], v[160:163], v[32:35]
    s_waitcnt vmcnt(3)
    s_waitcnt lgkmcnt(14)
    v_mfma_f32_16x16x32_bf16 v[16:19], v[68:71], v[164:167], v[16:19]
    s_waitcnt lgkmcnt(13)
    v_mfma_f32_16x16x32_bf16 v[20:23], v[72:75], v[164:167], v[20:23]
    s_waitcnt lgkmcnt(12)
    v_mfma_f32_16x16x32_bf16 v[24:27], v[76:79], v[164:167], v[24:27]
    s_waitcnt lgkmcnt(11)
    v_mfma_f32_16x16x32_bf16 v[28:31], v[80:83], v[164:167], v[28:31]
    s_waitcnt lgkmcnt(10)
    v_mfma_f32_16x16x32_bf16 v[32:35], v[84:87], v[164:167], v[32:35]
    s_waitcnt vmcnt(2)
    s_waitcnt lgkmcnt(9)
    v_mfma_f32_16x16x32_bf16 v[16:19], v[88:91], v[168:171], v[16:19]
    s_waitcnt lgkmcnt(8)
    v_mfma_f32_16x16x32_bf16 v[20:23], v[92:95], v[168:171], v[20:23]
    s_waitcnt lgkmcnt(7)
    v_mfma_f32_16x16x32_bf16 v[24:27], v[176:179], v[168:171], v[24:27]
    s_waitcnt lgkmcnt(6)
    v_mfma_f32_16x16x32_bf16 v[28:31], v[180:183], v[168:171], v[28:31]
    s_waitcnt lgkmcnt(5)
    v_mfma_f32_16x16x32_bf16 v[32:35], v[184:187], v[168:171], v[32:35]
    s_waitcnt vmcnt(1)
    s_waitcnt lgkmcnt(4)
    v_mfma_f32_16x16x32_bf16 v[16:19], v[188:191], v[172:175], v[16:19]
    s_waitcnt lgkmcnt(3)
    v_mfma_f32_16x16x32_bf16 v[20:23], v[192:195], v[172:175], v[20:23]
    s_waitcnt lgkmcnt(2)
    v_mfma_f32_16x16x32_bf16 v[24:27], v[196:199], v[172:175], v[24:27]
    s_waitcnt lgkmcnt(1)
    v_mfma_f32_16x16x32_bf16 v[28:31], v[200:203], v[172:175], v[28:31]
    s_waitcnt lgkmcnt(0)
    v_mfma_f32_16x16x32_bf16 v[32:35], v[204:207], v[172:175], v[32:35]
    s_mov_b32 s54, 30000
    s_waitcnt vmcnt(0)
    s_branch pc_79
pl_78:
    buffer_load_dword v13, v11, s[12:15], s53 offen sc1
    s_waitcnt vmcnt(0)
pc_79:
    v_cmp_ne_u32 vcc, s26, v13
    s_nop 0
    s_cmp_eq_u64 vcc, 0
    s_cbranch_scc1 pdn_80
    s_sleep 1
    s_sub_u32 s54, s54, 1
    s_cbranch_scc0 pl_78
pdn_80:
    v_cvt_pk_bf16_f32 v40, v16, v17
    v_cvt_pk_bf16_f32 v41, v18, v19
    v_cvt_pk_bf16_f32 v42, v20, v21
    v_cvt_pk_bf16_f32 v43, v22, v23
    buffer_store_dwordx4 v[40:43], v6, s[12:15], s48 offen
    v_cvt_pk_bf16_f32 v44, v24, v25
    v_cvt_pk_bf16_f32 v45, v26, v27
    v_cvt_pk_bf16_f32 v46, v28, v29
    v_cvt_pk_bf16_f32 v47, v30, v31
    buffer_store_dwordx4 v[44:47], v6, s[12:15], s49 offen
    v_cvt_pk_bf16_f32 v48, v32, v33
    v_cvt_pk_bf16_f32 v49, v34, v35
    buffer_store_dwordx2 v[48:49], v7, s[12:15], s50 offen
    v_pk_add_f32 v[56:57], v[16:17], v[18:19]
    v_pk_mul_f32 v[58:59], v[16:17], v[16:17]
    v_pk_fma_f32 v[58:59], v[18:19], v[18:19], v[58:59]
    v_pk_fma_f32 v[58:59], v[20:21], v[20:21], v[58:59]
    v_pk_add_f32 v[56:57], v[56:57], v[20:21]
    v_pk_fma_f32 v[58:59], v[22:23], v[22:23], v[58:59]
    v_pk_add_f32 v[56:57], v[56:57], v[22:23]
    v_pk_fma_f32 v[58:59], v[24:25], v[24:25], v[58:59]
    v_pk_add_f32 v[56:57], v[56:57], v[24:25]
    v_pk_fma_f32 v[58:59], v[26:27], v[26:27], v[58:59]
    v_pk_add_f32 v[56:57], v[56:57], v[26:27]
    v_pk_fma_f32 v[58:59], v[28:29], v[28:29], v[58:59]
    v_pk_add_f32 v[56:57], v[56:57], v[28:29]
    v_pk_fma_f32 v[58:59], v[30:31], v[30:31], v[58:59]
    v_pk_add_f32 v[56:57], v[56:57], v[30:31]
    v_pk_fma_f32 v[58:59], v[32:33], v[32:33], v[58:59]
    v_pk_add_f32 v[56:57], v[56:57], v[32:33]
    v_pk_fma_f32 v[58:59], v[34:35], v[34:35], v[58:59]
    v_pk_add_f32 v[56:57], v[56:57], v[34:35]
    v_mov_b32 v52, v56
    v_mov_b32 v53, v58
    v_mov_b32 v54, v57
    v_mov_b32 v55, v59
    v_add_f32 v52, v52, v54
    v_add_f32 v53, v53, v55
    v_mov_b32 v56, v52
    v_mov_b32 v57, v53
    s_nop 0
    v_permlane16_swap_b32 v52, v56
    v_permlane16_swap_b32 v53, v57
    v_add_f32 v52, v52, v56
    v_add_f32 v53, v53, v57
    v_mov_b32 v56, v52
    v_mov_b32 v57, v53
    s_nop 0
    v_permlane32_swap_b32 v52, v56
    v_permlane32_swap_b32 v53, v57
    v_add_f32 v52, v52, v56
    v_add_f32 v53, v53, v57
    v_mov_b32 v54, s26
    s_mov_b64 exec, 0xffff
    buffer_store_dwordx4 v[52:55], v3, s[12:15], s51 offen
    s_waitcnt vmcnt(1)
    s_mov_b64 exec, 1
    s_cmp_eq_u32 s27, 0
    s_cbranch_scc1 pf_81
    s_waitcnt vmcnt(0)
    buffer_wbl2 sc1
    s_waitcnt vmcnt(0)
    buffer_store_dword v54, off, s[12:15], s52 sc1
    s_branch pd_82
pf_81:
    buffer_store_dword v54, off, s[12:15], s52
pd_82:
    s_mov_b64 exec, -1
    s_barrier
    s_and_b32 s40, s25, 1
    s_lshr_b32 s42, s3, 1
    s_and_b32 s43, s3, 1
    s_lshl_b32 s44, s40, 1
    s_add_u32 s44, s44, s42
    s_lshl_b32 s45, s24, 2
    s_add_u32 s45, s45, s44
    s_lshl_b32 s47, s45, 7
    s_lshl_b32 s48, s43, 6
    s_add_u32 s47, s47, s48
    s_add_u32 s47, s47, 20480
    s_mul_i32 s45, s45, 655360
    s_add_u32 s45, s45, 1048576
    s_lshl_b32 s61, s43, 12
    s_add_u32 s61, s61, s45
    s_add_u32 s61, s61, 638976
    s_lshl_b32 s48, s43, 9
    s_add_u32 s45, s45, s48
    s_add_u32 s40, s45, 81920
    v_lshlrev_b32 v60, 2, v4
    v_mov_b32 v61, v7
    v_add_u32 v0, 0x10000, v3
    v_add_u32 v1, 0x20000, v3
    v_lshlrev_b32 v7, 5, v5
    v_add_u32 v7, 161792, v7
    ds_read_b128 v[8:11], v3 offset:53248
    ds_read_b128 v[12:15], v3 offset:54272
    ds_read_b128 v[16:19], v3 offset:55296
    ds_read_b128 v[20:23], v3 offset:56320
    ds_read_b128 v[24:27], v3 offset:49152
    ds_read_b128 v[28:31], v3 offset:50176
    ds_read_b128 v[32:35], v3 offset:51200
    s_mov_b32 s48, 30000
pl_83:
    buffer_load_dword v62, v60, s[12:15], s47 offen sc1
    s_waitcnt vmcnt(0)
pc_84:
    v_cmp_ne_u32 vcc, s26, v62
    s_nop 0
    s_cmp_eq_u64 vcc, 0
    s_cbranch_scc1 pdn_85
    s_sleep 1
    s_sub_u32 s48, s48, 1
    s_cbranch_scc0 pl_83
pdn_85:
    s_cmp_eq_u32 s27, 0
    s_cbranch_scc1 pi_86
    buffer_inv sc1
    s_waitcnt vmcnt(0)
pi_86:
    buffer_load_dwordx4 v[176:179], v6, s[12:15], s40 offen offset:0 sc1
    buffer_load_dwordx4 v[180:183], v6, s[12:15], s40 offen offset:256 sc1
    s_add_u32 s40, s40, 4096
    buffer_load_dwordx4 v[184:187], v6, s[12:15], s40 offen offset:0 sc1
    buffer_load_dwordx4 v[188:191], v6, s[12:15], s40 offen offset:256 sc1
    s_add_u32 s40, s40, 4096
    buffer_load_dwordx4 v[192:195], v6, s[12:15], s40 offen offset:0 sc1
    buffer_load_dwordx4 v[196:199], v6, s[12:15], s40 offen offset:256 sc1
    s_add_u32 s40, s40, 4096
    buffer_load_dwordx4 v[200:203], v6, s[12:15], s40 offen offset:0 sc1
    buffer_load_dwordx4 v[204:207], v6, s[12:15], s40 offen offset:256 sc1
    s_add_u32 s40, s40, 4096
    s_waitcnt vmcnt(6)
    s_waitcnt lgkmcnt(5)
    v_mfma_f32_16x16x32_bf16 v[64:67], v[8:11], v[176:179], 0
    ds_read_b128 v[36:39], v3 offset:52224
    buffer_load_dwordx4 v[208:211], v6, s[12:15], s40 offen offset:0 sc1
    v_mfma_f32_16x16x32_bf16 v[68:71], v[8:11], v[180:183], 0
    buffer_load_dwordx4 v[212:215], v6, s[12:15], s40 offen offset:256 sc1
    s_add_u32 s40, s40, 4096
    v_mfma_f32_16x16x32_bf16 v[72:75], v[12:15], v[176:179], 0
    ds_read_b128 v[8:11], v3 offset:45056
    v_mfma_f32_16x16x32_bf16 v[76:79], v[12:15], v[180:183], 0
    s_waitcnt lgkmcnt(5)
    v_mfma_f32_16x16x32_bf16 v[80:83], v[16:19], v[176:179], 0
    ds_read_b128 v[12:15], v3 offset:46080
    v_mov_b32 v53, v60
    v_mfma_f32_16x16x32_bf16 v[84:87], v[16:19], v[180:183], 0
    v_mov_b32 v55, v61
    s_lshr_b32 s41, s25, 1
    v_mfma_f32_16x16x32_bf16 v[88:91], v[20:23], v[176:179], 0
    ds_read_b128 v[16:19], v3 offset:47104
    s_lshl_b32 s48, s41, 12
    v_mfma_f32_16x16x32_bf16 v[92:95], v[20:23], v[180:183], 0
    s_add_u32 s53, s45, s48
    s_add_u32 s54, s53, 311296
    s_waitcnt vmcnt(6)
    s_waitcnt lgkmcnt(5)
    v_mfma_f32_16x16x32_bf16 v[64:67], v[24:27], v[184:187], v[64:67]
    ds_read_b128 v[20:23], v3 offset:48128
    buffer_load_dwordx4 v[216:219], v6, s[12:15], s40 offen offset:0 sc1
    v_mfma_f32_16x16x32_bf16 v[68:71], v[24:27], v[188:191], v[68:71]
    buffer_load_dwordx4 v[220:223], v6, s[12:15], s40 offen offset:256 sc1
    s_add_u32 s40, s40, 4096
    v_mfma_f32_16x16x32_bf16 v[72:75], v[28:31], v[184:187], v[72:75]
    ds_read_b128 v[24:27], v3 offset:40960
    s_add_u32 s53, s53, 245760
    v_mfma_f32_16x16x32_bf16 v[76:79], v[28:31], v[188:191], v[76:79]
    s_lshr_b32 s48, s41, 3
    s_sub_u32 s49, s41, s48
    s_waitcnt lgkmcnt(5)
    v_mfma_f32_16x16x32_bf16 v[80:83], v[32:35], v[184:187], v[80:83]
    ds_read_b128 v[28:31], v3 offset:41984
    s_add_u32 s48, s48, 14
    v_mfma_f32_16x16x32_bf16 v[84:87], v[32:35], v[188:191], v[84:87]
    s_and_b32 s50, s41, 7
    s_add_u32 s50, s50, 1
    v_mfma_f32_16x16x32_bf16 v[88:91], v[36:39], v[184:187], v[88:91]
    ds_read_b128 v[32:35], v3 offset:43008
    s_lshr_b32 s50, s50, 3
    v_mfma_f32_16x16x32_bf16 v[92:95], v[36:39], v[188:191], v[92:95]
    s_sub_u32 s48, s48, s49
    s_mul_i32 s48, s48, s50
    s_waitcnt vmcnt(6)
    s_waitcnt lgkmcnt(5)
    v_mfma_f32_16x16x32_bf16 v[64:67], v[8:11], v[192:195], v[64:67]
    ds_read_b128 v[36:39], v3 offset:44032
    buffer_load_dwordx4 v[224:227], v6, s[12:15], s40 offen offset:0 sc1
    v_mfma_f32_16x16x32_bf16 v[68:71], v[8:11], v[196:199], v[68:71]
    buffer_load_dwordx4 v[228:231], v6, s[12:15], s40 offen offset:256 sc1
    s_add_u32 s40, s40, 4096
    v_mfma_f32_16x16x32_bf16 v[72:75], v[12:15], v[192:195], v[72:75]
    ds_read_b128 v[8:11], v3 offset:36864
    s_add_u32 s49, s49, s48
    v_mfma_f32_16x16x32_bf16 v[76:79], v[12:15], v[196:199], v[76:79]
    s_lshl_b32 s49, s49, 12
    s_add_u32 s55, s45, s49
    s_waitcnt lgkmcnt(5)
    v_mfma_f32_16x16x32_bf16 v[80:83], v[16:19], v[192:195], v[80:83]
    ds_read_b128 v[12:15], v3 offset:37888
    s_add_u32 s55, s55, 376832
    v_mfma_f32_16x16x32_bf16 v[84:87], v[16:19], v[196:199], v[84:87]
    s_lshl_b32 s48, s41, 11
    s_add_u32 s56, s45, s48
    v_mfma_f32_16x16x32_bf16 v[88:91], v[20:23], v[192:195], v[88:91]
    ds_read_b128 v[16:19], v3 offset:38912
    s_add_u32 s56, s56, 442368
    v_mfma_f32_16x16x32_bf16 v[92:95], v[20:23], v[196:199], v[92:95]
    s_lshl_b32 s57, s24, 11
    s_lshl_b32 s48, s43, 6
    s_waitcnt vmcnt(6)
    s_waitcnt lgkmcnt(5)
    v_mfma_f32_16x16x32_bf16 v[64:67], v[24:27], v[200:203], v[64:67]
    ds_read_b128 v[20:23], v3 offset:39936
    buffer_load_dwordx4 v[232:235], v6, s[12:15], s40 offen offset:0 sc1
    v_mfma_f32_16x16x32_bf16 v[68:71], v[24:27], v[204:207], v[68:71]
    buffer_load_dwordx4 v[236:239], v6, s[12:15], s40 offen offset:256 sc1
    s_add_u32 s40, s40, 4096
    v_mfma_f32_16x16x32_bf16 v[72:75], v[28:31], v[200:203], v[72:75]
    ds_read_b128 v[24:27], v3 offset:32768
    s_add_u32 s57, s57, s48
    v_mfma_f32_16x16x32_bf16 v[76:79], v[28:31], v[204:207], v[76:79]
    s_add_u32 s57, s57, 24576
    s_and_b32 s58, s25, 3
    s_waitcnt lgkmcnt(5)
    v_mfma_f32_16x16x32_bf16 v[80:83], v[32:35], v[200:203], v[80:83]
    ds_read_b128 v[28:31], v3 offset:33792
    s_lshl_b32 s58, s58, 7
    v_mfma_f32_16x16x32_bf16 v[84:87], v[32:35], v[204:207], v[84:87]
    s_add_u32 s58, s58, s57
    s_lshl_b32 s48, s44, 7
    v_mfma_f32_16x16x32_bf16 v[88:91], v[36:39], v[200:203], v[88:91]
    ds_read_b128 v[32:35], v3 offset:34816
    s_add_u32 s57, s57, s48
    v_mfma_f32_16x16x32_bf16 v[92:95], v[36:39], v[204:207], v[92:95]
    s_lshl_b32 s48, s41, 2
    s_add_u32 s57, s57, s48
    s_waitcnt vmcnt(6)
    s_waitcnt lgkmcnt(5)
    v_mfma_f32_16x16x32_bf16 v[64:67], v[8:11], v[208:211], v[64:67]
    ds_read_b128 v[36:39], v3 offset:35840
    buffer_load_dwordx4 v[240:243], v6, s[12:15], s40 offen offset:0 sc1
    v_mfma_f32_16x16x32_bf16 v[68:71], v[8:11], v[212:215], v[68:71]
    buffer_load_dwordx4 v[244:247], v6, s[12:15], s40 offen offset:256 sc1
    s_add_u32 s40, s40, 4096
    v_mfma_f32_16x16x32_bf16 v[72:75], v[12:15], v[208:211], v[72:75]
    ds_read_b128 v[8:11], v3 offset:28672
    s_and_b32 s45, s25, 3
    v_mfma_f32_16x16x32_bf16 v[76:79], v[12:15], v[212:215], v[76:79]
    s_lshl_b32 s46, s24, 2
    s_add_u32 s45, s45, s46
    s_waitcnt lgkmcnt(5)
    v_mfma_f32_16x16x32_bf16 v[80:83], v[16:19], v[208:211], v[80:83]
    ds_read_b128 v[12:15], v3 offset:29696
    s_mul_i32 s46, s45, 655360
    v_mfma_f32_16x16x32_bf16 v[84:87], v[16:19], v[212:215], v[84:87]
    s_add_u32 s46, s46, 1048576
    s_lshl_b32 s59, s43, 9
    v_mfma_f32_16x16x32_bf16 v[88:91], v[20:23], v[208:211], v[88:91]
    ds_read_b128 v[16:19], v3 offset:30720
    s_add_u32 s59, s59, s46
    v_mfma_f32_16x16x32_bf16 v[92:95], v[20:23], v[212:215], v[92:95]
    s_lshl_b32 s48, s42, 12
    s_add_u32 s59, s59, s48
    s_waitcnt vmcnt(6)
    s_waitcnt lgkmcnt(5)
    v_mfma_f32_16x16x32_bf16 v[64:67], v[24:27], v[216:219], v[64:67]
    ds_read_b128 v[20:23], v3 offset:31744
    buffer_load_dwordx4 v[248:251], v6, s[12:15], s40 offen offset:0 sc1
    v_mfma_f32_16x16x32_bf16 v[68:71], v[24:27], v[220:223], v[68:71]
    buffer_load_dwordx4 v[252:255], v6, s[12:15], s40 offen offset:256 sc1
    s_add_u32 s40, s40, 4096
    v_mfma_f32_16x16x32_bf16 v[72:75], v[28:31], v[216:219], v[72:75]
    ds_read_b128 v[24:27], v3 offset:24576
    s_lshl_b32 s48, s42, 8
    v_mfma_f32_16x16x32_bf16 v[76:79], v[28:31], v[220:223], v[76:79]
    v_add_u32 v51, s48, v6
    v_xor_b32 v52, 256, v51
    s_waitcnt lgkmcnt(5)
    v_mfma_f32_16x16x32_bf16 v[80:83], v[32:35], v[216:219], v[80:83]
    ds_read_b128 v[28:31], v3 offset:25600
    s_lshl_b32 s48, s42, 10
    v_mfma_f32_16x16x32_bf16 v[84:87], v[32:35], v[220:223], v[84:87]
    v_add_u32 v48, s48, v3
    v_add_u32 v49, 0x10000, v48
    v_mfma_f32_16x16x32_bf16 v[88:91], v[36:39], v[216:219], v[88:91]
    ds_read_b128 v[32:35], v3 offset:26624
    v_add_u32 v50, 0x20000, v48
    v_mfma_f32_16x16x32_bf16 v[92:95], v[36:39], v[220:223], v[92:95]
    s_lshl_b32 s44, s43, 1
    s_add_u32 s44, s44, s42
    s_waitcnt vmcnt(6)
    s_waitcnt lgkmcnt(5)
    v_mfma_f32_16x16x32_bf16 v[64:67], v[8:11], v[224:227], v[64:67]
    ds_read_b128 v[36:39], v3 offset:27648
    buffer_load_dwordx3 v[128:130], v3, s[12:15], s61 offen offset:0 sc1
    v_mfma_f32_16x16x32_bf16 v[68:71], v[8:11], v[228:231], v[68:71]
    buffer_load_dwordx3 v[132:134], v3, s[12:15], s61 offen offset:1024 sc1
    buffer_load_dwordx3 v[136:138], v3, s[12:15], s61 offen offset:2048 sc1
    v_mfma_f32_16x16x32_bf16 v[72:75], v[12:15], v[224:227], v[72:75]
    s_barrier
    ds_read_b128 v[8:11], v3 offset:20480
    v_mfma_f32_16x16x32_bf16 v[76:79], v[12:15], v[228:231], v[76:79]
    buffer_load_dwordx3 v[140:142], v3, s[12:15], s61 offen offset:3072 sc1
    s_lshr_b32 s41, s25, 2
    s_waitcnt lgkmcnt(5)
    v_mfma_f32_16x16x32_bf16 v[80:83], v[16:19], v[224:227], v[80:83]
    ds_read_b128 v[12:15], v3 offset:21504
    s_lshl_b32 s49, s44, 11
    v_mfma_f32_16x16x32_bf16 v[84:87], v[16:19], v[228:231], v[84:87]
    s_add_u32 s49, s49, s46
    s_add_u32 s49, s49, 638976
    v_mfma_f32_16x16x32_bf16 v[88:91], v[20:23], v[224:227], v[88:91]
    ds_read_b128 v[16:19], v3 offset:22528
    s_lshl_b32 s48, s44, 8
    v_mfma_f32_16x16x32_bf16 v[92:95], v[20:23], v[228:231], v[92:95]
    s_add_u32 s46, s46, s48
    s_mul_i32 s48, s41, 10240
    s_waitcnt vmcnt(8)
    s_waitcnt lgkmcnt(5)
    v_mfma_f32_16x16x32_bf16 v[64:67], v[24:27], v[232:235], v[64:67]
    ds_read_b128 v[20:23], v3 offset:23552
    s_add_u32 s48, s48, s46
    v_mfma_f32_16x16x32_bf16 v[68:71], v[24:27], v[236:239], v[68:71]
    s_add_u32 s48, s48, 81920
    s_add_u32 s50, s48, 4096
    v_mfma_f32_16x16x32_bf16 v[72:75], v[28:31], v[232:235], v[72:75]
    ds_read_b128 v[24:27], v3 offset:16384
    s_add_u32 s51, s48, 8192
    v_mfma_f32_16x16x32_bf16 v[76:79], v[28:31], v[236:239], v[76:79]
    s_mul_i32 s52, s3, 5120
    s_add_u32 s52, s52, 0
    s_waitcnt lgkmcnt(5)
    v_mfma_f32_16x16x32_bf16 v[80:83], v[32:35], v[232:235], v[80:83]
    ds_read_b128 v[28:31], v3 offset:17408
    v_add_u32 v57, s52, v3
    v_mfma_f32_16x16x32_bf16 v[84:87], v[32:35], v[236:239], v[84:87]
    s_xor_b32 s52, s3, 2
    s_mul_i32 s52, s52, 5120
    v_mfma_f32_16x16x32_bf16 v[88:91], v[36:39], v[232:235], v[88:91]
    ds_read_b128 v[32:35], v3 offset:18432
    s_add_u32 s52, s52, 0
    v_mfma_f32_16x16x32_bf16 v[92:95], v[36:39], v[236:239], v[92:95]
    v_add_u32 v58, s52, v3
    s_lshl_b32 s52, s45, 6
    s_waitcnt vmcnt(6)
    s_waitcnt lgkmcnt(5)
    v_mfma_f32_16x16x32_bf16 v[64:67], v[8:11], v[240:243], v[64:67]
    ds_read_b128 v[36:39], v3 offset:19456
    s_lshl_b32 s46, s44, 4
    v_mfma_f32_16x16x32_bf16 v[68:71], v[8:11], v[244:247], v[68:71]
    s_add_u32 s52, s52, s46
    s_mul_i32 s52, s52, 1280
    v_mfma_f32_16x16x32_bf16 v[72:75], v[12:15], v[240:243], v[72:75]
    ds_read_b128 v[8:11], v3 offset:12288
    s_mul_i32 s46, s41, 160
    v_mfma_f32_16x16x32_bf16 v[76:79], v[12:15], v[244:247], v[76:79]
    s_add_u32 s52, s52, s46
    v_and_b32 v60, 15, v2
    s_waitcnt lgkmcnt(5)
    v_mfma_f32_16x16x32_bf16 v[80:83], v[16:19], v[240:243], v[80:83]
    ds_read_b128 v[12:15], v3 offset:13312
    v_lshrrev_b32 v61, 4, v2
    v_mfma_f32_16x16x32_bf16 v[84:87], v[16:19], v[244:247], v[84:87]
    v_mul_u32_u24 v60, 1280, v60
    v_lshl_add_u32 v59, v61, 3, v60
    v_mfma_f32_16x16x32_bf16 v[88:91], v[20:23], v[240:243], v[88:91]
    ds_read_b128 v[16:19], v3 offset:14336
    v_lshl_add_u32 v60, v61, 4, v60
    v_mfma_f32_16x16x32_bf16 v[92:95], v[20:23], v[244:247], v[92:95]
    v_mov_b32 v63, s26
    s_waitcnt vmcnt(4)
    s_waitcnt lgkmcnt(5)
    v_mfma_f32_16x16x32_bf16 v[64:67], v[24:27], v[248:251], v[64:67]
    ds_read_b128 v[20:23], v3 offset:15360
    v_mfma_f32_16x16x32_bf16 v[68:71], v[24:27], v[252:255], v[68:71]
    v_mfma_f32_16x16x32_bf16 v[72:75], v[28:31], v[248:251], v[72:75]
    ds_read_b128 v[24:27], v3 offset:8192
    v_mfma_f32_16x16x32_bf16 v[76:79], v[28:31], v[252:255], v[76:79]
    s_waitcnt lgkmcnt(5)
    v_mfma_f32_16x16x32_bf16 v[80:83], v[32:35], v[248:251], v[80:83]
    ds_read_b128 v[28:31], v3 offset:9216
    v_mfma_f32_16x16x32_bf16 v[84:87], v[32:35], v[252:255], v[84:87]
    v_mfma_f32_16x16x32_bf16 v[88:91], v[36:39], v[248:251], v[88:91]
    ds_read_b128 v[32:35], v3 offset:10240
    v_mfma_f32_16x16x32_bf16 v[92:95], v[36:39], v[252:255], v[92:95]
    s_waitcnt lgkmcnt(5)
    v_mfma_f32_16x16x32_bf16 v[160:163], v[8:11], v[176:179], 0
    ds_read_b128 v[36:39], v3 offset:11264
    v_mfma_f32_16x16x32_bf16 v[164:167], v[8:11], v[180:183], 0
    v_mfma_f32_16x16x32_bf16 v[168:171], v[12:15], v[176:179], 0
    ds_read_b128 v[8:11], v3 offset:4096
    v_mfma_f32_16x16x32_bf16 v[172:175], v[12:15], v[180:183], 0
    s_waitcnt lgkmcnt(5)
    v_mfma_f32_16x16x32_bf16 v[160:163], v[16:19], v[184:187], v[160:163]
    ds_read_b128 v[12:15], v3 offset:5120
    v_mfma_f32_16x16x32_bf16 v[164:167], v[16:19], v[188:191], v[164:167]
    v_mfma_f32_16x16x32_bf16 v[168:171], v[20:23], v[184:187], v[168:171]
    ds_read_b128 v[16:19], v3 offset:6144
    v_mfma_f32_16x16x32_bf16 v[172:175], v[20:23], v[188:191], v[172:175]
    s_waitcnt lgkmcnt(5)
    v_mfma_f32_16x16x32_bf16 v[160:163], v[24:27], v[192:195], v[160:163]
    ds_read_b128 v[20:23], v3 offset:7168
    v_mfma_f32_16x16x32_bf16 v[164:167], v[24:27], v[196:199], v[164:167]
    v_mfma_f32_16x16x32_bf16 v[168:171], v[28:31], v[192:195], v[168:171]
    ds_read_b128 v[24:27], v3 offset:0
    v_mfma_f32_16x16x32_bf16 v[172:175], v[28:31], v[196:199], v[172:175]
    s_waitcnt lgkmcnt(5)
    v_mfma_f32_16x16x32_bf16 v[160:163], v[32:35], v[200:203], v[160:163]
    ds_read_b128 v[28:31], v3 offset:1024
    v_mfma_f32_16x16x32_bf16 v[164:167], v[32:35], v[204:207], v[164:167]
    v_mfma_f32_16x16x32_bf16 v[168:171], v[36:39], v[200:203], v[168:171]
    ds_read_b128 v[32:35], v3 offset:2048
    v_mfma_f32_16x16x32_bf16 v[172:175], v[36:39], v[204:207], v[172:175]
    s_waitcnt lgkmcnt(5)
    v_mfma_f32_16x16x32_bf16 v[160:163], v[8:11], v[208:211], v[160:163]
    ds_read_b128 v[36:39], v3 offset:3072
    v_mfma_f32_16x16x32_bf16 v[164:167], v[8:11], v[212:215], v[164:167]
    v_mfma_f32_16x16x32_bf16 v[168:171], v[12:15], v[208:211], v[168:171]
    s_barrier
    ds_read_b128 v[8:11], v3 offset:57344
    v_mfma_f32_16x16x32_bf16 v[172:175], v[12:15], v[212:215], v[172:175]
    s_waitcnt lgkmcnt(5)
    v_mfma_f32_16x16x32_bf16 v[160:163], v[16:19], v[216:219], v[160:163]
    ds_read_b128 v[12:15], v3 offset:58368
    s_waitcnt vmcnt(0)
    v_mfma_f32_16x16x32_bf16 v[164:167], v[16:19], v[220:223], v[164:167]
    v_xor_b32 v131, v130, v134
    v_xor_b32 v135, v138, v142
    v_xor_b32 v139, s26, v130
    v_xor_b32 v143, s26, v138
    v_or3_b32 v131, v131, v135, v139
    v_or_b32 v131, v131, v143
    v_cmp_ne_u32 vcc, 0, v131
    s_nop 0
    s_cmp_eq_u64 vcc, 0
    s_cbranch_scc0 L_stc_r
L_stc_d:
    v_add_f32 v128, v128, v132
    v_mfma_f32_16x16x32_bf16 v[168:171], v[20:23], v[216:219], v[168:171]
    ds_read_b128 v[16:19], v3 offset:59392
    v_add_f32 v129, v129, v133
    v_mfma_f32_16x16x32_bf16 v[172:175], v[20:23], v[220:223], v[172:175]
    v_mov_b32 v144, v128
    v_mov_b32 v145, v129
    s_waitcnt lgkmcnt(5)
    v_mfma_f32_16x16x32_bf16 v[160:163], v[24:27], v[224:227], v[160:163]
    ds_read_b128 v[20:23], v3 offset:60416
    v_permlane16_swap_b32 v128, v144
    v_mfma_f32_16x16x32_bf16 v[164:167], v[24:27], v[228:231], v[164:167]
    v_permlane16_swap_b32 v129, v145
    v_add_f32 v128, v128, v144
    v_mfma_f32_16x16x32_bf16 v[168:171], v[28:31], v[224:227], v[168:171]
    ds_read_b128 v[24:27], v3 offset:61440
    v_add_f32 v129, v129, v145
    v_mfma_f32_16x16x32_bf16 v[172:175], v[28:31], v[228:231], v[172:175]
    v_mov_b32 v144, v128
    v_mov_b32 v145, v129
    s_waitcnt lgkmcnt(5)
    v_mfma_f32_16x16x32_bf16 v[160:163], v[32:35], v[232:235], v[160:163]
    ds_read_b128 v[28:31], v3 offset:62464
    v_permlane32_swap_b32 v128, v144
    v_mfma_f32_16x16x32_bf16 v[164:167], v[32:35], v[236:239], v[164:167]
    v_permlane32_swap_b32 v129, v145
    v_add_f32 v128, v128, v144
    v_mfma_f32_16x16x32_bf16 v[168:171], v[36:39], v[232:235], v[168:171]
    ds_read_b128 v[32:35], v3 offset:63488
    v_add_f32 v129, v129, v145
    v_mfma_f32_16x16x32_bf16 v[172:175], v[36:39], v[236:239], v[172:175]
    v_mul_f32 v128, 986500301, v128
    v_cvt_pk_bf16_f32 v4, -v128, -v128
    s_waitcnt lgkmcnt(5)
    v_mfma_f32_16x16x32_bf16 v[160:163], v[8:11], v[240:243], v[160:163]
    ds_read_b128 v[36:39], v3 offset:64512
    v_and_b32 v4, 0xffff0000, v4
    v_mfma_f32_16x16x32_bf16 v[164:167], v[8:11], v[244:247], v[164:167]
    v_add_f32 v136, v136, v140
    v_add_f32 v137, v137, v141
    v_mfma_f32_16x16x32_bf16 v[168:171], v[12:15], v[240:243], v[168:171]
    ds_read_b128 v[8:11], v0 offset:0
    v_mov_b32 v144, v136
    v_mfma_f32_16x16x32_bf16 v[172:175], v[12:15], v[244:247], v[172:175]
    v_mov_b32 v145, v137
    v_permlane16_swap_b32 v136, v144
    s_waitcnt lgkmcnt(5)
    v_mfma_f32_16x16x32_bf16 v[160:163], v[16:19], v[248:251], v[160:163]
    ds_read_b128 v[12:15], v0 offset:1024
    v_permlane16_swap_b32 v137, v145
    v_mfma_f32_16x16x32_bf16 v[164:167], v[16:19], v[252:255], v[164:167]
    v_add_f32 v136, v136, v144
    v_add_f32 v137, v137, v145
    v_mfma_f32_16x16x32_bf16 v[168:171], v[20:23], v[248:251], v[168:171]
    ds_read_b128 v[16:19], v0 offset:2048
    v_mov_b32 v144, v136
    v_mfma_f32_16x16x32_bf16 v[172:175], v[20:23], v[252:255], v[172:175]
    v_mov_b32 v145, v137
    v_permlane32_swap_b32 v136, v144
    s_waitcnt lgkmcnt(5)
    v_mfma_f32_16x16x32_bf16 v[96:99], v[24:27], v[176:179], 0
    ds_read_b128 v[20:23], v0 offset:3072
    v_permlane32_swap_b32 v137, v145
    v_mfma_f32_16x16x32_bf16 v[100:103], v[24:27], v[180:183], 0
    v_add_f32 v136, v136, v144
    v_add_f32 v137, v137, v145
    v_mfma_f32_16x16x32_bf16 v[104:107], v[28:31], v[176:179], 0
    ds_read_b128 v[24:27], v0 offset:4096
    v_mul_f32 v136, 986500301, v136
    v_mfma_f32_16x16x32_bf16 v[108:111], v[28:31], v[180:183], 0
    v_cvt_pk_bf16_f32 v5, -v136, -v136
    v_and_b32 v5, 0xffff0000, v5
    s_waitcnt lgkmcnt(5)
    v_mfma_f32_16x16x32_bf16 v[112:115], v[32:35], v[176:179], 0
    ds_read_b128 v[28:31], v0 offset:5120
    v_mfma_f32_16x16x32_bf16 v[116:119], v[32:35], v[180:183], 0
    v_mfma_f32_16x16x32_bf16 v[120:123], v[36:39], v[176:179], 0
    ds_read_b128 v[32:35], v0 offset:6144
    v_mfma_f32_16x16x32_bf16 v[124:127], v[36:39], v[180:183], 0
    s_waitcnt lgkmcnt(5)
    v_mfma_f32_16x16x32_bf16 v[96:99], v[8:11], v[184:187], v[96:99]
    ds_read_b128 v[36:39], v0 offset:7168
    v_mfma_f32_16x16x32_bf16 v[100:103], v[8:11], v[188:191], v[100:103]
    v_mfma_f32_16x16x32_bf16 v[104:107], v[12:15], v[184:187], v[104:107]
    ds_read_b128 v[8:11], v0 offset:8192
    v_mfma_f32_16x16x32_bf16 v[108:111], v[12:15], v[188:191], v[108:111]
    s_waitcnt lgkmcnt(5)
    v_mfma_f32_16x16x32_bf16 v[112:115], v[16:19], v[184:187], v[112:115]
    ds_read_b128 v[12:15], v0 offset:9216
    v_mfma_f32_16x16x32_bf16 v[116:119], v[16:19], v[188:191], v[116:119]
    v_mfma_f32_16x16x32_bf16 v[120:123], v[20:23], v[184:187], v[120:123]
    ds_read_b128 v[16:19], v0 offset:10240
    v_mfma_f32_16x16x32_bf16 v[124:127], v[20:23], v[188:191], v[124:127]
    s_waitcnt lgkmcnt(5)
    v_mfma_f32_16x16x32_bf16 v[96:99], v[24:27], v[192:195], v[96:99]
    ds_read_b128 v[20:23], v0 offset:11264
    v_mfma_f32_16x16x32_bf16 v[100:103], v[24:27], v[196:199], v[100:103]
    v_mfma_f32_16x16x32_bf16 v[104:107], v[28:31], v[192:195], v[104:107]
    ds_read_b128 v[24:27], v0 offset:12288
    v_mfma_f32_16x16x32_bf16 v[108:111], v[28:31], v[196:199], v[108:111]
    s_waitcnt lgkmcnt(5)
    v_mfma_f32_16x16x32_bf16 v[112:115], v[32:35], v[192:195], v[112:115]
    ds_read_b128 v[28:31], v0 offset:13312
    v_mfma_f32_16x16x32_bf16 v[116:119], v[32:35], v[196:199], v[116:119]
    v_mfma_f32_16x16x32_bf16 v[120:123], v[36:39], v[192:195], v[120:123]
    ds_read_b128 v[32:35], v0 offset:14336
    v_mfma_f32_16x16x32_bf16 v[124:127], v[36:39], v[196:199], v[124:127]
    s_waitcnt lgkmcnt(5)
    v_mfma_f32_16x16x32_bf16 v[96:99], v[8:11], v[200:203], v[96:99]
    ds_read_b128 v[36:39], v0 offset:15360
    v_mfma_f32_16x16x32_bf16 v[100:103], v[8:11], v[204:207], v[100:103]
    v_mfma_f32_16x16x32_bf16 v[104:107], v[12:15], v[200:203], v[104:107]
    s_barrier
    ds_read_b128 v[8:11], v0 offset:16384
    v_mfma_f32_16x16x32_bf16 v[108:111], v[12:15], v[204:207], v[108:111]
    s_waitcnt lgkmcnt(5)
    v_mfma_f32_16x16x32_bf16 v[112:115], v[16:19], v[200:203], v[112:115]
    ds_read_b128 v[12:15], v0 offset:17408
    v_mfma_f32_16x16x32_bf16 v[116:119], v[16:19], v[204:207], v[116:119]
    v_mfma_f32_16x16x32_bf16 v[120:123], v[20:23], v[200:203], v[120:123]
    ds_read_b128 v[16:19], v0 offset:18432
    v_mfma_f32_16x16x32_bf16 v[124:127], v[20:23], v[204:207], v[124:127]
    s_waitcnt lgkmcnt(5)
    v_mfma_f32_16x16x32_bf16 v[96:99], v[24:27], v[208:211], v[96:99]
    ds_read_b128 v[20:23], v0 offset:19456
    v_mfma_f32_16x16x32_bf16 v[100:103], v[24:27], v[212:215], v[100:103]
    v_mfma_f32_16x16x32_bf16 v[104:107], v[28:31], v[208:211], v[104:107]
    ds_read_b128 v[24:27], v0 offset:20480
    v_mfma_f32_16x16x32_bf16 v[108:111], v[28:31], v[212:215], v[108:111]
    s_waitcnt lgkmcnt(5)
    v_mfma_f32_16x16x32_bf16 v[112:115], v[32:35], v[208:211], v[112:115]
    ds_read_b128 v[28:31], v0 offset:21504
    v_mfma_f32_16x16x32_bf16 v[116:119], v[32:35], v[212:215], v[116:119]
    v_mfma_f32_16x16x32_bf16 v[120:123], v[36:39], v[208:211], v[120:123]
    ds_read_b128 v[32:35], v0 offset:22528
    v_mfma_f32_16x16x32_bf16 v[124:127], v[36:39], v[212:215], v[124:127]
    s_waitcnt lgkmcnt(5)
    v_mfma_f32_16x16x32_bf16 v[96:99], v[8:11], v[216:219], v[96:99]
    ds_read_b128 v[36:39], v0 offset:23552
    v_mfma_f32_16x16x32_bf16 v[100:103], v[8:11], v[220:223], v[100:103]
    v_mfma_f32_16x16x32_bf16 v[104:107], v[12:15], v[216:219], v[104:107]
    ds_read_b128 v[8:11], v0 offset:24576
    v_mfma_f32_16x16x32_bf16 v[108:111], v[12:15], v[220:223], v[108:111]
    s_waitcnt lgkmcnt(5)
    v_mfma_f32_16x16x32_bf16 v[112:115], v[16:19], v[216:219], v[112:115]
    ds_read_b128 v[12:15], v0 offset:25600
    v_mfma_f32_16x16x32_bf16 v[116:119], v[16:19], v[220:223], v[116:119]
    v_mfma_f32_16x16x32_bf16 v[120:123], v[20:23], v[216:219], v[120:123]
    ds_read_b128 v[16:19], v0 offset:26624
    v_mfma_f32_16x16x32_bf16 v[124:127], v[20:23], v[220:223], v[124:127]
    s_waitcnt lgkmcnt(5)
    v_mfma_f32_16x16x32_bf16 v[96:99], v[24:27], v[224:227], v[96:99]
    ds_read_b128 v[20:23], v0 offset:27648
    v_mfma_f32_16x16x32_bf16 v[100:103], v[24:27], v[228:231], v[100:103]
    v_mfma_f32_16x16x32_bf16 v[104:107], v[28:31], v[224:227], v[104:107]
    ds_read_b128 v[24:27], v0 offset:28672
    v_mfma_f32_16x16x32_bf16 v[108:111], v[28:31], v[228:231], v[108:111]
    s_waitcnt lgkmcnt(5)
    v_mfma_f32_16x16x32_bf16 v[112:115], v[32:35], v[224:227], v[112:115]
    ds_read_b128 v[28:31], v0 offset:29696
    v_mfma_f32_16x16x32_bf16 v[116:119], v[32:35], v[228:231], v[116:119]
    v_mfma_f32_16x16x32_bf16 v[120:123], v[36:39], v[224:227], v[120:123]
    ds_read_b128 v[32:35], v0 offset:30720
    v_mfma_f32_16x16x32_bf16 v[124:127], v[36:39], v[228:231], v[124:127]
    s_waitcnt lgkmcnt(5)
    v_mfma_f32_16x16x32_bf16 v[96:99], v[8:11], v[232:235], v[96:99]
    ds_read_b128 v[36:39], v0 offset:31744
    v_mfma_f32_16x16x32_bf16 v[100:103], v[8:11], v[236:239], v[100:103]
    v_mfma_f32_16x16x32_bf16 v[104:107], v[12:15], v[232:235], v[104:107]
    ds_read_b128 v[8:11], v0 offset:32768
    v_mfma_f32_16x16x32_bf16 v[108:111], v[12:15], v[236:239], v[108:111]
    s_waitcnt lgkmcnt(5)
    v_mfma_f32_16x16x32_bf16 v[112:115], v[16:19], v[232:235], v[112:115]
    ds_read_b128 v[12:15], v0 offset:33792
    v_mfma_f32_16x16x32_bf16 v[116:119], v[16:19], v[236:239], v[116:119]
    v_mfma_f32_16x16x32_bf16 v[120:123], v[20:23], v[232:235], v[120:123]
    ds_read_b128 v[16:19], v0 offset:34816
    v_mfma_f32_16x16x32_bf16 v[124:127], v[20:23], v[236:239], v[124:127]
    s_waitcnt lgkmcnt(5)
    v_mfma_f32_16x16x32_bf16 v[96:99], v[24:27], v[240:243], v[96:99]
    ds_read_b128 v[20:23], v0 offset:35840
    v_mfma_f32_16x16x32_bf16 v[100:103], v[24:27], v[244:247], v[100:103]
    v_mfma_f32_16x16x32_bf16 v[104:107], v[28:31], v[240:243], v[104:107]
    ds_read_b128 v[24:27], v0 offset:36864
    v_mfma_f32_16x16x32_bf16 v[108:111], v[28:31], v[244:247], v[108:111]
    s_waitcnt lgkmcnt(5)
    v_mfma_f32_16x16x32_bf16 v[112:115], v[32:35], v[240:243], v[112:115]
    ds_read_b128 v[28:31], v0 offset:37888
    v_mfma_f32_16x16x32_bf16 v[116:119], v[32:35], v[244:247], v[116:119]
    v_mfma_f32_16x16x32_bf16 v[120:123], v[36:39], v[240:243], v[120:123]
    ds_read_b128 v[32:35], v0 offset:38912
    v_mfma_f32_16x16x32_bf16 v[124:127], v[36:39], v[244:247], v[124:127]
    s_waitcnt lgkmcnt(5)
    v_mfma_f32_16x16x32_bf16 v[96:99], v[8:11], v[248:251], v[96:99]
    ds_read_b128 v[36:39], v0 offset:39936
    v_mfma_f32_16x16x32_bf16 v[100:103], v[8:11], v[252:255], v[100:103]
    v_mfma_f32_16x16x32_bf16 v[104:107], v[12:15], v[248:251], v[104:107]
    s_barrier
    ds_read_b128 v[8:11], v1 offset:24576
    v_mfma_f32_16x16x32_bf16 v[108:111], v[12:15], v[252:255], v[108:111]
    s_waitcnt lgkmcnt(5)
    v_mfma_f32_16x16x32_bf16 v[112:115], v[16:19], v[248:251], v[112:115]
    ds_read_b128 v[12:15], v1 offset:25600
    v_mfma_f32_16x16x32_bf16 v[116:119], v[16:19], v[252:255], v[116:119]
    v_mfma_f32_16x16x32_bf16 v[120:123], v[20:23], v[248:251], v[120:123]
    ds_read_b128 v[16:19], v1 offset:26624
    v_mfma_f32_16x16x32_bf16 v[124:127], v[20:23], v[252:255], v[124:127]
    s_waitcnt lgkmcnt(5)
    v_mfma_f32_16x16x32_bf16 v[128:131], v[24:27], v[176:179], 0
    ds_read_b128 v[20:23], v1 offset:27648
    v_mfma_f32_16x16x32_bf16 v[132:135], v[24:27], v[180:183], 0
    v_mfma_f32_16x16x32_bf16 v[136:139], v[28:31], v[176:179], 0
    ds_read_b128 v[24:27], v1 offset:20480
    v_mfma_f32_16x16x32_bf16 v[140:143], v[28:31], v[180:183], 0
    s_waitcnt lgkmcnt(5)
    v_mfma_f32_16x16x32_bf16 v[144:147], v[32:35], v[176:179], 0
    ds_read_b128 v[28:31], v1 offset:21504
    v_mfma_f32_16x16x32_bf16 v[148:151], v[32:35], v[180:183], 0
    v_mfma_f32_16x16x32_bf16 v[152:155], v[36:39], v[176:179], 0
    ds_read_b128 v[32:35], v1 offset:22528
    v_mfma_f32_16x16x32_bf16 v[156:159], v[36:39], v[180:183], 0
    s_waitcnt lgkmcnt(5)
    v_mfma_f32_16x16x32_bf16 v[128:131], v[8:11], v[184:187], v[128:131]
    ds_read_b128 v[36:39], v1 offset:23552
    buffer_load_dwordx4 v[176:179], v6, s[12:15], s40 offen offset:0 sc1
    v_mfma_f32_16x16x32_bf16 v[132:135], v[8:11], v[188:191], v[132:135]
    buffer_load_dwordx4 v[180:183], v6, s[12:15], s40 offen offset:256 sc1
    s_add_u32 s40, s40, 4096
    v_mfma_f32_16x16x32_bf16 v[136:139], v[12:15], v[184:187], v[136:139]
    ds_read_b128 v[8:11], v1 offset:16384
    v_mfma_f32_16x16x32_bf16 v[140:143], v[12:15], v[188:191], v[140:143]
    s_waitcnt lgkmcnt(5)
    v_mfma_f32_16x16x32_bf16 v[144:147], v[16:19], v[184:187], v[144:147]
    ds_read_b128 v[12:15], v1 offset:17408
    v_mfma_f32_16x16x32_bf16 v[148:151], v[16:19], v[188:191], v[148:151]
    v_mfma_f32_16x16x32_bf16 v[152:155], v[20:23], v[184:187], v[152:155]
    ds_read_b128 v[16:19], v1 offset:18432
    v_mfma_f32_16x16x32_bf16 v[156:159], v[20:23], v[188:191], v[156:159]
    s_waitcnt lgkmcnt(5)
    v_mfma_f32_16x16x32_bf16 v[128:131], v[24:27], v[192:195], v[128:131]
    ds_read_b128 v[20:23], v1 offset:19456
    buffer_load_dwordx4 v[184:187], v6, s[12:15], s40 offen offset:0 sc1
    v_mfma_f32_16x16x32_bf16 v[132:135], v[24:27], v[196:199], v[132:135]
    buffer_load_dwordx4 v[188:191], v6, s[12:15], s40 offen offset:256 sc1
    s_add_u32 s40, s40, 4096
    v_mfma_f32_16x16x32_bf16 v[136:139], v[28:31], v[192:195], v[136:139]
    ds_read_b128 v[24:27], v1 offset:12288
    v_mfma_f32_16x16x32_bf16 v[140:143], v[28:31], v[196:199], v[140:143]
    s_waitcnt lgkmcnt(5)
    v_mfma_f32_16x16x32_bf16 v[144:147], v[32:35], v[192:195], v[144:147]
    ds_read_b128 v[28:31], v1 offset:13312
    v_mfma_f32_16x16x32_bf16 v[148:151], v[32:35], v[196:199], v[148:151]
    v_mfma_f32_16x16x32_bf16 v[152:155], v[36:39], v[192:195], v[152:155]
    ds_read_b128 v[32:35], v1 offset:14336
    v_mfma_f32_16x16x32_bf16 v[156:159], v[36:39], v[196:199], v[156:159]
    s_waitcnt lgkmcnt(5)
    v_mfma_f32_16x16x32_bf16 v[128:131], v[8:11], v[200:203], v[128:131]
    ds_read_b128 v[36:39], v1 offset:15360
    buffer_load_dwordx4 v[192:195], v6, s[12:15], s40 offen offset:0 sc1
    v_mfma_f32_16x16x32_bf16 v[132:135], v[8:11], v[204:207], v[132:135]
    buffer_load_dwordx4 v[196:199], v6, s[12:15], s40 offen offset:256 sc1
    s_add_u32 s40, s40, 4096
    v_mfma_f32_16x16x32_bf16 v[136:139], v[12:15], v[200:203], v[136:139]
    ds_read_b128 v[8:11], v1 offset:8192
    v_mfma_f32_16x16x32_bf16 v[140:143], v[12:15], v[204:207], v[140:143]
    s_waitcnt lgkmcnt(5)
    v_mfma_f32_16x16x32_bf16 v[144:147], v[16:19], v[200:203], v[144:147]
    ds_read_b128 v[12:15], v1 offset:9216
    v_mfma_f32_16x16x32_bf16 v[148:151], v[16:19], v[204:207], v[148:151]
    v_mfma_f32_16x16x32_bf16 v[152:155], v[20:23], v[200:203], v[152:155]
    ds_read_b128 v[16:19], v1 offset:10240
    v_mfma_f32_16x16x32_bf16 v[156:159], v[20:23], v[204:207], v[156:159]
    s_waitcnt lgkmcnt(5)
    v_mfma_f32_16x16x32_bf16 v[128:131], v[24:27], v[208:211], v[128:131]
    ds_read_b128 v[20:23], v1 offset:11264
    buffer_load_dwordx4 v[200:203], v6, s[12:15], s40 offen offset:0 sc1
    v_mfma_f32_16x16x32_bf16 v[132:135], v[24:27], v[212:215], v[132:135]
    buffer_load_dwordx4 v[204:207], v6, s[12:15], s40 offen offset:256 sc1
    s_add_u32 s40, s40, 4096
    v_mfma_f32_16x16x32_bf16 v[136:139], v[28:31], v[208:211], v[136:139]
    ds_read_b128 v[24:27], v1 offset:4096
    v_mfma_f32_16x16x32_bf16 v[140:143], v[28:31], v[212:215], v[140:143]
    s_waitcnt lgkmcnt(5)
    v_mfma_f32_16x16x32_bf16 v[144:147], v[32:35], v[208:211], v[144:147]
    ds_read_b128 v[28:31], v1 offset:5120
    v_mfma_f32_16x16x32_bf16 v[148:151], v[32:35], v[212:215], v[148:151]
    v_mfma_f32_16x16x32_bf16 v[152:155], v[36:39], v[208:211], v[152:155]
    ds_read_b128 v[32:35], v1 offset:6144
    v_mfma_f32_16x16x32_bf16 v[156:159], v[36:39], v[212:215], v[156:159]
    s_waitcnt lgkmcnt(5)
    v_mfma_f32_16x16x32_bf16 v[128:131], v[8:11], v[216:219], v[128:131]
    ds_read_b128 v[36:39], v1 offset:7168
    buffer_load_dwordx4 v[208:211], v6, s[12:15], s40 offen offset:0 sc1
    v_mfma_f32_16x16x32_bf16 v[132:135], v[8:11], v[220:223], v[132:135]
    buffer_load_dwordx4 v[212:215], v6, s[12:15], s40 offen offset:256 sc1
    s_add_u32 s40, s40, 4096
    v_mfma_f32_16x16x32_bf16 v[136:139], v[12:15], v[216:219], v[136:139]
    s_barrier
    ds_read_b128 v[8:11], v1 offset:0
    v_mfma_f32_16x16x32_bf16 v[140:143], v[12:15], v[220:223], v[140:143]
    s_waitcnt lgkmcnt(5)
    v_mfma_f32_16x16x32_bf16 v[144:147], v[16:19], v[216:219], v[144:147]
    ds_read_b128 v[12:15], v1 offset:1024
    v_mfma_f32_16x16x32_bf16 v[148:151], v[16:19], v[220:223], v[148:151]
    v_mfma_f32_16x16x32_bf16 v[152:155], v[20:23], v[216:219], v[152:155]
    ds_read_b128 v[16:19], v1 offset:2048
    v_mfma_f32_16x16x32_bf16 v[156:159], v[20:23], v[220:223], v[156:159]
    s_waitcnt lgkmcnt(5)
    v_mfma_f32_16x16x32_bf16 v[128:131], v[24:27], v[224:227], v[128:131]
    ds_read_b128 v[20:23], v1 offset:3072
    buffer_load_dwordx4 v[216:219], v6, s[12:15], s40 offen offset:0 sc1
    v_mfma_f32_16x16x32_bf16 v[132:135], v[24:27], v[228:231], v[132:135]
    buffer_load_dwordx4 v[220:223], v6, s[12:15], s40 offen offset:256 sc1
    s_add_u32 s40, s40, 4096
    v_mfma_f32_16x16x32_bf16 v[136:139], v[28:31], v[224:227], v[136:139]
    ds_read_b128 v[24:27], v0 offset:61440
    v_mfma_f32_16x16x32_bf16 v[140:143], v[28:31], v[228:231], v[140:143]
    s_waitcnt lgkmcnt(5)
    v_mfma_f32_16x16x32_bf16 v[144:147], v[32:35], v[224:227], v[144:147]
    ds_read_b128 v[28:31], v0 offset:62464
    v_mfma_f32_16x16x32_bf16 v[148:151], v[32:35], v[228:231], v[148:151]
    v_mfma_f32_16x16x32_bf16 v[152:155], v[36:39], v[224:227], v[152:155]
    ds_read_b128 v[32:35], v0 offset:63488
    v_mfma_f32_16x16x32_bf16 v[156:159], v[36:39], v[228:231], v[156:159]
    s_waitcnt lgkmcnt(5)
    v_mfma_f32_16x16x32_bf16 v[128:131], v[8:11], v[232:235], v[128:131]
    ds_read_b128 v[36:39], v0 offset:64512
    buffer_load_dwordx4 v[224:227], v6, s[12:15], s40 offen offset:0 sc1
    v_mfma_f32_16x16x32_bf16 v[132:135], v[8:11], v[236:239], v[132:135]
    buffer_load_dwordx4 v[228:231], v6, s[12:15], s40 offen offset:256 sc1
    s_add_u32 s40, s40, 4096
    v_mfma_f32_16x16x32_bf16 v[136:139], v[12:15], v[232:235], v[136:139]
    ds_read_b128 v[8:11], v0 offset:57344
    v_mfma_f32_16x16x32_bf16 v[140:143], v[12:15], v[236:239], v[140:143]
    s_waitcnt lgkmcnt(5)
    v_mfma_f32_16x16x32_bf16 v[144:147], v[16:19], v[232:235], v[144:147]
    ds_read_b128 v[12:15], v0 offset:58368
    v_mfma_f32_16x16x32_bf16 v[148:151], v[16:19], v[236:239], v[148:151]
    v_mfma_f32_16x16x32_bf16 v[152:155], v[20:23], v[232:235], v[152:155]
    ds_read_b128 v[16:19], v0 offset:59392
    v_mfma_f32_16x16x32_bf16 v[156:159], v[20:23], v[236:239], v[156:159]
    s_waitcnt lgkmcnt(5)
    v_mfma_f32_16x16x32_bf16 v[128:131], v[24:27], v[240:243], v[128:131]
    ds_read_b128 v[20:23], v0 offset:60416
    buffer_load_dwordx4 v[232:235], v6, s[12:15], s40 offen offset:0 sc1
    v_mfma_f32_16x16x32_bf16 v[132:135], v[24:27], v[244:247], v[132:135]
    buffer_load_dwordx4 v[236:239], v6, s[12:15], s40 offen offset:256 sc1
    s_add_u32 s40, s40, 4096
    v_mfma_f32_16x16x32_bf16 v[136:139], v[28:31], v[240:243], v[136:139]
    ds_read_b128 v[24:27], v0 offset:53248
    v_mfma_f32_16x16x32_bf16 v[140:143], v[28:31], v[244:247], v[140:143]
    s_waitcnt lgkmcnt(5)
    v_mfma_f32_16x16x32_bf16 v[144:147], v[32:35], v[240:243], v[144:147]
    ds_read_b128 v[28:31], v0 offset:54272
    v_mfma_f32_16x16x32_bf16 v[148:151], v[32:35], v[244:247], v[148:151]
    v_mfma_f32_16x16x32_bf16 v[152:155], v[36:39], v[240:243], v[152:155]
    ds_read_b128 v[32:35], v0 offset:55296
    v_mfma_f32_16x16x32_bf16 v[156:159], v[36:39], v[244:247], v[156:159]
    s_waitcnt lgkmcnt(5)
    v_mfma_f32_16x16x32_bf16 v[128:131], v[8:11], v[248:251], v[128:131]
    ds_read_b128 v[36:39], v0 offset:56320
    buffer_load_dwordx4 v[240:243], v6, s[12:15], s40 offen offset:0 sc1
    v_mfma_f32_16x16x32_bf16 v[132:135], v[8:11], v[252:255], v[132:135]
    buffer_load_dwordx4 v[244:247], v6, s[12:15], s40 offen offset:256 sc1
    s_add_u32 s40, s40, 4096
    v_mfma_f32_16x16x32_bf16 v[136:139], v[12:15], v[248:251], v[136:139]
    ds_read_b128 v[8:11], v0 offset:49152
    v_mfma_f32_16x16x32_bf16 v[140:143], v[12:15], v[252:255], v[140:143]
    s_waitcnt lgkmcnt(5)
    v_mfma_f32_16x16x32_bf16 v[144:147], v[16:19], v[248:251], v[144:147]
    ds_read_b128 v[12:15], v0 offset:50176
    v_mfma_f32_16x16x32_bf16 v[148:151], v[16:19], v[252:255], v[148:151]
    v_mfma_f32_16x16x32_bf16 v[152:155], v[20:23], v[248:251], v[152:155]
    ds_read_b128 v[16:19], v0 offset:51200
    v_mfma_f32_16x16x32_bf16 v[156:159], v[20:23], v[252:255], v[156:159]
    s_waitcnt vmcnt(16)
    s_waitcnt lgkmcnt(5)
    v_mfma_f32_16x16x32_bf16 v[64:67], v[24:27], v[176:179], v[64:67]
    ds_read_b128 v[20:23], v0 offset:52224
    buffer_load_dwordx4 v[248:251], v6, s[12:15], s40 offen offset:0 sc1
    v_mfma_f32_16x16x32_bf16 v[68:71], v[24:27], v[180:183], v[68:71]
    buffer_load_dwordx4 v[252:255], v6, s[12:15], s40 offen offset:256 sc1
    s_add_u32 s40, s40, 4096
    v_mfma_f32_16x16x32_bf16 v[72:75], v[28:31], v[176:179], v[72:75]
    ds_read_b128 v[24:27], v0 offset:45056
    v_mfma_f32_16x16x32_bf16 v[76:79], v[28:31], v[180:183], v[76:79]
    s_waitcnt lgkmcnt(5)
    v_mfma_f32_16x16x32_bf16 v[80:83], v[32:35], v[176:179], v[80:83]
    ds_read_b128 v[28:31], v0 offset:46080
    v_mfma_f32_16x16x32_bf16 v[84:87], v[32:35], v[180:183], v[84:87]
    v_mfma_f32_16x16x32_bf16 v[88:91], v[36:39], v[176:179], v[88:91]
    ds_read_b128 v[32:35], v0 offset:47104
    v_mfma_f32_16x16x32_bf16 v[92:95], v[36:39], v[180:183], v[92:95]
    s_waitcnt vmcnt(16)
    s_waitcnt lgkmcnt(5)
    v_mfma_f32_16x16x32_bf16 v[64:67], v[8:11], v[184:187], v[64:67]
    ds_read_b128 v[36:39], v0 offset:48128
    v_mfma_f32_16x16x32_bf16 v[68:71], v[8:11], v[188:191], v[68:71]
    v_mfma_f32_16x16x32_bf16 v[72:75], v[12:15], v[184:187], v[72:75]
    s_barrier
    ds_read_b128 v[8:11], v0 offset:40960
    v_mfma_f32_16x16x32_bf16 v[76:79], v[12:15], v[188:191], v[76:79]
    s_waitcnt lgkmcnt(5)
    v_mfma_f32_16x16x32_bf16 v[80:83], v[16:19], v[184:187], v[80:83]
    ds_read_b128 v[12:15], v0 offset:41984
    v_mfma_f32_16x16x32_bf16 v[84:87], v[16:19], v[188:191], v[84:87]
    v_mfma_f32_16x16x32_bf16 v[88:91], v[20:23], v[184:187], v[88:91]
    ds_read_b128 v[16:19], v0 offset:43008
    v_mfma_f32_16x16x32_bf16 v[92:95], v[20:23], v[188:191], v[92:95]
    s_waitcnt vmcnt(14)
    s_waitcnt lgkmcnt(5)
    v_mfma_f32_16x16x32_bf16 v[64:67], v[24:27], v[192:195], v[64:67]
    ds_read_b128 v[20:23], v0 offset:44032
    v_mfma_f32_16x16x32_bf16 v[68:71], v[24:27], v[196:199], v[68:71]
    v_mfma_f32_16x16x32_bf16 v[72:75], v[28:31], v[192:195], v[72:75]
    ds_read_b128 v[24:27], v0 offset:4096
    v_mfma_f32_16x16x32_bf16 v[76:79], v[28:31], v[196:199], v[76:79]
    s_waitcnt lgkmcnt(5)
    v_mfma_f32_16x16x32_bf16 v[80:83], v[32:35], v[192:195], v[80:83]
    ds_read_b128 v[28:31], v0 offset:5120
    v_mfma_f32_16x16x32_bf16 v[84:87], v[32:35], v[196:199], v[84:87]
    v_mfma_f32_16x16x32_bf16 v[88:91], v[36:39], v[192:195], v[88:91]
    ds_read_b128 v[32:35], v0 offset:6144
    v_mfma_f32_16x16x32_bf16 v[92:95], v[36:39], v[196:199], v[92:95]
    s_waitcnt vmcnt(12)
    s_waitcnt lgkmcnt(5)
    v_mfma_f32_16x16x32_bf16 v[64:67], v[8:11], v[200:203], v[64:67]
    ds_read_b128 v[36:39], v0 offset:7168
    v_mfma_f32_16x16x32_bf16 v[68:71], v[8:11], v[204:207], v[68:71]
    v_mfma_f32_16x16x32_bf16 v[72:75], v[12:15], v[200:203], v[72:75]
    ds_read_b128 v[8:11], v0 offset:0
    v_mfma_f32_16x16x32_bf16 v[76:79], v[12:15], v[204:207], v[76:79]
    s_waitcnt lgkmcnt(5)
    v_mfma_f32_16x16x32_bf16 v[80:83], v[16:19], v[200:203], v[80:83]
    ds_read_b128 v[12:15], v0 offset:1024
    v_mfma_f32_16x16x32_bf16 v[84:87], v[16:19], v[204:207], v[84:87]
    v_mfma_f32_16x16x32_bf16 v[88:91], v[20:23], v[200:203], v[88:91]
    ds_read_b128 v[16:19], v0 offset:2048
    v_mfma_f32_16x16x32_bf16 v[92:95], v[20:23], v[204:207], v[92:95]
    s_waitcnt vmcnt(10)
    s_waitcnt lgkmcnt(5)
    v_mfma_f32_16x16x32_bf16 v[64:67], v[24:27], v[208:211], v[64:67]
    ds_read_b128 v[20:23], v0 offset:3072
    v_mfma_f32_16x16x32_bf16 v[68:71], v[24:27], v[212:215], v[68:71]
    v_mfma_f32_16x16x32_bf16 v[72:75], v[28:31], v[208:211], v[72:75]
    ds_read_b128 v[24:27], v3 offset:61440
    v_mfma_f32_16x16x32_bf16 v[76:79], v[28:31], v[212:215], v[76:79]
    s_waitcnt lgkmcnt(5)
    v_mfma_f32_16x16x32_bf16 v[80:83], v[32:35], v[208:211], v[80:83]
    ds_read_b128 v[28:31], v3 offset:62464
    v_mfma_f32_16x16x32_bf16 v[84:87], v[32:35], v[212:215], v[84:87]
    v_mfma_f32_16x16x32_bf16 v[88:91], v[36:39], v[208:211], v[88:91]
    ds_read_b128 v[32:35], v3 offset:63488
    v_mfma_f32_16x16x32_bf16 v[92:95], v[36:39], v[212:215], v[92:95]
    s_waitcnt vmcnt(8)
    s_waitcnt lgkmcnt(5)
    v_mfma_f32_16x16x32_bf16 v[64:67], v[8:11], v[216:219], v[64:67]
    ds_read_b128 v[36:39], v3 offset:64512
    v_mfma_f32_16x16x32_bf16 v[68:71], v[8:11], v[220:223], v[68:71]
    v_mfma_f32_16x16x32_bf16 v[72:75], v[12:15], v[216:219], v[72:75]
    ds_read_b128 v[8:11], v3 offset:57344
    v_mfma_f32_16x16x32_bf16 v[76:79], v[12:15], v[220:223], v[76:79]
    s_waitcnt lgkmcnt(5)
    v_mfma_f32_16x16x32_bf16 v[80:83], v[16:19], v[216:219], v[80:83]
    ds_read_b128 v[12:15], v3 offset:58368
    v_mfma_f32_16x16x32_bf16 v[84:87], v[16:19], v[220:223], v[84:87]
    v_mfma_f32_16x16x32_bf16 v[88:91], v[20:23], v[216:219], v[88:91]
    ds_read_b128 v[16:19], v3 offset:59392
    v_mfma_f32_16x16x32_bf16 v[92:95], v[20:23], v[220:223], v[92:95]
    s_waitcnt vmcnt(6)
    s_waitcnt lgkmcnt(5)
    v_mfma_f32_16x16x32_bf16 v[64:67], v[24:27], v[224:227], v[64:67]
    ds_read_b128 v[20:23], v3 offset:60416
    v_mfma_f32_16x16x32_bf16 v[68:71], v[24:27], v[228:231], v[68:71]
    v_mfma_f32_16x16x32_bf16 v[72:75], v[28:31], v[224:227], v[72:75]
    ds_read_b128 v[24:27], v3 offset:53248
    v_mfma_f32_16x16x32_bf16 v[76:79], v[28:31], v[228:231], v[76:79]
    s_waitcnt lgkmcnt(5)
    v_mfma_f32_16x16x32_bf16 v[80:83], v[32:35], v[224:227], v[80:83]
    ds_read_b128 v[28:31], v3 offset:54272
    v_mfma_f32_16x16x32_bf16 v[84:87], v[32:35], v[228:231], v[84:87]
    v_mfma_f32_16x16x32_bf16 v[88:91], v[36:39], v[224:227], v[88:91]
    ds_read_b128 v[32:35], v3 offset:55296
    v_mfma_f32_16x16x32_bf16 v[92:95], v[36:39], v[228:231], v[92:95]
    s_waitcnt vmcnt(4)
    s_waitcnt lgkmcnt(5)
    v_mfma_f32_16x16x32_bf16 v[64:67], v[8:11], v[232:235], v[64:67]
    ds_read_b128 v[36:39], v3 offset:56320
    v_mfma_f32_16x16x32_bf16 v[68:71], v[8:11], v[236:239], v[68:71]
    v_mfma_f32_16x16x32_bf16 v[72:75], v[12:15], v[232:235], v[72:75]
    s_barrier
    ds_read_b128 v[8:11], v3 offset:49152
    v_mfma_f32_16x16x32_bf16 v[76:79], v[12:15], v[236:239], v[76:79]
    s_waitcnt lgkmcnt(5)
    v_mfma_f32_16x16x32_bf16 v[80:83], v[16:19], v[232:235], v[80:83]
    ds_read_b128 v[12:15], v3 offset:50176
    v_mfma_f32_16x16x32_bf16 v[84:87], v[16:19], v[236:239], v[84:87]
    v_mfma_f32_16x16x32_bf16 v[88:91], v[20:23], v[232:235], v[88:91]
    ds_read_b128 v[16:19], v3 offset:51200
    v_mfma_f32_16x16x32_bf16 v[92:95], v[20:23], v[236:239], v[92:95]
    s_waitcnt vmcnt(2)
    s_waitcnt lgkmcnt(5)
    v_mfma_f32_16x16x32_bf16 v[64:67], v[24:27], v[240:243], v[64:67]
    ds_read_b128 v[20:23], v3 offset:52224
    v_mfma_f32_16x16x32_bf16 v[68:71], v[24:27], v[244:247], v[68:71]
    v_mfma_f32_16x16x32_bf16 v[72:75], v[28:31], v[240:243], v[72:75]
    ds_read_b128 v[24:27], v0 offset:28672
    v_mfma_f32_16x16x32_bf16 v[76:79], v[28:31], v[244:247], v[76:79]
    s_waitcnt lgkmcnt(5)
    v_mfma_f32_16x16x32_bf16 v[80:83], v[32:35], v[240:243], v[80:83]
    ds_read_b128 v[28:31], v0 offset:29696
    v_mfma_f32_16x16x32_bf16 v[84:87], v[32:35], v[244:247], v[84:87]
    v_mfma_f32_16x16x32_bf16 v[88:91], v[36:39], v[240:243], v[88:91]
    ds_read_b128 v[32:35], v0 offset:30720
    v_mfma_f32_16x16x32_bf16 v[92:95], v[36:39], v[244:247], v[92:95]
    s_waitcnt vmcnt(0)
    s_waitcnt lgkmcnt(5)
    v_mfma_f32_16x16x32_bf16 v[64:67], v[8:11], v[248:251], v[64:67]
    ds_read_b128 v[36:39], v0 offset:31744
    v_mfma_f32_16x16x32_bf16 v[68:71], v[8:11], v[252:255], v[68:71]
    v_mfma_f32_16x16x32_bf16 v[72:75], v[12:15], v[248:251], v[72:75]
    ds_read_b128 v[8:11], v0 offset:24576
    ds_read_b128 v[40:43], v7 offset:0
    v_mfma_f32_16x16x32_bf16 v[76:79], v[12:15], v[252:255], v[76:79]
    ds_read_b128 v[44:47], v7 offset:512
    s_waitcnt lgkmcnt(7)
    v_mfma_f32_16x16x32_bf16 v[80:83], v[16:19], v[248:251], v[80:83]
    ds_read_b128 v[12:15], v0 offset:25600
    v_mfma_f32_16x16x32_bf16 v[84:87], v[16:19], v[252:255], v[84:87]
    v_mfma_f32_16x16x32_bf16 v[88:91], v[20:23], v[248:251], v[88:91]
    ds_read_b128 v[16:19], v0 offset:26624
    v_mfma_f32_16x16x32_bf16 v[92:95], v[20:23], v[252:255], v[92:95]
    s_waitcnt lgkmcnt(7)
    v_mfma_f32_16x16x32_bf16 v[96:99], v[24:27], v[176:179], v[96:99]
    ds_read_b128 v[20:23], v0 offset:27648
    v_mfma_f32_16x16x32_bf16 v[100:103], v[24:27], v[180:183], v[100:103]
    v_mfma_f32_16x16x32_bf16 v[104:107], v[28:31], v[176:179], v[104:107]
    ds_read_b128 v[24:27], v0 offset:20480
    s_waitcnt lgkmcnt(4)
    v_fmac_f32 v64, v4, v40
    v_mfma_f32_16x16x32_bf16 v[108:111], v[28:31], v[180:183], v[108:111]
    v_fmac_f32 v65, v4, v41
    v_fmac_f32 v66, v4, v42
    v_mfma_f32_16x16x32_bf16 v[112:115], v[32:35], v[176:179], v[112:115]
    ds_read_b128 v[28:31], v0 offset:21504
    v_fmac_f32 v67, v4, v43
    v_mfma_f32_16x16x32_bf16 v[116:119], v[32:35], v[180:183], v[116:119]
    v_fmac_f32 v72, v4, v44
    v_fmac_f32 v73, v4, v45
    v_mfma_f32_16x16x32_bf16 v[120:123], v[36:39], v[176:179], v[120:123]
    ds_read_b128 v[32:35], v0 offset:22528
    v_fmac_f32 v74, v4, v46
    v_mfma_f32_16x16x32_bf16 v[124:127], v[36:39], v[180:183], v[124:127]
    v_fmac_f32 v75, v4, v47
    v_fmac_f32 v68, v5, v40
    s_waitcnt lgkmcnt(5)
    v_mfma_f32_16x16x32_bf16 v[96:99], v[8:11], v[184:187], v[96:99]
    ds_read_b128 v[36:39], v0 offset:23552
    v_fmac_f32 v69, v5, v41
    v_mfma_f32_16x16x32_bf16 v[100:103], v[8:11], v[188:191], v[100:103]
    v_fmac_f32 v70, v5, v42
    v_fmac_f32 v71, v5, v43
    v_mfma_f32_16x16x32_bf16 v[104:107], v[12:15], v[184:187], v[104:107]
    ds_read_b128 v[8:11], v0 offset:16384
    v_fmac_f32 v76, v5, v44
    v_mfma_f32_16x16x32_bf16 v[108:111], v[12:15], v[188:191], v[108:111]
    v_fmac_f32 v77, v5, v45
    v_fmac_f32 v78, v5, v46
    s_waitcnt lgkmcnt(5)
    v_mfma_f32_16x16x32_bf16 v[112:115], v[16:19], v[184:187], v[112:115]
    ds_read_b128 v[12:15], v0 offset:17408
    v_fmac_f32 v79, v5, v47
    v_mfma_f32_16x16x32_bf16 v[116:119], v[16:19], v[188:191], v[116:119]
    ds_read_b128 v[40:43], v7 offset:16
    ds_read_b128 v[44:47], v7 offset:528
    v_mfma_f32_16x16x32_bf16 v[120:123], v[20:23], v[184:187], v[120:123]
    ds_read_b128 v[16:19], v0 offset:18432
    v_max_f32 v64, 0, v64
    v_mfma_f32_16x16x32_bf16 v[124:127], v[20:23], v[188:191], v[124:127]
    v_max_f32 v65, 0, v65
    v_max_f32 v66, 0, v66
    s_waitcnt lgkmcnt(7)
    v_mfma_f32_16x16x32_bf16 v[96:99], v[24:27], v[192:195], v[96:99]
    ds_read_b128 v[20:23], v0 offset:19456
    v_max_f32 v67, 0, v67
    v_mfma_f32_16x16x32_bf16 v[100:103], v[24:27], v[196:199], v[100:103]
    v_mul_f32 v64, v64, v72
    v_mul_f32 v65, v65, v73
    v_mfma_f32_16x16x32_bf16 v[104:107], v[28:31], v[192:195], v[104:107]
    ds_read_b128 v[24:27], v1 offset:24576
    v_mul_f32 v66, v66, v74
    v_mfma_f32_16x16x32_bf16 v[108:111], v[28:31], v[196:199], v[108:111]
    v_mul_f32 v67, v67, v75
    v_cvt_pk_bf16_f32 v64, v64, v65
    s_waitcnt lgkmcnt(7)
    v_mfma_f32_16x16x32_bf16 v[112:115], v[32:35], v[192:195], v[112:115]
    ds_read_b128 v[28:31], v1 offset:25600
    v_cvt_pk_bf16_f32 v65, v66, v67
    v_mfma_f32_16x16x32_bf16 v[116:119], v[32:35], v[196:199], v[116:119]
    v_max_f32 v68, 0, v68
    v_max_f32 v69, 0, v69
    v_mfma_f32_16x16x32_bf16 v[120:123], v[36:39], v[192:195], v[120:123]
    ds_read_b128 v[32:35], v1 offset:26624
    v_max_f32 v70, 0, v70
    v_mfma_f32_16x16x32_bf16 v[124:127], v[36:39], v[196:199], v[124:127]
    v_max_f32 v71, 0, v71
    v_mul_f32 v68, v68, v76
    s_waitcnt lgkmcnt(7)
    v_mfma_f32_16x16x32_bf16 v[96:99], v[8:11], v[200:203], v[96:99]
    ds_read_b128 v[36:39], v1 offset:27648
    v_mul_f32 v69, v69, v77
    v_mfma_f32_16x16x32_bf16 v[100:103], v[8:11], v[204:207], v[100:103]
    v_mul_f32 v70, v70, v78
    v_mul_f32 v71, v71, v79
    v_mfma_f32_16x16x32_bf16 v[104:107], v[12:15], v[200:203], v[104:107]
    s_barrier
    ds_read_b128 v[8:11], v1 offset:20480
    v_mfma_f32_16x16x32_bf16 v[108:111], v[12:15], v[204:207], v[108:111]
    v_cvt_pk_bf16_f32 v68, v68, v69
    v_cvt_pk_bf16_f32 v69, v70, v71
    s_waitcnt lgkmcnt(5)
    v_mfma_f32_16x16x32_bf16 v[112:115], v[16:19], v[200:203], v[112:115]
    ds_read_b128 v[12:15], v1 offset:21504
    v_fmac_f32 v80, v4, v40
    v_mfma_f32_16x16x32_bf16 v[116:119], v[16:19], v[204:207], v[116:119]
    v_fmac_f32 v81, v4, v41
    v_fmac_f32 v82, v4, v42
    v_mfma_f32_16x16x32_bf16 v[120:123], v[20:23], v[200:203], v[120:123]
    ds_read_b128 v[16:19], v1 offset:22528
    v_fmac_f32 v83, v4, v43
    v_mfma_f32_16x16x32_bf16 v[124:127], v[20:23], v[204:207], v[124:127]
    v_fmac_f32 v88, v4, v44
    v_fmac_f32 v89, v4, v45
    s_waitcnt lgkmcnt(5)
    v_mfma_f32_16x16x32_bf16 v[96:99], v[24:27], v[208:211], v[96:99]
    ds_read_b128 v[20:23], v1 offset:23552
    v_fmac_f32 v90, v4, v46
    v_mfma_f32_16x16x32_bf16 v[100:103], v[24:27], v[212:215], v[100:103]
    v_fmac_f32 v91, v4, v47
    v_max_f32 v80, 0, v80
    v_mfma_f32_16x16x32_bf16 v[104:107], v[28:31], v[208:211], v[104:107]
    ds_read_b128 v[24:27], v1 offset:16384
    v_max_f32 v81, 0, v81
    v_mfma_f32_16x16x32_bf16 v[108:111], v[28:31], v[212:215], v[108:111]
    v_max_f32 v82, 0, v82
    v_max_f32 v83, 0, v83
    s_waitcnt lgkmcnt(5)
    v_mfma_f32_16x16x32_bf16 v[112:115], v[32:35], v[208:211], v[112:115]
    ds_read_b128 v[28:31], v1 offset:17408
    v_mul_f32 v80, v80, v88
    v_mfma_f32_16x16x32_bf16 v[116:119], v[32:35], v[212:215], v[116:119]
    v_mul_f32 v81, v81, v89
    v_mul_f32 v82, v82, v90
    v_mfma_f32_16x16x32_bf16 v[120:123], v[36:39], v[208:211], v[120:123]
    ds_read_b128 v[32:35], v1 offset:18432
    v_mul_f32 v83, v83, v91
    v_mfma_f32_16x16x32_bf16 v[124:127], v[36:39], v[212:215], v[124:127]
    v_cvt_pk_bf16_f32 v66, v80, v81
    v_cvt_pk_bf16_f32 v67, v82, v83
    s_waitcnt lgkmcnt(5)
    v_mfma_f32_16x16x32_bf16 v[96:99], v[8:11], v[216:219], v[96:99]
    ds_read_b128 v[36:39], v1 offset:19456
    buffer_store_dwordx4 v[64:67], v6, s[12:15], s53 offen offset:0 sc1
    v_mfma_f32_16x16x32_bf16 v[100:103], v[8:11], v[220:223], v[100:103]
    v_fmac_f32 v84, v5, v40
    v_fmac_f32 v85, v5, v41
    v_mfma_f32_16x16x32_bf16 v[104:107], v[12:15], v[216:219], v[104:107]
    ds_read_b128 v[8:11], v1 offset:12288
    v_fmac_f32 v86, v5, v42
    v_mfma_f32_16x16x32_bf16 v[108:111], v[12:15], v[220:223], v[108:111]
    v_fmac_f32 v87, v5, v43
    v_fmac_f32 v92, v5, v44
    s_waitcnt lgkmcnt(5)
    v_mfma_f32_16x16x32_bf16 v[112:115], v[16:19], v[216:219], v[112:115]
    ds_read_b128 v[12:15], v1 offset:13312
    v_fmac_f32 v93, v5, v45
    v_mfma_f32_16x16x32_bf16 v[116:119], v[16:19], v[220:223], v[116:119]
    v_fmac_f32 v94, v5, v46
    v_fmac_f32 v95, v5, v47
    v_mfma_f32_16x16x32_bf16 v[120:123], v[20:23], v[216:219], v[120:123]
    ds_read_b128 v[16:19], v1 offset:14336
    v_max_f32 v84, 0, v84
    v_mfma_f32_16x16x32_bf16 v[124:127], v[20:23], v[220:223], v[124:127]
    v_max_f32 v85, 0, v85
    v_max_f32 v86, 0, v86
    s_waitcnt lgkmcnt(5)
    v_mfma_f32_16x16x32_bf16 v[96:99], v[24:27], v[224:227], v[96:99]
    ds_read_b128 v[20:23], v1 offset:15360
    v_max_f32 v87, 0, v87
    v_mfma_f32_16x16x32_bf16 v[100:103], v[24:27], v[228:231], v[100:103]
    v_mul_f32 v84, v84, v92
    v_mul_f32 v85, v85, v93
    v_mfma_f32_16x16x32_bf16 v[104:107], v[28:31], v[224:227], v[104:107]
    ds_read_b128 v[24:27], v0 offset:36864
    v_mul_f32 v86, v86, v94
    v_mfma_f32_16x16x32_bf16 v[108:111], v[28:31], v[228:231], v[108:111]
    v_mul_f32 v87, v87, v95
    v_cvt_pk_bf16_f32 v70, v84, v85
    s_waitcnt lgkmcnt(5)
    v_mfma_f32_16x16x32_bf16 v[112:115], v[32:35], v[224:227], v[112:115]
    ds_read_b128 v[28:31], v0 offset:37888
    v_cvt_pk_bf16_f32 v71, v86, v87
    v_mfma_f32_16x16x32_bf16 v[116:119], v[32:35], v[228:231], v[116:119]
    buffer_store_dwordx4 v[68:71], v6, s[12:15], s53 offen offset:256 sc1
    v_mfma_f32_16x16x32_bf16 v[120:123], v[36:39], v[224:227], v[120:123]
    ds_read_b128 v[32:35], v0 offset:38912
    v_mfma_f32_16x16x32_bf16 v[124:127], v[36:39], v[228:231], v[124:127]
    s_waitcnt lgkmcnt(5)
    v_mfma_f32_16x16x32_bf16 v[96:99], v[8:11], v[232:235], v[96:99]
    ds_read_b128 v[36:39], v0 offset:39936
    v_mfma_f32_16x16x32_bf16 v[100:103], v[8:11], v[236:239], v[100:103]
    v_mfma_f32_16x16x32_bf16 v[104:107], v[12:15], v[232:235], v[104:107]
    ds_read_b128 v[8:11], v1 offset:8192
    v_mfma_f32_16x16x32_bf16 v[108:111], v[12:15], v[236:239], v[108:111]
    s_waitcnt lgkmcnt(5)
    v_mfma_f32_16x16x32_bf16 v[112:115], v[16:19], v[232:235], v[112:115]
    ds_read_b128 v[12:15], v1 offset:9216
    v_mfma_f32_16x16x32_bf16 v[116:119], v[16:19], v[236:239], v[116:119]
    v_mfma_f32_16x16x32_bf16 v[120:123], v[20:23], v[232:235], v[120:123]
    ds_read_b128 v[16:19], v1 offset:10240
    v_mfma_f32_16x16x32_bf16 v[124:127], v[20:23], v[236:239], v[124:127]
    s_waitcnt lgkmcnt(5)
    v_mfma_f32_16x16x32_bf16 v[96:99], v[24:27], v[240:243], v[96:99]
    ds_read_b128 v[20:23], v1 offset:11264
    v_mfma_f32_16x16x32_bf16 v[100:103], v[24:27], v[244:247], v[100:103]
    v_mfma_f32_16x16x32_bf16 v[104:107], v[28:31], v[240:243], v[104:107]
    ds_read_b128 v[24:27], v1 offset:4096
    v_mfma_f32_16x16x32_bf16 v[108:111], v[28:31], v[244:247], v[108:111]
    s_waitcnt lgkmcnt(5)
    v_mfma_f32_16x16x32_bf16 v[112:115], v[32:35], v[240:243], v[112:115]
    ds_read_b128 v[28:31], v1 offset:5120
    v_mfma_f32_16x16x32_bf16 v[116:119], v[32:35], v[244:247], v[116:119]
    v_mfma_f32_16x16x32_bf16 v[120:123], v[36:39], v[240:243], v[120:123]
    ds_read_b128 v[32:35], v1 offset:6144
    v_mfma_f32_16x16x32_bf16 v[124:127], v[36:39], v[244:247], v[124:127]
    s_waitcnt lgkmcnt(5)
    v_mfma_f32_16x16x32_bf16 v[96:99], v[8:11], v[248:251], v[96:99]
    ds_read_b128 v[36:39], v1 offset:7168
    v_mfma_f32_16x16x32_bf16 v[100:103], v[8:11], v[252:255], v[100:103]
    v_mfma_f32_16x16x32_bf16 v[104:107], v[12:15], v[248:251], v[104:107]
    s_barrier
    ds_read_b128 v[8:11], v1 offset:0
    v_mfma_f32_16x16x32_bf16 v[108:111], v[12:15], v[252:255], v[108:111]
    ds_read_b128 v[40:43], v7 offset:128
    ds_read_b128 v[44:47], v7 offset:640
    s_waitcnt lgkmcnt(7)
    v_mfma_f32_16x16x32_bf16 v[112:115], v[16:19], v[248:251], v[112:115]
    ds_read_b128 v[12:15], v1 offset:1024
    v_mfma_f32_16x16x32_bf16 v[116:119], v[16:19], v[252:255], v[116:119]
    v_mfma_f32_16x16x32_bf16 v[120:123], v[20:23], v[248:251], v[120:123]
    ds_read_b128 v[16:19], v1 offset:2048
    v_mfma_f32_16x16x32_bf16 v[124:127], v[20:23], v[252:255], v[124:127]
    s_waitcnt lgkmcnt(7)
    v_mfma_f32_16x16x32_bf16 v[128:131], v[24:27], v[176:179], v[128:131]
    ds_read_b128 v[20:23], v1 offset:3072
    v_mfma_f32_16x16x32_bf16 v[132:135], v[24:27], v[180:183], v[132:135]
    v_mfma_f32_16x16x32_bf16 v[136:139], v[28:31], v[176:179], v[136:139]
    ds_read_b128 v[24:27], v0 offset:61440
    s_waitcnt lgkmcnt(4)
    v_fmac_f32 v96, v4, v40
    v_mfma_f32_16x16x32_bf16 v[140:143], v[28:31], v[180:183], v[140:143]
    v_fmac_f32 v97, v4, v41
    v_fmac_f32 v98, v4, v42
    v_mfma_f32_16x16x32_bf16 v[144:147], v[32:35], v[176:179], v[144:147]
    ds_read_b128 v[28:31], v0 offset:62464
    v_fmac_f32 v99, v4, v43
    v_mfma_f32_16x16x32_bf16 v[148:151], v[32:35], v[180:183], v[148:151]
    v_fmac_f32 v104, v4, v44
    v_fmac_f32 v105, v4, v45
    v_mfma_f32_16x16x32_bf16 v[152:155], v[36:39], v[176:179], v[152:155]
    ds_read_b128 v[32:35], v0 offset:63488
    v_fmac_f32 v106, v4, v46
    v_mfma_f32_16x16x32_bf16 v[156:159], v[36:39], v[180:183], v[156:159]
    v_fmac_f32 v107, v4, v47
    v_fmac_f32 v100, v5, v40
    s_waitcnt lgkmcnt(5)
    v_mfma_f32_16x16x32_bf16 v[128:131], v[8:11], v[184:187], v[128:131]
    ds_read_b128 v[36:39], v0 offset:64512
    v_fmac_f32 v101, v5, v41
    v_mfma_f32_16x16x32_bf16 v[132:135], v[8:11], v[188:191], v[132:135]
    v_fmac_f32 v102, v5, v42
    v_fmac_f32 v103, v5, v43
    v_mfma_f32_16x16x32_bf16 v[136:139], v[12:15], v[184:187], v[136:139]
    ds_read_b128 v[8:11], v0 offset:57344
    v_fmac_f32 v108, v5, v44
    v_mfma_f32_16x16x32_bf16 v[140:143], v[12:15], v[188:191], v[140:143]
    v_fmac_f32 v109, v5, v45
    v_fmac_f32 v110, v5, v46
    s_waitcnt lgkmcnt(5)
    v_mfma_f32_16x16x32_bf16 v[144:147], v[16:19], v[184:187], v[144:147]
    ds_read_b128 v[12:15], v0 offset:58368
    v_fmac_f32 v111, v5, v47
    v_mfma_f32_16x16x32_bf16 v[148:151], v[16:19], v[188:191], v[148:151]
    ds_read_b128 v[40:43], v7 offset:144
    ds_read_b128 v[44:47], v7 offset:656
    v_mfma_f32_16x16x32_bf16 v[152:155], v[20:23], v[184:187], v[152:155]
    ds_read_b128 v[16:19], v0 offset:59392
    v_max_f32 v96, 0, v96
    v_mfma_f32_16x16x32_bf16 v[156:159], v[20:23], v[188:191], v[156:159]
    v_max_f32 v97, 0, v97
    v_max_f32 v98, 0, v98
    s_waitcnt lgkmcnt(7)
    v_mfma_f32_16x16x32_bf16 v[128:131], v[24:27], v[192:195], v[128:131]
    ds_read_b128 v[20:23], v0 offset:60416
    v_max_f32 v99, 0, v99
    v_mfma_f32_16x16x32_bf16 v[132:135], v[24:27], v[196:199], v[132:135]
    v_mul_f32 v96, v96, v104
    v_mul_f32 v97, v97, v105
    v_mfma_f32_16x16x32_bf16 v[136:139], v[28:31], v[192:195], v[136:139]
    ds_read_b128 v[24:27], v0 offset:53248
    v_mul_f32 v98, v98, v106
    v_mfma_f32_16x16x32_bf16 v[140:143], v[28:31], v[196:199], v[140:143]
    v_mul_f32 v99, v99, v107
    v_cvt_pk_bf16_f32 v96, v96, v97
    s_waitcnt lgkmcnt(7)
    v_mfma_f32_16x16x32_bf16 v[144:147], v[32:35], v[192:195], v[144:147]
    ds_read_b128 v[28:31], v0 offset:54272
    s_waitcnt vmcnt(0)
    s_mov_b64 exec, 1
    s_cmp_eq_u32 s27, 0
    s_cbranch_scc1 pf_87
    s_waitcnt vmcnt(0)
    buffer_wbl2 sc1
    s_waitcnt vmcnt(0)
    buffer_store_dword v63, off, s[12:15], s57 sc1
    s_branch pd_88
pf_87:
    buffer_store_dword v63, off, s[12:15], s57
pd_88:
    s_mov_b64 exec, -1
    s_add_u32 s57, s57, 512
    v_mfma_f32_16x16x32_bf16 v[148:151], v[32:35], v[196:199], v[148:151]
    v_cvt_pk_bf16_f32 v97, v98, v99
    v_max_f32 v100, 0, v100
    v_mfma_f32_16x16x32_bf16 v[152:155], v[36:39], v[192:195], v[152:155]
    ds_read_b128 v[32:35], v0 offset:55296
    v_max_f32 v101, 0, v101
    v_mfma_f32_16x16x32_bf16 v[156:159], v[36:39], v[196:199], v[156:159]
    v_max_f32 v102, 0, v102
    v_max_f32 v103, 0, v103
    s_waitcnt lgkmcnt(7)
    v_mfma_f32_16x16x32_bf16 v[128:131], v[8:11], v[200:203], v[128:131]
    ds_read_b128 v[36:39], v0 offset:56320
    v_mul_f32 v100, v100, v108
    v_mfma_f32_16x16x32_bf16 v[132:135], v[8:11], v[204:207], v[132:135]
    v_mul_f32 v101, v101, v109
    v_mul_f32 v102, v102, v110
    v_mfma_f32_16x16x32_bf16 v[136:139], v[12:15], v[200:203], v[136:139]
    ds_read_b128 v[8:11], v0 offset:32768
    v_mul_f32 v103, v103, v111
    v_mfma_f32_16x16x32_bf16 v[140:143], v[12:15], v[204:207], v[140:143]
    v_cvt_pk_bf16_f32 v100, v100, v101
    v_cvt_pk_bf16_f32 v101, v102, v103
    s_waitcnt lgkmcnt(5)
    v_mfma_f32_16x16x32_bf16 v[144:147], v[16:19], v[200:203], v[144:147]
    ds_read_b128 v[12:15], v0 offset:33792
    v_fmac_f32 v112, v4, v40
    v_mfma_f32_16x16x32_bf16 v[148:151], v[16:19], v[204:207], v[148:151]
    v_fmac_f32 v113, v4, v41
    v_fmac_f32 v114, v4, v42
    v_mfma_f32_16x16x32_bf16 v[152:155], v[20:23], v[200:203], v[152:155]
    ds_read_b128 v[16:19], v0 offset:34816
    v_fmac_f32 v115, v4, v43
    v_mfma_f32_16x16x32_bf16 v[156:159], v[20:23], v[204:207], v[156:159]
    v_fmac_f32 v120, v4, v44
    v_fmac_f32 v121, v4, v45
    s_waitcnt lgkmcnt(5)
    v_mfma_f32_16x16x32_bf16 v[128:131], v[24:27], v[208:211], v[128:131]
    ds_read_b128 v[20:23], v0 offset:35840
    v_fmac_f32 v122, v4, v46
    v_mfma_f32_16x16x32_bf16 v[132:135], v[24:27], v[212:215], v[132:135]
    v_fmac_f32 v123, v4, v47
    v_max_f32 v112, 0, v112
    v_mfma_f32_16x16x32_bf16 v[136:139], v[28:31], v[208:211], v[136:139]
    ds_read_b128 v[24:27], v0 offset:12288
    v_max_f32 v113, 0, v113
    v_mfma_f32_16x16x32_bf16 v[140:143], v[28:31], v[212:215], v[140:143]
    v_max_f32 v114, 0, v114
    v_max_f32 v115, 0, v115
    s_waitcnt lgkmcnt(5)
    v_mfma_f32_16x16x32_bf16 v[144:147], v[32:35], v[208:211], v[144:147]
    ds_read_b128 v[28:31], v0 offset:13312
    v_mul_f32 v112, v112, v120
    v_mfma_f32_16x16x32_bf16 v[148:151], v[32:35], v[212:215], v[148:151]
    v_mul_f32 v113, v113, v121
    v_mul_f32 v114, v114, v122
    v_mfma_f32_16x16x32_bf16 v[152:155], v[36:39], v[208:211], v[152:155]
    ds_read_b128 v[32:35], v0 offset:14336
    v_mul_f32 v115, v115, v123
    v_mfma_f32_16x16x32_bf16 v[156:159], v[36:39], v[212:215], v[156:159]
    v_cvt_pk_bf16_f32 v98, v112, v113
    v_cvt_pk_bf16_f32 v99, v114, v115
    s_waitcnt lgkmcnt(5)
    v_mfma_f32_16x16x32_bf16 v[128:131], v[8:11], v[216:219], v[128:131]
    ds_read_b128 v[36:39], v0 offset:15360
    buffer_store_dwordx4 v[96:99], v6, s[12:15], s54 offen offset:0 sc1
    v_mfma_f32_16x16x32_bf16 v[132:135], v[8:11], v[220:223], v[132:135]
    v_fmac_f32 v116, v5, v40
    v_fmac_f32 v117, v5, v41
    v_mfma_f32_16x16x32_bf16 v[136:139], v[12:15], v[216:219], v[136:139]
    s_barrier
    ds_read_b128 v[8:11], v0 offset:8192
    v_mfma_f32_16x16x32_bf16 v[140:143], v[12:15], v[220:223], v[140:143]
    v_fmac_f32 v118, v5, v42
    v_fmac_f32 v119, v5, v43
    s_waitcnt lgkmcnt(5)
    v_mfma_f32_16x16x32_bf16 v[144:147], v[16:19], v[216:219], v[144:147]
    ds_read_b128 v[12:15], v0 offset:9216
    v_fmac_f32 v124, v5, v44
    v_mfma_f32_16x16x32_bf16 v[148:151], v[16:19], v[220:223], v[148:151]
    v_fmac_f32 v125, v5, v45
    v_fmac_f32 v126, v5, v46
    v_mfma_f32_16x16x32_bf16 v[152:155], v[20:23], v[216:219], v[152:155]
    ds_read_b128 v[16:19], v0 offset:10240
    v_fmac_f32 v127, v5, v47
    v_mfma_f32_16x16x32_bf16 v[156:159], v[20:23], v[220:223], v[156:159]
    v_max_f32 v116, 0, v116
    v_max_f32 v117, 0, v117
    s_waitcnt lgkmcnt(5)
    v_mfma_f32_16x16x32_bf16 v[128:131], v[24:27], v[224:227], v[128:131]
    ds_read_b128 v[20:23], v0 offset:11264
    s_add_u32 s47, s58, 0
    v_mfma_f32_16x16x32_bf16 v[132:135], v[24:27], v[228:231], v[132:135]
    buffer_load_dword v54, v53, s[12:15], s47 offen sc1
    v_max_f32 v118, 0, v118
    v_mfma_f32_16x16x32_bf16 v[136:139], v[28:31], v[224:227], v[136:139]
    ds_read_b128 v[24:27], v3 offset:45056
    v_max_f32 v119, 0, v119
    v_mfma_f32_16x16x32_bf16 v[140:143], v[28:31], v[228:231], v[140:143]
    v_mul_f32 v116, v116, v124
    v_mul_f32 v117, v117, v125
    s_waitcnt lgkmcnt(5)
    v_mfma_f32_16x16x32_bf16 v[144:147], v[32:35], v[224:227], v[144:147]
    ds_read_b128 v[28:31], v3 offset:46080
    v_mul_f32 v118, v118, v126
    v_mfma_f32_16x16x32_bf16 v[148:151], v[32:35], v[228:231], v[148:151]
    v_mul_f32 v119, v119, v127
    v_cvt_pk_bf16_f32 v102, v116, v117
    v_mfma_f32_16x16x32_bf16 v[152:155], v[36:39], v[224:227], v[152:155]
    ds_read_b128 v[32:35], v3 offset:47104
    v_cvt_pk_bf16_f32 v103, v118, v119
    v_mfma_f32_16x16x32_bf16 v[156:159], v[36:39], v[228:231], v[156:159]
    buffer_store_dwordx4 v[100:103], v6, s[12:15], s54 offen offset:256 sc1
    s_waitcnt lgkmcnt(5)
    v_mfma_f32_16x16x32_bf16 v[128:131], v[8:11], v[232:235], v[128:131]
    ds_read_b128 v[36:39], v3 offset:48128
    v_mfma_f32_16x16x32_bf16 v[132:135], v[8:11], v[236:239], v[132:135]
    v_mfma_f32_16x16x32_bf16 v[136:139], v[12:15], v[232:235], v[136:139]
    ds_read_b128 v[8:11], v0 offset:49152
    v_mfma_f32_16x16x32_bf16 v[140:143], v[12:15], v[236:239], v[140:143]
    s_waitcnt lgkmcnt(5)
    v_mfma_f32_16x16x32_bf16 v[144:147], v[16:19], v[232:235], v[144:147]
    ds_read_b128 v[12:15], v0 offset:50176
    v_mfma_f32_16x16x32_bf16 v[148:151], v[16:19], v[236:239], v[148:151]
    v_mfma_f32_16x16x32_bf16 v[152:155], v[20:23], v[232:235], v[152:155]
    ds_read_b128 v[16:19], v0 offset:51200
    v_mfma_f32_16x16x32_bf16 v[156:159], v[20:23], v[236:239], v[156:159]
    s_waitcnt lgkmcnt(5)
    v_mfma_f32_16x16x32_bf16 v[128:131], v[24:27], v[240:243], v[128:131]
    ds_read_b128 v[20:23], v0 offset:52224
    v_mfma_f32_16x16x32_bf16 v[132:135], v[24:27], v[244:247], v[132:135]
    v_mfma_f32_16x16x32_bf16 v[136:139], v[28:31], v[240:243], v[136:139]
    ds_read_b128 v[24:27], v0 offset:45056
    v_mfma_f32_16x16x32_bf16 v[140:143], v[28:31], v[244:247], v[140:143]
    s_waitcnt lgkmcnt(5)
    v_mfma_f32_16x16x32_bf16 v[144:147], v[32:35], v[240:243], v[144:147]
    ds_read_b128 v[28:31], v0 offset:46080
    v_mfma_f32_16x16x32_bf16 v[148:151], v[32:35], v[244:247], v[148:151]
    v_mfma_f32_16x16x32_bf16 v[152:155], v[36:39], v[240:243], v[152:155]
    ds_read_b128 v[32:35], v0 offset:47104
    v_mfma_f32_16x16x32_bf16 v[156:159], v[36:39], v[244:247], v[156:159]
    s_waitcnt lgkmcnt(5)
    v_mfma_f32_16x16x32_bf16 v[128:131], v[8:11], v[248:251], v[128:131]
    ds_read_b128 v[36:39], v0 offset:48128
    v_mfma_f32_16x16x32_bf16 v[132:135], v[8:11], v[252:255], v[132:135]
    v_mfma_f32_16x16x32_bf16 v[136:139], v[12:15], v[248:251], v[136:139]
    ds_read_b128 v[8:11], v0 offset:40960
    ds_read_b128 v[40:43], v7 offset:256
    v_mfma_f32_16x16x32_bf16 v[140:143], v[12:15], v[252:255], v[140:143]
    ds_read_b128 v[44:47], v7 offset:768
    s_waitcnt lgkmcnt(7)
    v_mfma_f32_16x16x32_bf16 v[144:147], v[16:19], v[248:251], v[144:147]
    ds_read_b128 v[12:15], v0 offset:41984
    s_mov_b32 s60, 30000
    s_waitcnt vmcnt(1)
    s_branch pc_90
pl_89:
    buffer_load_dword v54, v53, s[12:15], s47 offen sc1
    s_waitcnt vmcnt(0)
pc_90:
    v_cmp_ne_u32 vcc, s26, v54
    s_nop 0
    s_cmp_eq_u64 vcc, 0
    s_cbranch_scc1 pdn_91
    s_sleep 1
    s_sub_u32 s60, s60, 1
    s_cbranch_scc0 pl_89
pdn_91:
    s_cmp_eq_u32 s27, 0
    s_cbranch_scc1 pi_92
    buffer_inv sc1
    s_waitcnt vmcnt(0)
pi_92:
    v_mfma_f32_16x16x32_bf16 v[148:151], v[16:19], v[252:255], v[148:151]
    s_add_u32 s40, s59, 245760
    buffer_load_dwordx4 v[64:67], v51, s[12:15], s40 offen sc1
    v_mfma_f32_16x16x32_bf16 v[152:155], v[20:23], v[248:251], v[152:155]
    ds_read_b128 v[16:19], v0 offset:43008
    buffer_load_dwordx4 v[68:71], v52, s[12:15], s40 offen sc1
    v_mfma_f32_16x16x32_bf16 v[156:159], v[20:23], v[252:255], v[156:159]
    s_add_u32 s40, s40, 8192
    s_waitcnt lgkmcnt(7)
    v_mfma_f32_16x16x32_bf16 v[160:163], v[24:27], v[176:179], v[160:163]
    ds_read_b128 v[20:23], v0 offset:44032
    v_mfma_f32_16x16x32_bf16 v[164:167], v[24:27], v[180:183], v[164:167]
    v_mfma_f32_16x16x32_bf16 v[168:171], v[28:31], v[176:179], v[168:171]
    ds_read_b128 v[24:27], v0 offset:4096
    s_waitcnt lgkmcnt(4)
    v_fmac_f32 v128, v4, v40
    v_mfma_f32_16x16x32_bf16 v[172:175], v[28:31], v[180:183], v[172:175]
    v_fmac_f32 v129, v4, v41
    v_fmac_f32 v130, v4, v42
    v_mfma_f32_16x16x32_bf16 v[160:163], v[32:35], v[184:187], v[160:163]
    ds_read_b128 v[28:31], v0 offset:5120
    buffer_load_dwordx4 v[72:75], v51, s[12:15], s40 offen sc1
    v_mfma_f32_16x16x32_bf16 v[164:167], v[32:35], v[188:191], v[164:167]
    buffer_load_dwordx4 v[76:79], v52, s[12:15], s40 offen sc1
    s_add_u32 s40, s40, 8192
    v_mfma_f32_16x16x32_bf16 v[168:171], v[36:39], v[184:187], v[168:171]
    ds_read_b128 v[32:35], v0 offset:6144
    v_fmac_f32 v131, v4, v43
    v_mfma_f32_16x16x32_bf16 v[172:175], v[36:39], v[188:191], v[172:175]
    v_fmac_f32 v136, v4, v44
    v_fmac_f32 v137, v4, v45
    s_waitcnt lgkmcnt(5)
    v_mfma_f32_16x16x32_bf16 v[160:163], v[8:11], v[192:195], v[160:163]
    ds_read_b128 v[36:39], v0 offset:7168
    v_fmac_f32 v138, v4, v46
    v_mfma_f32_16x16x32_bf16 v[164:167], v[8:11], v[196:199], v[164:167]
    v_fmac_f32 v139, v4, v47
    v_fmac_f32 v132, v5, v40
    v_mfma_f32_16x16x32_bf16 v[168:171], v[12:15], v[192:195], v[168:171]
    ds_read_b128 v[8:11], v0 offset:0
    v_fmac_f32 v133, v5, v41
    v_mfma_f32_16x16x32_bf16 v[172:175], v[12:15], v[196:199], v[172:175]
    v_fmac_f32 v134, v5, v42
    v_fmac_f32 v135, v5, v43
    s_waitcnt lgkmcnt(5)
    v_mfma_f32_16x16x32_bf16 v[160:163], v[16:19], v[200:203], v[160:163]
    ds_read_b128 v[12:15], v0 offset:1024
    buffer_load_dwordx4 v[80:83], v51, s[12:15], s40 offen sc1
    v_mfma_f32_16x16x32_bf16 v[164:167], v[16:19], v[204:207], v[164:167]
    buffer_load_dwordx4 v[84:87], v52, s[12:15], s40 offen sc1
    s_add_u32 s40, s40, 8192
    v_mfma_f32_16x16x32_bf16 v[168:171], v[20:23], v[200:203], v[168:171]
    ds_read_b128 v[16:19], v0 offset:2048
    v_fmac_f32 v140, v5, v44
    v_mfma_f32_16x16x32_bf16 v[172:175], v[20:23], v[204:207], v[172:175]
    v_fmac_f32 v141, v5, v45
    v_fmac_f32 v142, v5, v46
    s_waitcnt lgkmcnt(5)
    v_mfma_f32_16x16x32_bf16 v[160:163], v[24:27], v[208:211], v[160:163]
    ds_read_b128 v[20:23], v0 offset:3072
    v_fmac_f32 v143, v5, v47
    v_mfma_f32_16x16x32_bf16 v[164:167], v[24:27], v[212:215], v[164:167]
    ds_read_b128 v[40:43], v7 offset:272
    ds_read_b128 v[44:47], v7 offset:784
    v_mfma_f32_16x16x32_bf16 v[168:171], v[28:31], v[208:211], v[168:171]
    ds_read_b128 v[24:27], v3 offset:61440
    v_max_f32 v128, 0, v128
    v_mfma_f32_16x16x32_bf16 v[172:175], v[28:31], v[212:215], v[172:175]
    v_max_f32 v129, 0, v129
    v_max_f32 v130, 0, v130
    s_waitcnt lgkmcnt(7)
    v_mfma_f32_16x16x32_bf16 v[160:163], v[32:35], v[216:219], v[160:163]
    ds_read_b128 v[28:31], v3 offset:62464
    buffer_load_dwordx4 v[88:91], v51, s[12:15], s40 offen sc1
    v_mfma_f32_16x16x32_bf16 v[164:167], v[32:35], v[220:223], v[164:167]
    buffer_load_dwordx4 v[92:95], v52, s[12:15], s40 offen sc1
    s_add_u32 s40, s40, 8192
    v_mfma_f32_16x16x32_bf16 v[168:171], v[36:39], v[216:219], v[168:171]
    ds_read_b128 v[32:35], v3 offset:63488
    s_waitcnt vmcnt(8)
    s_mov_b64 exec, 1
    s_cmp_eq_u32 s27, 0
    s_cbranch_scc1 pf_93
    s_waitcnt vmcnt(0)
    buffer_wbl2 sc1
    s_waitcnt vmcnt(0)
    buffer_store_dword v63, off, s[12:15], s57 sc1
    s_branch pd_94
pf_93:
    buffer_store_dword v63, off, s[12:15], s57
pd_94:
    s_mov_b64 exec, -1
    s_add_u32 s57, s57, 512
    v_mfma_f32_16x16x32_bf16 v[172:175], v[36:39], v[220:223], v[172:175]
    v_max_f32 v131, 0, v131
    v_mul_f32 v128, v128, v136
    s_waitcnt lgkmcnt(7)
    v_mfma_f32_16x16x32_bf16 v[160:163], v[8:11], v[224:227], v[160:163]
    ds_read_b128 v[36:39], v3 offset:64512
    v_mul_f32 v129, v129, v137
    v_mfma_f32_16x16x32_bf16 v[164:167], v[8:11], v[228:231], v[164:167]
    v_mul_f32 v130, v130, v138
    v_mul_f32 v131, v131, v139
    v_mfma_f32_16x16x32_bf16 v[168:171], v[12:15], v[224:227], v[168:171]
    v_cvt_pk_bf16_f32 v128, v128, v129
    v_cvt_pk_bf16_f32 v129, v130, v131
    v_mfma_f32_16x16x32_bf16 v[172:175], v[12:15], v[228:231], v[172:175]
    v_max_f32 v132, 0, v132
    v_max_f32 v133, 0, v133
    s_waitcnt lgkmcnt(6)
    v_mfma_f32_16x16x32_bf16 v[160:163], v[16:19], v[232:235], v[160:163]
    buffer_load_dwordx4 v[96:99], v51, s[12:15], s40 offen sc1
    buffer_load_dwordx4 v[100:103], v52, s[12:15], s40 offen sc1
    v_mfma_f32_16x16x32_bf16 v[164:167], v[16:19], v[236:239], v[164:167]
    s_add_u32 s40, s40, 8192
    v_max_f32 v134, 0, v134
    v_mfma_f32_16x16x32_bf16 v[168:171], v[20:23], v[232:235], v[168:171]
    v_max_f32 v135, 0, v135
    v_mul_f32 v132, v132, v140
    v_mfma_f32_16x16x32_bf16 v[172:175], v[20:23], v[236:239], v[172:175]
    v_mul_f32 v133, v133, v141
    v_mul_f32 v134, v134, v142
    s_waitcnt lgkmcnt(2)
    v_mfma_f32_16x16x32_bf16 v[160:163], v[24:27], v[240:243], v[160:163]
    s_barrier
    ds_read_b128 v[216:219], v48 offset:40960
    v_mfma_f32_16x16x32_bf16 v[164:167], v[24:27], v[244:247], v[164:167]
    ds_read_b128 v[220:223], v48 offset:43008
    ds_read_b128 v[224:227], v48 offset:36864
    ds_read_b128 v[228:231], v48 offset:38912
    ds_read_b128 v[232:235], v48 offset:32768
    v_mfma_f32_16x16x32_bf16 v[168:171], v[28:31], v[240:243], v[168:171]
    v_mul_f32 v135, v135, v143
    v_cvt_pk_bf16_f32 v132, v132, v133
    v_mfma_f32_16x16x32_bf16 v[172:175], v[28:31], v[244:247], v[172:175]
    v_cvt_pk_bf16_f32 v133, v134, v135
    v_fmac_f32 v144, v4, v40
    s_waitcnt lgkmcnt(5)
    v_mfma_f32_16x16x32_bf16 v[160:163], v[32:35], v[248:251], v[160:163]
    buffer_load_dwordx4 v[104:107], v51, s[12:15], s40 offen sc1
    buffer_load_dwordx4 v[108:111], v52, s[12:15], s40 offen sc1
    v_mfma_f32_16x16x32_bf16 v[164:167], v[32:35], v[252:255], v[164:167]
    s_add_u32 s40, s40, 8192
    v_fmac_f32 v145, v4, v41
    v_mfma_f32_16x16x32_bf16 v[168:171], v[36:39], v[248:251], v[168:171]
    v_fmac_f32 v146, v4, v42
    v_fmac_f32 v147, v4, v43
    v_mfma_f32_16x16x32_bf16 v[172:175], v[36:39], v[252:255], v[172:175]
    v_fmac_f32 v152, v4, v44
    v_fmac_f32 v153, v4, v45
    s_waitcnt vmcnt(11)
    s_waitcnt lgkmcnt(4)
    v_mfma_f32_16x16x32_bf16 v[176:179], v[216:219], v[64:67], 0
    ds_read_b128 v[236:239], v48 offset:34816
    s_add_u32 s47, s58, 512
    v_mfma_f32_16x16x32_bf16 v[196:199], v[216:219], v[68:71], 0
    ds_read_b128 v[240:243], v48 offset:28672
    buffer_load_dword v54, v53, s[12:15], s47 offen sc1
    s_waitcnt lgkmcnt(5)
    v_mfma_f32_16x16x32_bf16 v[180:183], v[220:223], v[64:67], 0
    ds_read_b128 v[244:247], v48 offset:30720
    buffer_load_dwordx4 v[112:115], v51, s[12:15], s40 offen sc1
    v_mfma_f32_16x16x32_bf16 v[200:203], v[220:223], v[68:71], 0
    ds_read_b128 v[248:251], v49 offset:28672
    buffer_load_dwordx4 v[116:119], v52, s[12:15], s40 offen sc1
    s_waitcnt lgkmcnt(6)
    v_mfma_f32_16x16x32_bf16 v[184:187], v[224:227], v[64:67], 0
    ds_read_b128 v[252:255], v49 offset:30720
    s_add_u32 s40, s40, 8192
    v_mfma_f32_16x16x32_bf16 v[204:207], v[224:227], v[68:71], 0
    v_fmac_f32 v154, v4, v46
    v_fmac_f32 v155, v4, v47
    s_waitcnt lgkmcnt(6)
    v_mfma_f32_16x16x32_bf16 v[188:191], v[228:231], v[64:67], 0
    v_max_f32 v144, 0, v144
    v_max_f32 v145, 0, v145
    v_mfma_f32_16x16x32_bf16 v[208:211], v[228:231], v[68:71], 0
    v_max_f32 v146, 0, v146
    v_max_f32 v147, 0, v147
    s_waitcnt lgkmcnt(5)
    v_mfma_f32_16x16x32_bf16 v[192:195], v[232:235], v[64:67], 0
    v_mul_f32 v144, v144, v152
    v_mul_f32 v145, v145, v153
    v_mfma_f32_16x16x32_bf16 v[212:215], v[232:235], v[68:71], 0
    v_mul_f32 v146, v146, v154
    v_mul_f32 v147, v147, v155
    s_waitcnt vmcnt(12)
    s_waitcnt lgkmcnt(4)
    v_mfma_f32_16x16x32_bf16 v[176:179], v[236:239], v[72:75], v[176:179]
    ds_read_b128 v[216:219], v49 offset:24576
    buffer_load_dwordx4 v[120:123], v51, s[12:15], s40 offen sc1
    v_mfma_f32_16x16x32_bf16 v[196:199], v[236:239], v[76:79], v[196:199]
    ds_read_b128 v[220:223], v49 offset:26624
    buffer_load_dwordx4 v[124:127], v52, s[12:15], s40 offen sc1
    s_waitcnt lgkmcnt(5)
    v_mfma_f32_16x16x32_bf16 v[180:183], v[240:243], v[72:75], v[180:183]
    ds_read_b128 v[224:227], v49 offset:20480
    s_add_u32 s40, s40, 8192
    v_mfma_f32_16x16x32_bf16 v[200:203], v[240:243], v[76:79], v[200:203]
    ds_read_b128 v[228:231], v49 offset:22528
    v_cvt_pk_bf16_f32 v130, v144, v145
    s_waitcnt lgkmcnt(6)
    v_mfma_f32_16x16x32_bf16 v[184:187], v[244:247], v[72:75], v[184:187]
    ds_read_b128 v[232:235], v48 offset:57344
    v_cvt_pk_bf16_f32 v131, v146, v147
    v_mfma_f32_16x16x32_bf16 v[204:207], v[244:247], v[76:79], v[204:207]
    buffer_store_dwordx4 v[128:131], v6, s[12:15], s55 offen offset:0 sc1
    v_fmac_f32 v148, v5, v40
    s_waitcnt lgkmcnt(6)
    v_mfma_f32_16x16x32_bf16 v[188:191], v[248:251], v[72:75], v[188:191]
    v_fmac_f32 v149, v5, v41
    v_fmac_f32 v150, v5, v42
    v_mfma_f32_16x16x32_bf16 v[208:211], v[248:251], v[76:79], v[208:211]
    v_fmac_f32 v151, v5, v43
    v_fmac_f32 v156, v5, v44
    s_waitcnt lgkmcnt(5)
    v_mfma_f32_16x16x32_bf16 v[192:195], v[252:255], v[72:75], v[192:195]
    v_fmac_f32 v157, v5, v45
    v_fmac_f32 v158, v5, v46
    v_mfma_f32_16x16x32_bf16 v[212:215], v[252:255], v[76:79], v[212:215]
    v_fmac_f32 v159, v5, v47
    ds_read_b128 v[40:43], v7 offset:384
    s_waitcnt vmcnt(13)
    s_waitcnt lgkmcnt(5)
    v_mfma_f32_16x16x32_bf16 v[176:179], v[216:219], v[80:83], v[176:179]
    ds_read_b128 v[236:239], v48 offset:59392
    ds_read_b128 v[44:47], v7 offset:896
    v_mfma_f32_16x16x32_bf16 v[196:199], v[216:219], v[84:87], v[196:199]
    ds_read_b128 v[240:243], v48 offset:53248
    v_max_f32 v148, 0, v148
    s_waitcnt lgkmcnt(7)
    v_mfma_f32_16x16x32_bf16 v[180:183], v[220:223], v[80:83], v[180:183]
    ds_read_b128 v[244:247], v48 offset:55296
    v_max_f32 v149, 0, v149
    v_mfma_f32_16x16x32_bf16 v[200:203], v[220:223], v[84:87], v[200:203]
    ds_read_b128 v[248:251], v48 offset:49152
    v_max_f32 v150, 0, v150
    s_waitcnt lgkmcnt(8)
    v_mfma_f32_16x16x32_bf16 v[184:187], v[224:227], v[80:83], v[184:187]
    ds_read_b128 v[252:255], v48 offset:51200
    v_max_f32 v151, 0, v151
    v_mfma_f32_16x16x32_bf16 v[204:207], v[224:227], v[84:87], v[204:207]
    v_mul_f32 v148, v148, v156
    v_mul_f32 v149, v149, v157
    s_waitcnt lgkmcnt(8)
    v_mfma_f32_16x16x32_bf16 v[188:191], v[228:231], v[80:83], v[188:191]
    v_mul_f32 v150, v150, v158
    v_mul_f32 v151, v151, v159
    v_mfma_f32_16x16x32_bf16 v[208:211], v[228:231], v[84:87], v[208:211]
    v_cvt_pk_bf16_f32 v134, v148, v149
    v_cvt_pk_bf16_f32 v135, v150, v151
    s_waitcnt lgkmcnt(7)
    v_mfma_f32_16x16x32_bf16 v[192:195], v[232:235], v[80:83], v[192:195]
    buffer_store_dwordx4 v[132:135], v6, s[12:15], s55 offen offset:256 sc1
    s_waitcnt lgkmcnt(4)
    v_fmac_f32 v160, v4, v40
    v_mfma_f32_16x16x32_bf16 v[212:215], v[232:235], v[84:87], v[212:215]
    v_fmac_f32 v161, v4, v41
    v_fmac_f32 v162, v4, v42
    s_waitcnt vmcnt(12)
    v_mfma_f32_16x16x32_bf16 v[176:179], v[236:239], v[88:91], v[176:179]
    s_barrier
    ds_read_b128 v[216:219], v48 offset:24576
    v_mfma_f32_16x16x32_bf16 v[196:199], v[236:239], v[92:95], v[196:199]
    ds_read_b128 v[220:223], v48 offset:26624
    s_mov_b32 s60, 30000
    s_waitcnt vmcnt(6)
    s_branch pc_96
pl_95:
    buffer_load_dword v54, v53, s[12:15], s47 offen sc1
    s_waitcnt vmcnt(0)
pc_96:
    v_cmp_ne_u32 vcc, s26, v54
    s_nop 0
    s_cmp_eq_u64 vcc, 0
    s_cbranch_scc1 pdn_97
    s_sleep 1
    s_sub_u32 s60, s60, 1
    s_cbranch_scc0 pl_95
pdn_97:
    s_cmp_eq_u32 s27, 0
    s_cbranch_scc1 pi_98
    buffer_inv sc1
    s_waitcnt vmcnt(0)
pi_98:
    s_waitcnt lgkmcnt(5)
    v_mfma_f32_16x16x32_bf16 v[180:183], v[240:243], v[88:91], v[180:183]
    ds_read_b128 v[224:227], v48 offset:20480
    s_add_u32 s40, s59, 311296
    v_mfma_f32_16x16x32_bf16 v[200:203], v[240:243], v[92:95], v[200:203]
    ds_read_b128 v[228:231], v48 offset:22528
    buffer_load_dwordx4 v[8:11], v51, s[12:15], s40 offen sc1
    s_waitcnt lgkmcnt(6)
    v_mfma_f32_16x16x32_bf16 v[184:187], v[244:247], v[88:91], v[184:187]
    ds_read_b128 v[232:235], v48 offset:16384
    buffer_load_dwordx4 v[12:15], v52, s[12:15], s40 offen sc1
    v_mfma_f32_16x16x32_bf16 v[204:207], v[244:247], v[92:95], v[204:207]
    s_add_u32 s40, s40, 8192
    buffer_load_dwordx4 v[16:19], v51, s[12:15], s40 offen sc1
    s_waitcnt lgkmcnt(6)
    v_mfma_f32_16x16x32_bf16 v[188:191], v[248:251], v[88:91], v[188:191]
    buffer_load_dwordx4 v[20:23], v52, s[12:15], s40 offen sc1
    s_add_u32 s40, s40, 8192
    v_mfma_f32_16x16x32_bf16 v[208:211], v[248:251], v[92:95], v[208:211]
    v_fmac_f32 v163, v4, v43
    v_fmac_f32 v168, v4, v44
    s_waitcnt lgkmcnt(5)
    v_mfma_f32_16x16x32_bf16 v[192:195], v[252:255], v[88:91], v[192:195]
    v_fmac_f32 v169, v4, v45
    v_fmac_f32 v170, v4, v46
    v_mfma_f32_16x16x32_bf16 v[212:215], v[252:255], v[92:95], v[212:215]
    v_fmac_f32 v171, v4, v47
    v_max_f32 v160, 0, v160
    s_waitcnt lgkmcnt(4)
    v_mfma_f32_16x16x32_bf16 v[176:179], v[216:219], v[96:99], v[176:179]
    ds_read_b128 v[236:239], v48 offset:18432
    buffer_load_dwordx4 v[24:27], v51, s[12:15], s40 offen sc1
    v_mfma_f32_16x16x32_bf16 v[196:199], v[216:219], v[100:103], v[196:199]
    ds_read_b128 v[240:243], v48 offset:12288
    buffer_load_dwordx4 v[28:31], v52, s[12:15], s40 offen sc1
    s_waitcnt lgkmcnt(5)
    v_mfma_f32_16x16x32_bf16 v[180:183], v[220:223], v[96:99], v[180:183]
    ds_read_b128 v[244:247], v48 offset:14336
    s_add_u32 s40, s40, 8192
    v_mfma_f32_16x16x32_bf16 v[200:203], v[220:223], v[100:103], v[200:203]
    ds_read_b128 v[248:251], v50 offset:24576
    buffer_load_dwordx4 v[32:35], v51, s[12:15], s40 offen sc1
    s_waitcnt lgkmcnt(6)
    v_mfma_f32_16x16x32_bf16 v[184:187], v[224:227], v[96:99], v[184:187]
    ds_read_b128 v[252:255], v50 offset:26624
    buffer_load_dwordx4 v[36:39], v52, s[12:15], s40 offen sc1
    v_mfma_f32_16x16x32_bf16 v[204:207], v[224:227], v[100:103], v[204:207]
    s_add_u32 s40, s40, 8192
    v_max_f32 v161, 0, v161
    s_waitcnt lgkmcnt(6)
    v_mfma_f32_16x16x32_bf16 v[188:191], v[228:231], v[96:99], v[188:191]
    v_max_f32 v162, 0, v162
    v_max_f32 v163, 0, v163
    v_mfma_f32_16x16x32_bf16 v[208:211], v[228:231], v[100:103], v[208:211]
    v_mul_f32 v160, v160, v168
    v_mul_f32 v161, v161, v169
    s_waitcnt lgkmcnt(5)
    v_mfma_f32_16x16x32_bf16 v[192:195], v[232:235], v[96:99], v[192:195]
    v_mul_f32 v162, v162, v170
    v_mul_f32 v163, v163, v171
    v_mfma_f32_16x16x32_bf16 v[212:215], v[232:235], v[100:103], v[212:215]
    v_cvt_pk_bf16_f32 v160, v160, v161
    v_cvt_pk_bf16_f32 v161, v162, v163
    s_waitcnt lgkmcnt(4)
    v_mfma_f32_16x16x32_bf16 v[176:179], v[236:239], v[104:107], v[176:179]
    ds_read_b128 v[216:219], v50 offset:20480
    buffer_load_dwordx4 v[64:67], v51, s[12:15], s40 offen sc1
    v_mfma_f32_16x16x32_bf16 v[196:199], v[236:239], v[108:111], v[196:199]
    ds_read_b128 v[220:223], v50 offset:22528
    buffer_load_dwordx4 v[68:71], v52, s[12:15], s40 offen sc1
    s_waitcnt lgkmcnt(5)
    v_mfma_f32_16x16x32_bf16 v[180:183], v[240:243], v[104:107], v[180:183]
    ds_read_b128 v[224:227], v50 offset:16384
    s_add_u32 s40, s40, 8192
    v_mfma_f32_16x16x32_bf16 v[200:203], v[240:243], v[108:111], v[200:203]
    ds_read_b128 v[228:231], v50 offset:18432
    buffer_load_dwordx4 v[72:75], v51, s[12:15], s40 offen sc1
    s_waitcnt lgkmcnt(6)
    v_mfma_f32_16x16x32_bf16 v[184:187], v[244:247], v[104:107], v[184:187]
    ds_read_b128 v[232:235], v50 offset:12288
    buffer_load_dwordx4 v[76:79], v52, s[12:15], s40 offen sc1
    v_mfma_f32_16x16x32_bf16 v[204:207], v[244:247], v[108:111], v[204:207]
    s_add_u32 s40, s40, 8192
    buffer_store_dwordx2 v[160:161], v55, s[12:15], s56 offen offset:0 sc1
    s_waitcnt lgkmcnt(6)
    v_mfma_f32_16x16x32_bf16 v[188:191], v[248:251], v[104:107], v[188:191]
    v_fmac_f32 v164, v5, v40
    v_fmac_f32 v165, v5, v41
    v_mfma_f32_16x16x32_bf16 v[208:211], v[248:251], v[108:111], v[208:211]
    v_fmac_f32 v166, v5, v42
    v_fmac_f32 v167, v5, v43
    s_waitcnt lgkmcnt(5)
    v_mfma_f32_16x16x32_bf16 v[192:195], v[252:255], v[104:107], v[192:195]
    v_fmac_f32 v172, v5, v44
    v_fmac_f32 v173, v5, v45
    v_mfma_f32_16x16x32_bf16 v[212:215], v[252:255], v[108:111], v[212:215]
    v_fmac_f32 v174, v5, v46
    v_fmac_f32 v175, v5, v47
    s_waitcnt vmcnt(17)
    s_waitcnt lgkmcnt(4)
    v_mfma_f32_16x16x32_bf16 v[176:179], v[216:219], v[112:115], v[176:179]
    ds_read_b128 v[236:239], v50 offset:14336
    buffer_load_dwordx4 v[80:83], v51, s[12:15], s40 offen sc1
    v_mfma_f32_16x16x32_bf16 v[196:199], v[216:219], v[116:119], v[196:199]
    ds_read_b128 v[240:243], v49 offset:36864
    buffer_load_dwordx4 v[84:87], v52, s[12:15], s40 offen sc1
    s_waitcnt lgkmcnt(5)
    v_mfma_f32_16x16x32_bf16 v[180:183], v[220:223], v[112:115], v[180:183]
    ds_read_b128 v[244:247], v49 offset:38912
    s_add_u32 s40, s40, 8192
    v_mfma_f32_16x16x32_bf16 v[200:203], v[220:223], v[116:119], v[200:203]
    ds_read_b128 v[248:251], v49 offset:16384
    s_waitcnt vmcnt(15)
    s_mov_b64 exec, 1
    s_cmp_eq_u32 s27, 0
    s_cbranch_scc1 pf_99
    s_waitcnt vmcnt(0)
    buffer_wbl2 sc1
    s_waitcnt vmcnt(0)
    buffer_store_dword v63, off, s[12:15], s57 sc1
    s_branch pd_100
pf_99:
    buffer_store_dword v63, off, s[12:15], s57
pd_100:
    s_mov_b64 exec, -1
    s_add_u32 s57, s57, 512
    s_waitcnt lgkmcnt(6)
    v_mfma_f32_16x16x32_bf16 v[184:187], v[224:227], v[112:115], v[184:187]
    ds_read_b128 v[252:255], v49 offset:18432
    v_max_f32 v164, 0, v164
    v_mfma_f32_16x16x32_bf16 v[204:207], v[224:227], v[116:119], v[204:207]
    v_max_f32 v165, 0, v165
    v_max_f32 v166, 0, v166
    s_waitcnt lgkmcnt(6)
    v_mfma_f32_16x16x32_bf16 v[188:191], v[228:231], v[112:115], v[188:191]
    v_max_f32 v167, 0, v167
    v_mul_f32 v164, v164, v172
    v_mfma_f32_16x16x32_bf16 v[208:211], v[228:231], v[116:119], v[208:211]
    v_mul_f32 v165, v165, v173
    v_mul_f32 v166, v166, v174
    s_waitcnt lgkmcnt(5)
    v_mfma_f32_16x16x32_bf16 v[192:195], v[232:235], v[112:115], v[192:195]
    v_mul_f32 v167, v167, v175
    v_cvt_pk_bf16_f32 v164, v164, v165
    v_mfma_f32_16x16x32_bf16 v[212:215], v[232:235], v[116:119], v[212:215]
    v_cvt_pk_bf16_f32 v165, v166, v167
    buffer_store_dwordx2 v[164:165], v55, s[12:15], s56 offen offset:256 sc1
    s_waitcnt lgkmcnt(4)
    v_mfma_f32_16x16x32_bf16 v[176:179], v[236:239], v[120:123], v[176:179]
    s_barrier
    ds_read_b128 v[216:219], v48 offset:8192
    v_mfma_f32_16x16x32_bf16 v[196:199], v[236:239], v[124:127], v[196:199]
    ds_read_b128 v[220:223], v48 offset:10240
    buffer_load_dwordx4 v[88:91], v51, s[12:15], s40 offen sc1
    s_waitcnt lgkmcnt(5)
    v_mfma_f32_16x16x32_bf16 v[180:183], v[240:243], v[120:123], v[180:183]
    ds_read_b128 v[224:227], v48 offset:4096
    buffer_load_dwordx4 v[92:95], v52, s[12:15], s40 offen sc1
    v_mfma_f32_16x16x32_bf16 v[200:203], v[240:243], v[124:127], v[200:203]
    ds_read_b128 v[228:231], v48 offset:6144
    s_add_u32 s40, s40, 8192
    s_waitcnt lgkmcnt(6)
    v_mfma_f32_16x16x32_bf16 v[184:187], v[244:247], v[120:123], v[184:187]
    ds_read_b128 v[232:235], v48 offset:0
    v_mfma_f32_16x16x32_bf16 v[204:207], v[244:247], v[124:127], v[204:207]
    s_waitcnt lgkmcnt(6)
    v_mfma_f32_16x16x32_bf16 v[188:191], v[248:251], v[120:123], v[188:191]
    v_mfma_f32_16x16x32_bf16 v[208:211], v[248:251], v[124:127], v[208:211]
    s_waitcnt lgkmcnt(5)
    v_mfma_f32_16x16x32_bf16 v[192:195], v[252:255], v[120:123], v[192:195]
    v_mfma_f32_16x16x32_bf16 v[212:215], v[252:255], v[124:127], v[212:215]
    s_waitcnt vmcnt(17)
    s_waitcnt lgkmcnt(4)
    v_mfma_f32_16x16x32_bf16 v[176:179], v[216:219], v[8:11], v[176:179]
    ds_read_b128 v[236:239], v48 offset:2048
    s_add_u32 s47, s58, 1024
    v_mfma_f32_16x16x32_bf16 v[196:199], v[216:219], v[12:15], v[196:199]
    ds_read_b128 v[240:243], v50 offset:8192
    buffer_load_dword v54, v53, s[12:15], s47 offen sc1
    s_waitcnt lgkmcnt(5)
    v_mfma_f32_16x16x32_bf16 v[180:183], v[220:223], v[8:11], v[180:183]
    ds_read_b128 v[244:247], v50 offset:10240
    v_mfma_f32_16x16x32_bf16 v[200:203], v[220:223], v[12:15], v[200:203]
    ds_read_b128 v[248:251], v50 offset:4096
    s_waitcnt lgkmcnt(6)
    v_mfma_f32_16x16x32_bf16 v[184:187], v[224:227], v[8:11], v[184:187]
    ds_read_b128 v[252:255], v50 offset:6144
    v_mfma_f32_16x16x32_bf16 v[204:207], v[224:227], v[12:15], v[204:207]
    s_waitcnt lgkmcnt(6)
    v_mfma_f32_16x16x32_bf16 v[188:191], v[228:231], v[8:11], v[188:191]
    v_mfma_f32_16x16x32_bf16 v[208:211], v[228:231], v[12:15], v[208:211]
    s_waitcnt lgkmcnt(5)
    v_mfma_f32_16x16x32_bf16 v[192:195], v[232:235], v[8:11], v[192:195]
    v_mfma_f32_16x16x32_bf16 v[212:215], v[232:235], v[12:15], v[212:215]
    s_waitcnt vmcnt(16)
    s_waitcnt lgkmcnt(4)
    v_mfma_f32_16x16x32_bf16 v[176:179], v[236:239], v[16:19], v[176:179]
    ds_read_b128 v[216:219], v50 offset:0
    v_mfma_f32_16x16x32_bf16 v[196:199], v[236:239], v[20:23], v[196:199]
    ds_read_b128 v[220:223], v50 offset:2048
    s_waitcnt lgkmcnt(5)
    v_mfma_f32_16x16x32_bf16 v[180:183], v[240:243], v[16:19], v[180:183]
    ds_read_b128 v[224:227], v49 offset:61440
    v_mfma_f32_16x16x32_bf16 v[200:203], v[240:243], v[20:23], v[200:203]
    ds_read_b128 v[228:231], v49 offset:63488
    s_waitcnt lgkmcnt(6)
    v_mfma_f32_16x16x32_bf16 v[184:187], v[244:247], v[16:19], v[184:187]
    ds_read_b128 v[232:235], v49 offset:57344
    v_mfma_f32_16x16x32_bf16 v[204:207], v[244:247], v[20:23], v[204:207]
    s_waitcnt lgkmcnt(6)
    v_mfma_f32_16x16x32_bf16 v[188:191], v[248:251], v[16:19], v[188:191]
    v_mfma_f32_16x16x32_bf16 v[208:211], v[248:251], v[20:23], v[208:211]
    s_waitcnt lgkmcnt(5)
    v_mfma_f32_16x16x32_bf16 v[192:195], v[252:255], v[16:19], v[192:195]
    v_mfma_f32_16x16x32_bf16 v[212:215], v[252:255], v[20:23], v[212:215]
    s_waitcnt vmcnt(14)
    s_waitcnt lgkmcnt(4)
    v_mfma_f32_16x16x32_bf16 v[176:179], v[216:219], v[24:27], v[176:179]
    ds_read_b128 v[236:239], v49 offset:59392
    v_mfma_f32_16x16x32_bf16 v[196:199], v[216:219], v[28:31], v[196:199]
    ds_read_b128 v[240:243], v49 offset:53248
    s_waitcnt lgkmcnt(5)
    v_mfma_f32_16x16x32_bf16 v[180:183], v[220:223], v[24:27], v[180:183]
    ds_read_b128 v[244:247], v49 offset:55296
    v_mfma_f32_16x16x32_bf16 v[200:203], v[220:223], v[28:31], v[200:203]
    ds_read_b128 v[248:251], v49 offset:49152
    s_waitcnt lgkmcnt(6)
    v_mfma_f32_16x16x32_bf16 v[184:187], v[224:227], v[24:27], v[184:187]
    ds_read_b128 v[252:255], v49 offset:51200
    v_mfma_f32_16x16x32_bf16 v[204:207], v[224:227], v[28:31], v[204:207]
    s_waitcnt lgkmcnt(6)
    v_mfma_f32_16x16x32_bf16 v[188:191], v[228:231], v[24:27], v[188:191]
    v_mfma_f32_16x16x32_bf16 v[208:211], v[228:231], v[28:31], v[208:211]
    s_waitcnt lgkmcnt(5)
    v_mfma_f32_16x16x32_bf16 v[192:195], v[232:235], v[24:27], v[192:195]
    v_mfma_f32_16x16x32_bf16 v[212:215], v[232:235], v[28:31], v[212:215]
    s_waitcnt vmcnt(12)
    s_waitcnt lgkmcnt(4)
    v_mfma_f32_16x16x32_bf16 v[176:179], v[236:239], v[32:35], v[176:179]
    s_barrier
    ds_read_b128 v[216:219], v49 offset:45056
    v_mfma_f32_16x16x32_bf16 v[196:199], v[236:239], v[36:39], v[196:199]
    ds_read_b128 v[220:223], v49 offset:47104
    s_mov_b32 s60, 30000
    s_waitcnt vmcnt(0)
    s_branch pc_102
pl_101:
    buffer_load_dword v54, v53, s[12:15], s47 offen sc1
    s_waitcnt vmcnt(0)
pc_102:
    v_cmp_ne_u32 vcc, s26, v54
    s_nop 0
    s_cmp_eq_u64 vcc, 0
    s_cbranch_scc1 pdn_103
    s_sleep 1
    s_sub_u32 s60, s60, 1
    s_cbranch_scc0 pl_101
pdn_103:
    s_cmp_eq_u32 s27, 0
    s_cbranch_scc1 pi_104
    buffer_inv sc1
    s_waitcnt vmcnt(0)
pi_104:
    s_waitcnt lgkmcnt(5)
    v_mfma_f32_16x16x32_bf16 v[180:183], v[240:243], v[32:35], v[180:183]
    ds_read_b128 v[224:227], v49 offset:40960
    s_add_u32 s40, s59, 376832
    v_mfma_f32_16x16x32_bf16 v[200:203], v[240:243], v[36:39], v[200:203]
    ds_read_b128 v[228:231], v49 offset:43008
    buffer_load_dwordx4 v[96:99], v51, s[12:15], s40 offen sc1
    s_waitcnt lgkmcnt(6)
    v_mfma_f32_16x16x32_bf16 v[184:187], v[244:247], v[32:35], v[184:187]
    ds_read_b128 v[232:235], v49 offset:32768
    buffer_load_dwordx4 v[100:103], v52, s[12:15], s40 offen sc1
    v_mfma_f32_16x16x32_bf16 v[204:207], v[244:247], v[36:39], v[204:207]
    s_add_u32 s40, s40, 8192
    buffer_load_dwordx4 v[104:107], v51, s[12:15], s40 offen sc1
    s_waitcnt lgkmcnt(6)
    v_mfma_f32_16x16x32_bf16 v[188:191], v[248:251], v[32:35], v[188:191]
    buffer_load_dwordx4 v[108:111], v52, s[12:15], s40 offen sc1
    s_add_u32 s40, s40, 8192
    v_mfma_f32_16x16x32_bf16 v[208:211], v[248:251], v[36:39], v[208:211]
    s_waitcnt vmcnt(63)
    s_mov_b64 exec, 1
    s_cmp_eq_u32 s27, 0
    s_cbranch_scc1 pf_105
    s_waitcnt vmcnt(0)
    buffer_wbl2 sc1
    s_waitcnt vmcnt(0)
    buffer_store_dword v63, off, s[12:15], s57 sc1
    s_branch pd_106
pf_105:
    buffer_store_dword v63, off, s[12:15], s57
pd_106:
    s_mov_b64 exec, -1
    s_add_u32 s57, s57, 512
    s_waitcnt lgkmcnt(5)
    v_mfma_f32_16x16x32_bf16 v[192:195], v[252:255], v[32:35], v[192:195]
    v_mfma_f32_16x16x32_bf16 v[212:215], v[252:255], v[36:39], v[212:215]
    s_waitcnt lgkmcnt(4)
    v_mfma_f32_16x16x32_bf16 v[176:179], v[216:219], v[64:67], v[176:179]
    ds_read_b128 v[236:239], v49 offset:34816
    buffer_load_dwordx4 v[112:115], v51, s[12:15], s40 offen sc1
    v_mfma_f32_16x16x32_bf16 v[196:199], v[216:219], v[68:71], v[196:199]
    ds_read_b128 v[240:243], v49 offset:12288
    buffer_load_dwordx4 v[116:119], v52, s[12:15], s40 offen sc1
    s_waitcnt lgkmcnt(5)
    v_mfma_f32_16x16x32_bf16 v[180:183], v[220:223], v[64:67], v[180:183]
    ds_read_b128 v[244:247], v49 offset:14336
    s_add_u32 s40, s40, 8192
    v_mfma_f32_16x16x32_bf16 v[200:203], v[220:223], v[68:71], v[200:203]
    ds_read_b128 v[248:251], v49 offset:8192
    buffer_load_dwordx4 v[120:123], v51, s[12:15], s40 offen sc1
    s_waitcnt lgkmcnt(6)
    v_mfma_f32_16x16x32_bf16 v[184:187], v[224:227], v[64:67], v[184:187]
    ds_read_b128 v[252:255], v49 offset:10240
    buffer_load_dwordx4 v[124:127], v52, s[12:15], s40 offen sc1
    v_mfma_f32_16x16x32_bf16 v[204:207], v[224:227], v[68:71], v[204:207]
    s_add_u32 s40, s40, 8192
    s_waitcnt lgkmcnt(6)
    v_mfma_f32_16x16x32_bf16 v[188:191], v[228:231], v[64:67], v[188:191]
    v_mfma_f32_16x16x32_bf16 v[208:211], v[228:231], v[68:71], v[208:211]
    s_waitcnt lgkmcnt(5)
    v_mfma_f32_16x16x32_bf16 v[192:195], v[232:235], v[64:67], v[192:195]
    v_mfma_f32_16x16x32_bf16 v[212:215], v[232:235], v[68:71], v[212:215]
    s_waitcnt lgkmcnt(4)
    v_mfma_f32_16x16x32_bf16 v[176:179], v[236:239], v[72:75], v[176:179]
    ds_read_b128 v[216:219], v49 offset:4096
    buffer_load_dwordx4 v[8:11], v51, s[12:15], s40 offen sc1
    v_mfma_f32_16x16x32_bf16 v[196:199], v[236:239], v[76:79], v[196:199]
    ds_read_b128 v[220:223], v49 offset:6144
    buffer_load_dwordx4 v[12:15], v52, s[12:15], s40 offen sc1
    s_waitcnt lgkmcnt(5)
    v_mfma_f32_16x16x32_bf16 v[180:183], v[240:243], v[72:75], v[180:183]
    ds_read_b128 v[224:227], v49 offset:0
    s_add_u32 s40, s40, 8192
    v_mfma_f32_16x16x32_bf16 v[200:203], v[240:243], v[76:79], v[200:203]
    ds_read_b128 v[228:231], v49 offset:2048
    buffer_load_dwordx4 v[16:19], v51, s[12:15], s40 offen sc1
    s_waitcnt lgkmcnt(6)
    v_mfma_f32_16x16x32_bf16 v[184:187], v[244:247], v[72:75], v[184:187]
    ds_read_b128 v[232:235], v49 offset:28672
    buffer_load_dwordx4 v[20:23], v52, s[12:15], s40 offen sc1
    v_mfma_f32_16x16x32_bf16 v[204:207], v[244:247], v[76:79], v[204:207]
    s_add_u32 s40, s40, 8192
    buffer_load_dwordx2 v[140:141], v3, s[12:15], s49 offen sc1
    s_waitcnt lgkmcnt(6)
    v_mfma_f32_16x16x32_bf16 v[188:191], v[248:251], v[72:75], v[188:191]
    buffer_load_dwordx2 v[142:143], v3, s[12:15], s49 offen offset:1024 sc1
    buffer_load_dwordx4 v[128:131], v6, s[12:15], s48 offen sc1
    v_mfma_f32_16x16x32_bf16 v[208:211], v[248:251], v[76:79], v[208:211]
    buffer_load_dwordx4 v[132:135], v6, s[12:15], s50 offen sc1
    buffer_load_dwordx2 v[136:137], v55, s[12:15], s51 offen sc1
    s_waitcnt lgkmcnt(5)
    v_mfma_f32_16x16x32_bf16 v[192:195], v[252:255], v[72:75], v[192:195]
    v_mfma_f32_16x16x32_bf16 v[212:215], v[252:255], v[76:79], v[212:215]
    s_waitcnt lgkmcnt(4)
    v_mfma_f32_16x16x32_bf16 v[176:179], v[216:219], v[80:83], v[176:179]
    ds_read_b128 v[236:239], v49 offset:30720
    buffer_load_dwordx4 v[24:27], v51, s[12:15], s40 offen sc1
    v_mfma_f32_16x16x32_bf16 v[196:199], v[216:219], v[84:87], v[196:199]
    ds_read_b128 v[240:243], v49 offset:24576
    buffer_load_dwordx4 v[28:31], v52, s[12:15], s40 offen sc1
    s_waitcnt lgkmcnt(5)
    v_mfma_f32_16x16x32_bf16 v[180:183], v[220:223], v[80:83], v[180:183]
    ds_read_b128 v[244:247], v49 offset:26624
    s_add_u32 s40, s40, 8192
    v_mfma_f32_16x16x32_bf16 v[200:203], v[220:223], v[84:87], v[200:203]
    ds_read_b128 v[248:251], v49 offset:20480
    s_waitcnt lgkmcnt(6)
    v_mfma_f32_16x16x32_bf16 v[184:187], v[224:227], v[80:83], v[184:187]
    ds_read_b128 v[252:255], v49 offset:22528
    v_mfma_f32_16x16x32_bf16 v[204:207], v[224:227], v[84:87], v[204:207]
    s_waitcnt lgkmcnt(6)
    v_mfma_f32_16x16x32_bf16 v[188:191], v[228:231], v[80:83], v[188:191]
    v_mfma_f32_16x16x32_bf16 v[208:211], v[228:231], v[84:87], v[208:211]
    s_waitcnt lgkmcnt(5)
    v_mfma_f32_16x16x32_bf16 v[192:195], v[232:235], v[80:83], v[192:195]
    v_mfma_f32_16x16x32_bf16 v[212:215], v[232:235], v[84:87], v[212:215]
    s_waitcnt lgkmcnt(4)
    v_mfma_f32_16x16x32_bf16 v[176:179], v[236:239], v[88:91], v[176:179]
    s_barrier
    ds_read_b128 v[216:219], v50 offset:24576
    v_mfma_f32_16x16x32_bf16 v[196:199], v[236:239], v[92:95], v[196:199]
    ds_read_b128 v[220:223], v50 offset:26624
    s_add_u32 s47, s58, 1536
    s_waitcnt lgkmcnt(5)
    v_mfma_f32_16x16x32_bf16 v[180:183], v[240:243], v[88:91], v[180:183]
    ds_read_b128 v[224:227], v50 offset:20480
    buffer_load_dword v54, v53, s[12:15], s47 offen sc1
    v_mfma_f32_16x16x32_bf16 v[200:203], v[240:243], v[92:95], v[200:203]
    ds_read_b128 v[228:231], v50 offset:22528
    s_waitcnt lgkmcnt(6)
    v_mfma_f32_16x16x32_bf16 v[184:187], v[244:247], v[88:91], v[184:187]
    ds_read_b128 v[232:235], v50 offset:16384
    v_mfma_f32_16x16x32_bf16 v[204:207], v[244:247], v[92:95], v[204:207]
    s_waitcnt lgkmcnt(6)
    v_mfma_f32_16x16x32_bf16 v[188:191], v[248:251], v[88:91], v[188:191]
    v_mfma_f32_16x16x32_bf16 v[208:211], v[248:251], v[92:95], v[208:211]
    s_waitcnt lgkmcnt(5)
    v_mfma_f32_16x16x32_bf16 v[192:195], v[252:255], v[88:91], v[192:195]
    v_mfma_f32_16x16x32_bf16 v[212:215], v[252:255], v[92:95], v[212:215]
    s_waitcnt vmcnt(19)
    s_waitcnt lgkmcnt(4)
    v_mfma_f32_16x16x32_bf16 v[176:179], v[216:219], v[96:99], v[176:179]
    ds_read_b128 v[236:239], v50 offset:18432
    v_mfma_f32_16x16x32_bf16 v[196:199], v[216:219], v[100:103], v[196:199]
    ds_read_b128 v[240:243], v48 offset:61440
    s_waitcnt lgkmcnt(5)
    v_mfma_f32_16x16x32_bf16 v[180:183], v[220:223], v[96:99], v[180:183]
    ds_read_b128 v[244:247], v48 offset:63488
    v_mfma_f32_16x16x32_bf16 v[200:203], v[220:223], v[100:103], v[200:203]
    ds_read_b128 v[248:251], v48 offset:57344
    s_waitcnt lgkmcnt(6)
    v_mfma_f32_16x16x32_bf16 v[184:187], v[224:227], v[96:99], v[184:187]
    ds_read_b128 v[252:255], v48 offset:59392
    v_mfma_f32_16x16x32_bf16 v[204:207], v[224:227], v[100:103], v[204:207]
    s_waitcnt lgkmcnt(6)
    v_mfma_f32_16x16x32_bf16 v[188:191], v[228:231], v[96:99], v[188:191]
    v_mfma_f32_16x16x32_bf16 v[208:211], v[228:231], v[100:103], v[208:211]
    s_waitcnt lgkmcnt(5)
    v_mfma_f32_16x16x32_bf16 v[192:195], v[232:235], v[96:99], v[192:195]
    v_mfma_f32_16x16x32_bf16 v[212:215], v[232:235], v[100:103], v[212:215]
    s_waitcnt vmcnt(17)
    s_waitcnt lgkmcnt(4)
    v_mfma_f32_16x16x32_bf16 v[176:179], v[236:239], v[104:107], v[176:179]
    ds_read_b128 v[216:219], v48 offset:53248
    v_mfma_f32_16x16x32_bf16 v[196:199], v[236:239], v[108:111], v[196:199]
    ds_read_b128 v[220:223], v48 offset:55296
    s_waitcnt lgkmcnt(5)
    v_mfma_f32_16x16x32_bf16 v[180:183], v[240:243], v[104:107], v[180:183]
    ds_read_b128 v[224:227], v48 offset:49152
    v_mfma_f32_16x16x32_bf16 v[200:203], v[240:243], v[108:111], v[200:203]
    ds_read_b128 v[228:231], v48 offset:51200
    s_waitcnt lgkmcnt(6)
    v_mfma_f32_16x16x32_bf16 v[184:187], v[244:247], v[104:107], v[184:187]
    ds_read_b128 v[232:235], v48 offset:45056
    v_mfma_f32_16x16x32_bf16 v[204:207], v[244:247], v[108:111], v[204:207]
    s_waitcnt lgkmcnt(6)
    v_mfma_f32_16x16x32_bf16 v[188:191], v[248:251], v[104:107], v[188:191]
    v_mfma_f32_16x16x32_bf16 v[208:211], v[248:251], v[108:111], v[208:211]
    s_waitcnt lgkmcnt(5)
    v_mfma_f32_16x16x32_bf16 v[192:195], v[252:255], v[104:107], v[192:195]
    v_mfma_f32_16x16x32_bf16 v[212:215], v[252:255], v[108:111], v[212:215]
    s_waitcnt vmcnt(14)
    s_waitcnt lgkmcnt(4)
    v_mfma_f32_16x16x32_bf16 v[176:179], v[216:219], v[112:115], v[176:179]
    ds_read_b128 v[236:239], v48 offset:47104
    s_mov_b32 s60, 30000
    s_waitcnt vmcnt(0)
    s_branch pc_108
pl_107:
    buffer_load_dword v54, v53, s[12:15], s47 offen sc1
    s_waitcnt vmcnt(0)
pc_108:
    v_cmp_ne_u32 vcc, s26, v54
    s_nop 0
    s_cmp_eq_u64 vcc, 0
    s_cbranch_scc1 pdn_109
    s_sleep 1
    s_sub_u32 s60, s60, 1
    s_cbranch_scc0 pl_107
pdn_109:
    s_cmp_eq_u32 s27, 0
    s_cbranch_scc1 pi_110
    buffer_inv sc1
    s_waitcnt vmcnt(0)
pi_110:
    v_mfma_f32_16x16x32_bf16 v[196:199], v[216:219], v[116:119], v[196:199]
    ds_read_b128 v[240:243], v48 offset:40960
    s_add_u32 s40, s59, 442368
    s_waitcnt lgkmcnt(5)
    v_mfma_f32_16x16x32_bf16 v[180:183], v[220:223], v[112:115], v[180:183]
    ds_read_b128 v[244:247], v48 offset:43008
    buffer_load_dwordx4 v[32:35], v51, s[12:15], s40 offen sc1
    v_mfma_f32_16x16x32_bf16 v[200:203], v[220:223], v[116:119], v[200:203]
    ds_read_b128 v[248:251], v48 offset:36864
    buffer_load_dwordx4 v[36:39], v52, s[12:15], s40 offen sc1
    s_waitcnt lgkmcnt(6)
    v_mfma_f32_16x16x32_bf16 v[184:187], v[224:227], v[112:115], v[184:187]
    ds_read_b128 v[252:255], v48 offset:38912
    s_add_u32 s40, s40, 8192
    v_mfma_f32_16x16x32_bf16 v[204:207], v[224:227], v[116:119], v[204:207]
    buffer_load_dwordx4 v[64:67], v51, s[12:15], s40 offen sc1
    buffer_load_dwordx4 v[68:71], v52, s[12:15], s40 offen sc1
    s_waitcnt lgkmcnt(6)
    v_mfma_f32_16x16x32_bf16 v[188:191], v[228:231], v[112:115], v[188:191]
    s_add_u32 s40, s40, 8192
    v_mfma_f32_16x16x32_bf16 v[208:211], v[228:231], v[116:119], v[208:211]
    s_waitcnt lgkmcnt(5)
    v_mfma_f32_16x16x32_bf16 v[192:195], v[232:235], v[112:115], v[192:195]
    v_mfma_f32_16x16x32_bf16 v[212:215], v[232:235], v[116:119], v[212:215]
    s_waitcnt lgkmcnt(4)
    v_mfma_f32_16x16x32_bf16 v[176:179], v[236:239], v[120:123], v[176:179]
    s_barrier
    ds_read_b128 v[216:219], v50 offset:12288
    v_mfma_f32_16x16x32_bf16 v[196:199], v[236:239], v[124:127], v[196:199]
    ds_read_b128 v[220:223], v50 offset:14336
    buffer_load_dwordx4 v[72:75], v51, s[12:15], s40 offen sc1
    s_waitcnt lgkmcnt(5)
    v_mfma_f32_16x16x32_bf16 v[180:183], v[240:243], v[120:123], v[180:183]
    ds_read_b128 v[224:227], v50 offset:8192
    buffer_load_dwordx4 v[76:79], v52, s[12:15], s40 offen sc1
    v_mfma_f32_16x16x32_bf16 v[200:203], v[240:243], v[124:127], v[200:203]
    ds_read_b128 v[228:231], v50 offset:10240
    s_add_u32 s40, s40, 8192
    s_waitcnt lgkmcnt(6)
    v_mfma_f32_16x16x32_bf16 v[184:187], v[244:247], v[120:123], v[184:187]
    ds_read_b128 v[232:235], v50 offset:4096
    buffer_load_dwordx4 v[80:83], v51, s[12:15], s40 offen sc1
    v_mfma_f32_16x16x32_bf16 v[204:207], v[244:247], v[124:127], v[204:207]
    buffer_load_dwordx4 v[84:87], v52, s[12:15], s40 offen sc1
    s_add_u32 s40, s40, 8192
    s_waitcnt lgkmcnt(6)
    v_mfma_f32_16x16x32_bf16 v[188:191], v[248:251], v[120:123], v[188:191]
    v_mfma_f32_16x16x32_bf16 v[208:211], v[248:251], v[124:127], v[208:211]
    s_waitcnt lgkmcnt(5)
    v_mfma_f32_16x16x32_bf16 v[192:195], v[252:255], v[120:123], v[192:195]
    v_mfma_f32_16x16x32_bf16 v[212:215], v[252:255], v[124:127], v[212:215]
    s_waitcnt lgkmcnt(4)
    v_mfma_f32_16x16x32_bf16 v[176:179], v[216:219], v[8:11], v[176:179]
    ds_read_b128 v[236:239], v50 offset:6144
    v_mfma_f32_16x16x32_bf16 v[196:199], v[216:219], v[12:15], v[196:199]
    ds_read_b128 v[240:243], v50 offset:0
    v_add_f32 v140, v140, v142
    s_waitcnt lgkmcnt(5)
    v_mfma_f32_16x16x32_bf16 v[180:183], v[220:223], v[8:11], v[180:183]
    ds_read_b128 v[244:247], v50 offset:2048
    v_add_f32 v141, v141, v143
    v_mfma_f32_16x16x32_bf16 v[200:203], v[220:223], v[12:15], v[200:203]
    ds_read_b128 v[248:251], v49 offset:61440
    v_mov_b32 v138, v140
    s_waitcnt lgkmcnt(6)
    v_mfma_f32_16x16x32_bf16 v[184:187], v[224:227], v[8:11], v[184:187]
    ds_read_b128 v[252:255], v49 offset:63488
    v_mov_b32 v139, v141
    v_mfma_f32_16x16x32_bf16 v[204:207], v[224:227], v[12:15], v[204:207]
    v_permlane16_swap_b32 v140, v138
    v_permlane16_swap_b32 v141, v139
    s_waitcnt lgkmcnt(6)
    v_mfma_f32_16x16x32_bf16 v[188:191], v[228:231], v[8:11], v[188:191]
    v_add_f32 v140, v140, v138
    v_add_f32 v141, v141, v139
    v_mfma_f32_16x16x32_bf16 v[208:211], v[228:231], v[12:15], v[208:211]
    v_mov_b32 v138, v140
    v_mov_b32 v139, v141
    s_waitcnt lgkmcnt(5)
    v_mfma_f32_16x16x32_bf16 v[192:195], v[232:235], v[8:11], v[192:195]
    v_permlane32_swap_b32 v140, v138
    v_permlane32_swap_b32 v141, v139
    v_mfma_f32_16x16x32_bf16 v[212:215], v[232:235], v[12:15], v[212:215]
    v_add_f32 v140, v140, v138
    v_add_f32 v141, v141, v139
    s_waitcnt lgkmcnt(4)
    v_mfma_f32_16x16x32_bf16 v[176:179], v[236:239], v[16:19], v[176:179]
    ds_read_b128 v[216:219], v49 offset:36864
    v_mul_f32 v140, 986500301, v140
    v_mfma_f32_16x16x32_bf16 v[196:199], v[236:239], v[20:23], v[196:199]
    ds_read_b128 v[220:223], v49 offset:38912
    v_mul_f32 v141, 986500301, v141
    s_waitcnt lgkmcnt(5)
    v_mfma_f32_16x16x32_bf16 v[180:183], v[240:243], v[16:19], v[180:183]
    ds_read_b128 v[224:227], v49 offset:16384
    v_fma_f32 v141, -v140, v140, v141
    v_mfma_f32_16x16x32_bf16 v[200:203], v[240:243], v[20:23], v[200:203]
    ds_read_b128 v[228:231], v49 offset:18432
    v_max_f32 v141, 0, v141
    s_waitcnt lgkmcnt(6)
    v_mfma_f32_16x16x32_bf16 v[184:187], v[244:247], v[16:19], v[184:187]
    ds_read_b128 v[232:235], v48 offset:32768
    v_cvt_pk_bf16_f32 v141, v141, v141
    v_mfma_f32_16x16x32_bf16 v[204:207], v[244:247], v[20:23], v[204:207]
    v_and_b32 v141, 0xffff0000, v141
    v_add_f32 v141, 925353388, v141
    s_waitcnt lgkmcnt(6)
    v_mfma_f32_16x16x32_bf16 v[188:191], v[248:251], v[16:19], v[188:191]
    v_cvt_pk_bf16_f32 v141, v141, v141
    v_and_b32 v141, 0xffff0000, v141
    v_mfma_f32_16x16x32_bf16 v[208:211], v[248:251], v[20:23], v[208:211]
    v_sqrt_f32 v141, v141
    s_nop 0
    v_cvt_pk_bf16_f32 v141, v141, v141
    s_waitcnt lgkmcnt(5)
    v_mfma_f32_16x16x32_bf16 v[192:195], v[252:255], v[16:19], v[192:195]
    v_and_b32 v141, 0xffff0000, v141
    v_rcp_f32 v141, v141
    v_mfma_f32_16x16x32_bf16 v[212:215], v[252:255], v[20:23], v[212:215]
    v_mul_f32 v141, v141, v141
    v_mov_b32 v140, v141
    s_waitcnt lgkmcnt(4)
    v_mfma_f32_16x16x32_bf16 v[176:179], v[216:219], v[24:27], v[176:179]
    ds_read_b128 v[236:239], v48 offset:34816
    v_lshlrev_b32 v144, 16, v128
    v_mfma_f32_16x16x32_bf16 v[196:199], v[216:219], v[28:31], v[196:199]
    ds_read_b128 v[240:243], v48 offset:28672
    v_and_b32 v145, 0xffff0000, v128
    s_waitcnt lgkmcnt(5)
    v_mfma_f32_16x16x32_bf16 v[180:183], v[220:223], v[24:27], v[180:183]
    ds_read_b128 v[244:247], v48 offset:30720
    v_lshlrev_b32 v146, 16, v129
    v_mfma_f32_16x16x32_bf16 v[200:203], v[220:223], v[28:31], v[200:203]
    ds_read_b128 v[248:251], v48 offset:24576
    v_and_b32 v147, 0xffff0000, v129
    s_waitcnt lgkmcnt(6)
    v_mfma_f32_16x16x32_bf16 v[184:187], v[224:227], v[24:27], v[184:187]
    ds_read_b128 v[252:255], v48 offset:26624
    v_lshlrev_b32 v148, 16, v130
    v_mfma_f32_16x16x32_bf16 v[204:207], v[224:227], v[28:31], v[204:207]
    v_and_b32 v149, 0xffff0000, v130
    v_lshlrev_b32 v150, 16, v131
    s_waitcnt lgkmcnt(6)
    v_mfma_f32_16x16x32_bf16 v[188:191], v[228:231], v[24:27], v[188:191]
    v_and_b32 v151, 0xffff0000, v131
    v_lshlrev_b32 v152, 16, v132
    v_mfma_f32_16x16x32_bf16 v[208:211], v[228:231], v[28:31], v[208:211]
    v_and_b32 v153, 0xffff0000, v132
    v_lshlrev_b32 v154, 16, v133
    s_waitcnt lgkmcnt(5)
    v_mfma_f32_16x16x32_bf16 v[192:195], v[232:235], v[24:27], v[192:195]
    v_and_b32 v155, 0xffff0000, v133
    v_lshlrev_b32 v156, 16, v134
    v_mfma_f32_16x16x32_bf16 v[212:215], v[232:235], v[28:31], v[212:215]
    v_and_b32 v157, 0xffff0000, v134
    v_lshlrev_b32 v158, 16, v135
    s_waitcnt vmcnt(6)
    s_waitcnt lgkmcnt(4)
    v_mfma_f32_16x16x32_bf16 v[176:179], v[236:239], v[32:35], v[176:179]
    s_barrier
    ds_read_b128 v[216:219], v49 offset:57344
    v_mfma_f32_16x16x32_bf16 v[196:199], v[236:239], v[36:39], v[196:199]
    ds_read_b128 v[220:223], v49 offset:59392
    v_and_b32 v159, 0xffff0000, v135
    s_waitcnt lgkmcnt(5)
    v_mfma_f32_16x16x32_bf16 v[180:183], v[240:243], v[32:35], v[180:183]
    ds_read_b128 v[224:227], v49 offset:53248
    v_lshlrev_b32 v160, 16, v136
    v_mfma_f32_16x16x32_bf16 v[200:203], v[240:243], v[36:39], v[200:203]
    ds_read_b128 v[228:231], v49 offset:55296
    v_and_b32 v161, 0xffff0000, v136
    s_waitcnt lgkmcnt(6)
    v_mfma_f32_16x16x32_bf16 v[184:187], v[244:247], v[32:35], v[184:187]
    ds_read_b128 v[232:235], v49 offset:49152
    v_lshlrev_b32 v162, 16, v137
    v_mfma_f32_16x16x32_bf16 v[204:207], v[244:247], v[36:39], v[204:207]
    v_and_b32 v163, 0xffff0000, v137
    s_waitcnt lgkmcnt(6)
    v_mfma_f32_16x16x32_bf16 v[188:191], v[248:251], v[32:35], v[188:191]
    v_mfma_f32_16x16x32_bf16 v[208:211], v[248:251], v[36:39], v[208:211]
    s_waitcnt lgkmcnt(5)
    v_mfma_f32_16x16x32_bf16 v[192:195], v[252:255], v[32:35], v[192:195]
    v_mfma_f32_16x16x32_bf16 v[212:215], v[252:255], v[36:39], v[212:215]
    s_waitcnt vmcnt(4)
    s_waitcnt lgkmcnt(4)
    v_mfma_f32_16x16x32_bf16 v[176:179], v[216:219], v[64:67], v[176:179]
    ds_read_b128 v[236:239], v49 offset:51200
    v_mfma_f32_16x16x32_bf16 v[196:199], v[216:219], v[68:71], v[196:199]
    ds_read_b128 v[240:243], v49 offset:45056
    s_waitcnt lgkmcnt(5)
    v_mfma_f32_16x16x32_bf16 v[180:183], v[220:223], v[64:67], v[180:183]
    ds_read_b128 v[244:247], v49 offset:47104
    v_mfma_f32_16x16x32_bf16 v[200:203], v[220:223], v[68:71], v[200:203]
    ds_read_b128 v[248:251], v49 offset:40960
    s_waitcnt lgkmcnt(6)
    v_mfma_f32_16x16x32_bf16 v[184:187], v[224:227], v[64:67], v[184:187]
    ds_read_b128 v[252:255], v49 offset:43008
    v_mfma_f32_16x16x32_bf16 v[204:207], v[224:227], v[68:71], v[204:207]
    s_waitcnt lgkmcnt(6)
    v_mfma_f32_16x16x32_bf16 v[188:191], v[228:231], v[64:67], v[188:191]
    v_mfma_f32_16x16x32_bf16 v[208:211], v[228:231], v[68:71], v[208:211]
    s_waitcnt lgkmcnt(5)
    v_mfma_f32_16x16x32_bf16 v[192:195], v[232:235], v[64:67], v[192:195]
    v_mfma_f32_16x16x32_bf16 v[212:215], v[232:235], v[68:71], v[212:215]
    s_waitcnt vmcnt(2)
    s_waitcnt lgkmcnt(4)
    v_mfma_f32_16x16x32_bf16 v[176:179], v[236:239], v[72:75], v[176:179]
    ds_read_b128 v[216:219], v49 offset:32768
    v_mfma_f32_16x16x32_bf16 v[196:199], v[236:239], v[76:79], v[196:199]
    ds_read_b128 v[220:223], v49 offset:34816
    s_waitcnt lgkmcnt(5)
    v_mfma_f32_16x16x32_bf16 v[180:183], v[240:243], v[72:75], v[180:183]
    ds_read_b128 v[224:227], v49 offset:12288
    v_mfma_f32_16x16x32_bf16 v[200:203], v[240:243], v[76:79], v[200:203]
    ds_read_b128 v[228:231], v49 offset:14336
    s_waitcnt lgkmcnt(6)
    v_mfma_f32_16x16x32_bf16 v[184:187], v[244:247], v[72:75], v[184:187]
    ds_read_b128 v[232:235], v49 offset:8192
    v_mfma_f32_16x16x32_bf16 v[204:207], v[244:247], v[76:79], v[204:207]
    s_waitcnt lgkmcnt(6)
    v_mfma_f32_16x16x32_bf16 v[188:191], v[248:251], v[72:75], v[188:191]
    v_mfma_f32_16x16x32_bf16 v[208:211], v[248:251], v[76:79], v[208:211]
    s_waitcnt lgkmcnt(5)
    v_mfma_f32_16x16x32_bf16 v[192:195], v[252:255], v[72:75], v[192:195]
    v_mfma_f32_16x16x32_bf16 v[212:215], v[252:255], v[76:79], v[212:215]
    s_waitcnt vmcnt(0)
    s_waitcnt lgkmcnt(4)
    v_mfma_f32_16x16x32_bf16 v[196:199], v[216:219], v[84:87], v[196:199]
    s_waitcnt lgkmcnt(3)
    v_mfma_f32_16x16x32_bf16 v[200:203], v[220:223], v[84:87], v[200:203]
    s_waitcnt lgkmcnt(2)
    v_mfma_f32_16x16x32_bf16 v[204:207], v[224:227], v[84:87], v[204:207]
    s_waitcnt lgkmcnt(1)
    v_mfma_f32_16x16x32_bf16 v[208:211], v[228:231], v[84:87], v[208:211]
    s_waitcnt lgkmcnt(0)
    v_mfma_f32_16x16x32_bf16 v[212:215], v[232:235], v[84:87], v[212:215]
    v_mfma_f32_16x16x32_bf16 v[176:179], v[216:219], v[80:83], v[176:179]
    v_mfma_f32_16x16x32_bf16 v[180:183], v[220:223], v[80:83], v[180:183]
    ds_write_b128 v57, v[196:199] offset:0
    v_mfma_f32_16x16x32_bf16 v[184:187], v[224:227], v[80:83], v[184:187]
    ds_write_b128 v57, v[200:203] offset:1024
    v_mfma_f32_16x16x32_bf16 v[188:191], v[228:231], v[80:83], v[188:191]
    ds_write_b128 v57, v[204:207] offset:2048
    v_mfma_f32_16x16x32_bf16 v[192:195], v[232:235], v[80:83], v[192:195]
    ds_write_b128 v57, v[208:211] offset:3072
    ds_write_b128 v57, v[212:215] offset:4096
    s_waitcnt lgkmcnt(0)
    s_barrier
    ds_read_b128 v[196:199], v58 offset:0
    ds_read_b128 v[200:203], v58 offset:1024
    ds_read_b128 v[204:207], v58 offset:2048
    ds_read_b128 v[208:211], v58 offset:3072
    ds_read_b128 v[212:215], v58 offset:4096
    v_pk_fma_f32 v[144:145], v[176:177], v[140:141], v[144:145]
    v_pk_fma_f32 v[146:147], v[178:179], v[140:141], v[146:147]
    v_pk_fma_f32 v[148:149], v[180:181], v[140:141], v[148:149]
    v_pk_fma_f32 v[150:151], v[182:183], v[140:141], v[150:151]
    v_pk_fma_f32 v[152:153], v[184:185], v[140:141], v[152:153]
    v_pk_fma_f32 v[154:155], v[186:187], v[140:141], v[154:155]
    v_pk_fma_f32 v[156:157], v[188:189], v[140:141], v[156:157]
    v_pk_fma_f32 v[158:159], v[190:191], v[140:141], v[158:159]
    v_pk_fma_f32 v[160:161], v[192:193], v[140:141], v[160:161]
    v_pk_fma_f32 v[162:163], v[194:195], v[140:141], v[162:163]
    s_waitcnt lgkmcnt(4)
    v_pk_fma_f32 v[144:145], v[196:197], v[140:141], v[144:145]
    v_pk_fma_f32 v[146:147], v[198:199], v[140:141], v[146:147]
    v_cvt_pk_bf16_f32 v128, v144, v145
    v_cvt_pk_bf16_f32 v129, v146, v147
    s_waitcnt lgkmcnt(3)
    v_pk_fma_f32 v[148:149], v[200:201], v[140:141], v[148:149]
    v_pk_fma_f32 v[150:151], v[202:203], v[140:141], v[150:151]
    v_cvt_pk_bf16_f32 v130, v148, v149
    v_cvt_pk_bf16_f32 v131, v150, v151
    buffer_store_dwordx4 v[128:131], v60, s[16:19], s52 offen
    s_waitcnt lgkmcnt(2)
    v_pk_fma_f32 v[152:153], v[204:205], v[140:141], v[152:153]
    v_pk_fma_f32 v[154:155], v[206:207], v[140:141], v[154:155]
    v_cvt_pk_bf16_f32 v132, v152, v153
    v_cvt_pk_bf16_f32 v133, v154, v155
    s_waitcnt lgkmcnt(1)
    v_pk_fma_f32 v[156:157], v[208:209], v[140:141], v[156:157]
    v_pk_fma_f32 v[158:159], v[210:211], v[140:141], v[158:159]
    v_cvt_pk_bf16_f32 v134, v156, v157
    v_cvt_pk_bf16_f32 v135, v158, v159
    buffer_store_dwordx4 v[132:135], v60, s[16:19], s52 offen offset:64
    s_waitcnt lgkmcnt(0)
    v_pk_fma_f32 v[160:161], v[212:213], v[140:141], v[160:161]
    v_pk_fma_f32 v[162:163], v[214:215], v[140:141], v[162:163]
    v_cvt_pk_bf16_f32 v136, v160, v161
    v_cvt_pk_bf16_f32 v137, v162, v163
    buffer_store_dwordx2 v[136:137], v59, s[16:19], s52 offen offset:128
    s_branch L_fin
L_stc_r:
    s_mov_b32 s60, 30000
L_stc_l:
    buffer_load_dwordx3 v[128:130], v3, s[12:15], s61 offen offset:0 sc1
    buffer_load_dwordx3 v[132:134], v3, s[12:15], s61 offen offset:1024 sc1
    buffer_load_dwordx3 v[136:138], v3, s[12:15], s61 offen offset:2048 sc1
    buffer_load_dwordx3 v[140:142], v3, s[12:15], s61 offen offset:3072 sc1
    s_waitcnt vmcnt(0)
    v_xor_b32 v131, v130, v134
    v_xor_b32 v135, v138, v142
    v_xor_b32 v139, s26, v130
    v_xor_b32 v143, s26, v138
    v_or3_b32 v131, v131, v135, v139
    v_or_b32 v131, v131, v143
    v_cmp_ne_u32 vcc, 0, v131
    s_nop 0
    s_cmp_eq_u64 vcc, 0
    s_cbranch_scc1 L_stc_d
    s_sub_u32 s60, s60, 1
    s_cbranch_scc0 L_stc_l
    s_branch L_stc_d
L_pad4:
    s_setpc_b64 s[0:1]
L_loader45:
    s_and_b32 s45, s3, 3
    s_lshl_b32 s44, s45, 10
    s_lshr_b32 s46, s25, 1
    s_mul_i32 s40, s46, 286720
    s_add_u32 s40, s40, s44
    s_add_u32 s40, s40, 32505856
    s_lshr_b32 s48, s25, 2
    s_mul_i32 s41, s48, 276480
    s_add_u32 s41, s41, s44
    s_add_u32 s41, s41, 29360128
    v_add_u32 v4, s44, v3
    v_add_u32 v5, 0x10000, v4
    v_add_u32 v6, 0x20000, v4
    s_lshr_b32 s47, s45, 1
    s_lshl_b32 s47, s47, 4
    s_add_u32 s47, s47, s46
    s_mul_i32 s47, s47, 10240
    s_and_b32 s48, s45, 1
    s_lshl_b32 s48, s48, 8
    s_add_u32 s47, s47, s48
    s_add_u32 s50, s47, 262144
    s_add_u32 s51, s50, 4096
    s_add_u32 s52, s50, 8192
    v_lshrrev_b32 v14, 4, v2
    v_and_b32 v10, 15, v2
    v_lshlrev_b32 v14, 9, v14
    v_lshl_add_u32 v14, v10, 4, v14
    v_lshlrev_b32 v10, 2, v2
    v_min_u32 v8, 212, v10
    v_min_u32 v11, 76, v10
    s_lshl_b32 s48, s45, 8
    s_add_u32 s48, s48, 161792
    v_and_b32 v10, 255, v14
    v_add_u32 v10, s48, v10
    s_lshr_b32 s47, s25, 3
    s_lshl_b32 s47, s47, 8
    s_add_u32 s47, s47, 41472
    s_lshl_b32 s53, s46, 8
    s_add_u32 s53, s53, 69712
    s_barrier
    s_waitcnt vmcnt(0)
    s_cmp_eq_u32 s29, 9999
    s_cbranch_scc1 L_ld_nr
    v_mov_b32 v13, s26
    s_waitcnt vmcnt(0)
    s_mov_b64 exec, 1
    buffer_store_dword v13, off, s[12:15], s29 sc1
    s_mov_b64 exec, -1
L_ld_nr:
    s_barrier
    s_add_u32 m0, s44, 53248
    s_add_u32 s49, s40, 0
    buffer_load_dwordx4 v3, s[12:15], s49 offen sc1 lds
    s_add_u32 m0, s44, 49152
    s_add_u32 s49, s40, 4096
    buffer_load_dwordx4 v3, s[12:15], s49 offen sc1 lds
    s_add_u32 m0, s44, 45056
    s_add_u32 s49, s40, 8192
    buffer_load_dwordx4 v3, s[12:15], s49 offen sc1 lds
    s_add_u32 m0, s44, 40960
    s_add_u32 s49, s40, 12288
    buffer_load_dwordx4 v3, s[12:15], s49 offen sc1 lds
    s_add_u32 m0, s44, 36864
    s_add_u32 s49, s40, 16384
    buffer_load_dwordx4 v3, s[12:15], s49 offen sc1 lds
    s_add_u32 m0, s44, 32768
    s_add_u32 s49, s40, 20480
    buffer_load_dwordx4 v3, s[12:15], s49 offen sc1 lds
    s_add_u32 m0, s44, 28672
    s_add_u32 s49, s40, 24576
    buffer_load_dwordx4 v3, s[12:15], s49 offen sc1 lds
    s_add_u32 m0, s44, 24576
    s_add_u32 s49, s40, 28672
    buffer_load_dwordx4 v3, s[12:15], s49 offen sc1 lds
    s_add_u32 m0, s44, 20480
    s_add_u32 s49, s40, 32768
    buffer_load_dwordx4 v3, s[12:15], s49 offen sc1 lds
    s_add_u32 m0, s44, 16384
    s_add_u32 s49, s40, 36864
    buffer_load_dwordx4 v3, s[12:15], s49 offen sc1 lds
    s_add_u32 m0, s44, 12288
    s_add_u32 s49, s40, 40960
    buffer_load_dwordx4 v3, s[12:15], s49 offen sc1 lds
    s_add_u32 m0, s44, 8192
    s_add_u32 s49, s40, 45056
    buffer_load_dwordx4 v3, s[12:15], s49 offen sc1 lds
    s_add_u32 m0, s44, 4096
    s_add_u32 s49, s40, 49152
    buffer_load_dwordx4 v3, s[12:15], s49 offen sc1 lds
    s_add_u32 m0, s44, 0
    s_add_u32 s49, s40, 53248
    buffer_load_dwordx4 v3, s[12:15], s49 offen sc1 lds
    s_add_u32 s49, s40, 73728
    buffer_load_dwordx4 v[216:219], v3, s[12:15], s49 offen sc1
    s_add_u32 s49, s40, 77824
    buffer_load_dwordx4 v[220:223], v3, s[12:15], s49 offen sc1
    s_add_u32 s49, s40, 81920
    buffer_load_dwordx4 v[224:227], v3, s[12:15], s49 offen sc1
    s_add_u32 s49, s40, 86016
    buffer_load_dwordx4 v[228:231], v3, s[12:15], s49 offen sc1
    s_add_u32 s49, s40, 90112
    buffer_load_dwordx4 v[232:235], v3, s[12:15], s49 offen sc1
    s_add_u32 s49, s40, 94208
    buffer_load_dwordx4 v[236:239], v3, s[12:15], s49 offen sc1
    s_add_u32 s49, s40, 98304
    buffer_load_dwordx4 v[240:243], v3, s[12:15], s49 offen sc1
    s_add_u32 s49, s40, 102400
    buffer_load_dwordx4 v[244:247], v3, s[12:15], s49 offen sc1
    s_waitcnt vmcnt(14)
    s_barrier
    ds_write_b128 v4, v[200:203] offset:57344
    ds_write_b128 v4, v[204:207] offset:61440
    ds_write_b128 v5, v[208:211] offset:0
    ds_write_b128 v5, v[212:215] offset:4096
    s_waitcnt vmcnt(7)
    ds_write_b128 v5, v[216:219] offset:8192
    s_waitcnt vmcnt(6)
    ds_write_b128 v5, v[220:223] offset:12288
    s_waitcnt vmcnt(5)
    ds_write_b128 v5, v[224:227] offset:16384
    s_waitcnt vmcnt(4)
    ds_write_b128 v5, v[228:231] offset:20480
    s_waitcnt vmcnt(3)
    ds_write_b128 v5, v[232:235] offset:24576
    s_waitcnt vmcnt(2)
    ds_write_b128 v5, v[236:239] offset:28672
    s_waitcnt vmcnt(1)
    ds_write_b128 v5, v[240:243] offset:32768
    s_waitcnt vmcnt(0)
    ds_write_b128 v5, v[244:247] offset:36864
    s_waitcnt lgkmcnt(0)
    buffer_load_dword v12, v11, s[12:15], s53 offen sc1
    buffer_load_dword v9, v8, s[12:15], s47 offen sc1
    s_barrier
    s_mov_b32 s48, 30000
    s_waitcnt vmcnt(0)
    s_branch pc_112
pl_111:
    buffer_load_dword v12, v11, s[12:15], s53 offen sc1
    s_waitcnt vmcnt(0)
pc_112:
    v_cmp_ne_u32 vcc, s26, v12
    s_nop 0
    s_cmp_eq_u64 vcc, 0
    s_cbranch_scc1 pdn_113
    s_sleep 1
    s_sub_u32 s48, s48, 1
    s_cbranch_scc0 pl_111
pdn_113:
    s_mov_b32 s48, 30000
    s_waitcnt vmcnt(63)
    s_branch pc_115
pl_114:
    buffer_load_dword v9, v8, s[12:15], s47 offen sc1
    s_waitcnt vmcnt(0)
pc_115:
    v_cmp_ne_u32 vcc, s26, v9
    s_nop 0
    s_cmp_eq_u64 vcc, 0
    s_cbranch_scc1 pdn_116
    s_sleep 1
    s_sub_u32 s48, s48, 1
    s_cbranch_scc0 pl_114
pdn_116:
    s_add_u32 m0, s44, 155648
    s_add_u32 s49, s40, 106496
    buffer_load_dwordx4 v3, s[12:15], s49 offen sc1 lds
    s_add_u32 m0, s44, 151552
    s_add_u32 s49, s40, 110592
    buffer_load_dwordx4 v3, s[12:15], s49 offen sc1 lds
    s_add_u32 m0, s44, 147456
    s_add_u32 s49, s40, 114688
    buffer_load_dwordx4 v3, s[12:15], s49 offen sc1 lds
    s_add_u32 m0, s44, 143360
    s_add_u32 s49, s40, 118784
    buffer_load_dwordx4 v3, s[12:15], s49 offen sc1 lds
    s_add_u32 m0, s44, 139264
    s_add_u32 s49, s40, 122880
    buffer_load_dwordx4 v3, s[12:15], s49 offen sc1 lds
    s_add_u32 m0, s44, 135168
    s_add_u32 s49, s40, 126976
    buffer_load_dwordx4 v3, s[12:15], s49 offen sc1 lds
    s_add_u32 m0, s44, 131072
    s_add_u32 s49, s40, 131072
    buffer_load_dwordx4 v3, s[12:15], s49 offen sc1 lds
    s_add_u32 m0, s44, 126976
    s_add_u32 s49, s40, 135168
    buffer_load_dwordx4 v3, s[12:15], s49 offen sc1 lds
    s_barrier
    buffer_load_dwordx4 v[180:183], v14, s[12:15], s50 offen offset:0 sc1
    buffer_load_dwordx4 v[184:187], v14, s[12:15], s50 offen offset:2048 sc1
    buffer_load_dwordx4 v[188:191], v14, s[12:15], s51 offen offset:0 sc1
    buffer_load_dwordx4 v[192:195], v14, s[12:15], s51 offen offset:2048 sc1
    buffer_load_dwordx4 v[196:199], v14, s[12:15], s52 offen offset:0 sc1
    s_add_u32 m0, s44, 122880
    s_add_u32 s49, s40, 139264
    buffer_load_dwordx4 v3, s[12:15], s49 offen sc1 lds
    s_add_u32 m0, s44, 118784
    s_add_u32 s49, s40, 143360
    buffer_load_dwordx4 v3, s[12:15], s49 offen sc1 lds
    s_add_u32 m0, s44, 114688
    s_add_u32 s49, s40, 147456
    buffer_load_dwordx4 v3, s[12:15], s49 offen sc1 lds
    s_add_u32 m0, s44, 110592
    s_add_u32 s49, s40, 151552
    buffer_load_dwordx4 v3, s[12:15], s49 offen sc1 lds
    s_barrier
    s_add_u32 m0, s44, 106496
    s_add_u32 s49, s40, 155648
    buffer_load_dwordx4 v3, s[12:15], s49 offen sc1 lds
    s_add_u32 m0, s44, 69632
    s_add_u32 s49, s40, 159744
    buffer_load_dwordx4 v3, s[12:15], s49 offen sc1 lds
    s_add_u32 m0, s44, 65536
    s_add_u32 s49, s40, 163840
    buffer_load_dwordx4 v3, s[12:15], s49 offen sc1 lds
    s_add_u32 m0, s44, 61440
    s_add_u32 s49, s40, 167936
    buffer_load_dwordx4 v3, s[12:15], s49 offen sc1 lds
    s_add_u32 m0, s44, 57344
    s_add_u32 s49, s40, 172032
    buffer_load_dwordx4 v3, s[12:15], s49 offen sc1 lds
    s_add_u32 m0, s44, 53248
    s_add_u32 s49, s40, 176128
    buffer_load_dwordx4 v3, s[12:15], s49 offen sc1 lds
    s_add_u32 m0, s44, 49152
    s_add_u32 s49, s40, 180224
    buffer_load_dwordx4 v3, s[12:15], s49 offen sc1 lds
    s_waitcnt vmcnt(18)
    s_barrier
    s_add_u32 m0, s44, 94208
    s_add_u32 s49, s40, 204800
    buffer_load_dwordx4 v3, s[12:15], s49 offen sc1 lds
    s_waitcnt vmcnt(12)
    v_add_f32 v180, v180, v184
    v_add_f32 v181, v181, v185
    v_add_f32 v182, v182, v186
    v_add_f32 v183, v183, v187
    v_add_f32 v180, v180, v188
    v_add_f32 v181, v181, v189
    v_add_f32 v182, v182, v190
    v_add_f32 v183, v183, v191
    v_add_f32 v180, v180, v192
    v_add_f32 v181, v181, v193
    v_add_f32 v182, v182, v194
    v_add_f32 v183, v183, v195
    v_add_f32 v180, v180, v196
    v_add_f32 v181, v181, v197
    s_add_u32 m0, s44, 90112
    s_add_u32 s49, s40, 208896
    buffer_load_dwordx4 v3, s[12:15], s49 offen sc1 lds
    v_add_f32 v182, v182, v198
    v_add_f32 v183, v183, v199
    v_mov_b32 v184, v180
    v_mov_b32 v185, v181
    v_mov_b32 v186, v182
    v_mov_b32 v187, v183
    v_permlane16_swap_b32 v180, v184
    v_permlane16_swap_b32 v181, v185
    v_permlane16_swap_b32 v182, v186
    v_permlane16_swap_b32 v183, v187
    v_add_f32 v180, v180, v184
    v_add_f32 v181, v181, v185
    v_add_f32 v182, v182, v186
    v_add_f32 v183, v183, v187
    s_add_u32 m0, s44, 86016
    s_add_u32 s49, s40, 212992
    buffer_load_dwordx4 v3, s[12:15], s49 offen sc1 lds
    v_mov_b32 v184, v180
    v_mov_b32 v185, v181
    v_mov_b32 v186, v182
    v_mov_b32 v187, v183
    v_permlane32_swap_b32 v180, v184
    v_permlane32_swap_b32 v181, v185
    v_permlane32_swap_b32 v182, v186
    v_permlane32_swap_b32 v183, v187
    v_add_f32 v180, v180, v184
    v_add_f32 v181, v181, v185
    v_add_f32 v182, v182, v186
    v_add_f32 v183, v183, v187
    ds_write_b128 v10, v[180:183]
    s_add_u32 m0, s44, 81920
    s_add_u32 s49, s40, 217088
    buffer_load_dwordx4 v3, s[12:15], s49 offen sc1 lds
    s_waitcnt lgkmcnt(0)
    s_waitcnt vmcnt(11)
    s_barrier
    s_add_u32 m0, s44, 155648
    s_add_u32 s49, s40, 221184
    buffer_load_dwordx4 v3, s[12:15], s49 offen sc1 lds
    s_add_u32 m0, s44, 151552
    s_add_u32 s49, s40, 225280
    buffer_load_dwordx4 v3, s[12:15], s49 offen sc1 lds
    s_add_u32 m0, s44, 147456
    s_add_u32 s49, s40, 229376
    buffer_load_dwordx4 v3, s[12:15], s49 offen sc1 lds
    s_add_u32 m0, s44, 143360
    s_add_u32 s49, s40, 233472
    buffer_load_dwordx4 v3, s[12:15], s49 offen sc1 lds
    s_add_u32 m0, s44, 102400
    s_add_u32 s49, s40, 237568
    buffer_load_dwordx4 v3, s[12:15], s49 offen sc1 lds
    s_waitcnt vmcnt(10)
    s_barrier
    s_add_u32 m0, s44, 139264
    s_add_u32 s49, s40, 241664
    buffer_load_dwordx4 v3, s[12:15], s49 offen sc1 lds
    s_add_u32 m0, s44, 135168
    s_add_u32 s49, s40, 245760
    buffer_load_dwordx4 v3, s[12:15], s49 offen sc1 lds
    s_add_u32 m0, s44, 131072
    s_add_u32 s49, s40, 249856
    buffer_load_dwordx4 v3, s[12:15], s49 offen sc1 lds
    s_add_u32 m0, s44, 126976
    s_add_u32 s49, s40, 253952
    buffer_load_dwordx4 v3, s[12:15], s49 offen sc1 lds
    s_add_u32 m0, s44, 122880
    s_add_u32 s49, s40, 258048
    buffer_load_dwordx4 v3, s[12:15], s49 offen sc1 lds
    s_add_u32 m0, s44, 118784
    s_add_u32 s49, s40, 262144
    buffer_load_dwordx4 v3, s[12:15], s49 offen sc1 lds
    s_add_u32 m0, s44, 98304
    s_add_u32 s49, s40, 266240
    buffer_load_dwordx4 v3, s[12:15], s49 offen sc1 lds
    s_add_u32 m0, s44, 77824
    s_add_u32 s49, s40, 270336
    buffer_load_dwordx4 v3, s[12:15], s49 offen sc1 lds
    s_add_u32 m0, s44, 73728
    s_add_u32 s49, s40, 274432
    buffer_load_dwordx4 v3, s[12:15], s49 offen sc1 lds
    s_add_u32 m0, s44, 45056
    s_add_u32 s49, s40, 278528
    buffer_load_dwordx4 v3, s[12:15], s49 offen sc1 lds
    s_waitcnt vmcnt(14)
    s_barrier
    s_add_u32 m0, s44, 114688
    s_add_u32 s49, s40, 282624
    buffer_load_dwordx4 v3, s[12:15], s49 offen sc1 lds
    s_add_u32 m0, s44, 110592
    s_add_u32 s49, s40, 184320
    buffer_load_dwordx4 v3, s[12:15], s49 offen sc1 lds
    s_add_u32 m0, s44, 106496
    s_add_u32 s49, s40, 188416
    buffer_load_dwordx4 v3, s[12:15], s49 offen sc1 lds
    s_add_u32 m0, s44, 69632
    s_add_u32 s49, s40, 192512
    buffer_load_dwordx4 v3, s[12:15], s49 offen sc1 lds
    s_add_u32 m0, s44, 65536
    s_add_u32 s49, s40, 196608
    buffer_load_dwordx4 v3, s[12:15], s49 offen sc1 lds
    s_add_u32 m0, s44, 61440
    s_add_u32 s49, s40, 200704
    buffer_load_dwordx4 v3, s[12:15], s49 offen sc1 lds
    s_add_u32 m0, s44, 40960
    s_add_u32 s49, s41, 0
    buffer_load_dwordx4 v3, s[12:15], s49 offen sc1 lds
    s_add_u32 m0, s44, 36864
    s_add_u32 s49, s41, 4096
    buffer_load_dwordx4 v3, s[12:15], s49 offen sc1 lds
    s_add_u32 m0, s44, 32768
    s_add_u32 s49, s41, 8192
    buffer_load_dwordx4 v3, s[12:15], s49 offen sc1 lds
    s_add_u32 m0, s44, 28672
    s_add_u32 s49, s41, 12288
    buffer_load_dwordx4 v3, s[12:15], s49 offen sc1 lds
    s_waitcnt vmcnt(18)
    s_barrier
    s_add_u32 m0, s44, 94208
    s_add_u32 s49, s41, 16384
    buffer_load_dwordx4 v3, s[12:15], s49 offen sc1 lds
    s_add_u32 m0, s44, 90112
    s_add_u32 s49, s41, 20480
    buffer_load_dwordx4 v3, s[12:15], s49 offen sc1 lds
    s_add_u32 m0, s44, 86016
    s_add_u32 s49, s41, 24576
    buffer_load_dwordx4 v3, s[12:15], s49 offen sc1 lds
    s_add_u32 m0, s44, 57344
    s_add_u32 s49, s41, 28672
    buffer_load_dwordx4 v3, s[12:15], s49 offen sc1 lds
    s_add_u32 m0, s44, 53248
    s_add_u32 s49, s41, 32768
    buffer_load_dwordx4 v3, s[12:15], s49 offen sc1 lds
    s_add_u32 m0, s44, 49152
    s_add_u32 s49, s41, 36864
    buffer_load_dwordx4 v3, s[12:15], s49 offen sc1 lds
    s_add_u32 m0, s44, 24576
    s_add_u32 s49, s41, 40960
    buffer_load_dwordx4 v3, s[12:15], s49 offen sc1 lds
    s_add_u32 m0, s44, 20480
    s_add_u32 s49, s41, 45056
    buffer_load_dwordx4 v3, s[12:15], s49 offen sc1 lds
    s_add_u32 m0, s44, 16384
    s_add_u32 s49, s41, 49152
    buffer_load_dwordx4 v3, s[12:15], s49 offen sc1 lds
    s_add_u32 m0, s44, 12288
    s_add_u32 s49, s41, 53248
    buffer_load_dwordx4 v3, s[12:15], s49 offen sc1 lds
    s_waitcnt vmcnt(22)
    s_barrier
    s_add_u32 m0, s44, 155648
    s_add_u32 s49, s41, 57344
    buffer_load_dwordx4 v3, s[12:15], s49 offen sc1 lds
    s_add_u32 m0, s44, 151552
    s_add_u32 s49, s41, 61440
    buffer_load_dwordx4 v3, s[12:15], s49 offen sc1 lds
    s_add_u32 m0, s44, 147456
    s_add_u32 s49, s41, 65536
    buffer_load_dwordx4 v3, s[12:15], s49 offen sc1 lds
    s_add_u32 m0, s44, 143360
    s_add_u32 s49, s41, 69632
    buffer_load_dwordx4 v3, s[12:15], s49 offen sc1 lds
    s_add_u32 m0, s44, 102400
    s_add_u32 s49, s41, 73728
    buffer_load_dwordx4 v3, s[12:15], s49 offen sc1 lds
    s_add_u32 m0, s44, 81920
    s_add_u32 s49, s41, 77824
    buffer_load_dwordx4 v3, s[12:15], s49 offen sc1 lds
    s_add_u32 m0, s44, 8192
    s_add_u32 s49, s41, 81920
    buffer_load_dwordx4 v3, s[12:15], s49 offen sc1 lds
    s_add_u32 m0, s44, 4096
    s_add_u32 s49, s41, 86016
    buffer_load_dwordx4 v3, s[12:15], s49 offen sc1 lds
    s_add_u32 m0, s44, 0
    s_add_u32 s49, s41, 90112
    buffer_load_dwordx4 v3, s[12:15], s49 offen sc1 lds
    s_waitcnt vmcnt(23)
    s_barrier
    s_add_u32 m0, s44, 139264
    s_add_u32 s49, s41, 94208
    buffer_load_dwordx4 v3, s[12:15], s49 offen sc1 lds
    s_add_u32 m0, s44, 135168
    s_add_u32 s49, s41, 98304
    buffer_load_dwordx4 v3, s[12:15], s49 offen sc1 lds
    s_add_u32 m0, s44, 131072
    s_add_u32 s49, s41, 102400
    buffer_load_dwordx4 v3, s[12:15], s49 offen sc1 lds
    s_add_u32 m0, s44, 126976
    s_add_u32 s49, s41, 106496
    buffer_load_dwordx4 v3, s[12:15], s49 offen sc1 lds
    s_add_u32 m0, s44, 122880
    s_add_u32 s49, s41, 110592
    buffer_load_dwordx4 v3, s[12:15], s49 offen sc1 lds
    s_add_u32 m0, s44, 118784
    s_add_u32 s49, s41, 114688
    buffer_load_dwordx4 v3, s[12:15], s49 offen sc1 lds
    s_waitcnt vmcnt(19)
    s_barrier
    s_add_u32 m0, s44, 114688
    s_add_u32 s49, s41, 118784
    buffer_load_dwordx4 v3, s[12:15], s49 offen sc1 lds
    s_add_u32 m0, s44, 110592
    s_add_u32 s49, s41, 122880
    buffer_load_dwordx4 v3, s[12:15], s49 offen sc1 lds
    s_add_u32 m0, s44, 106496
    s_add_u32 s49, s41, 126976
    buffer_load_dwordx4 v3, s[12:15], s49 offen sc1 lds
    s_add_u32 m0, s44, 98304
    s_add_u32 s49, s41, 131072
    buffer_load_dwordx4 v3, s[12:15], s49 offen sc1 lds
    s_add_u32 m0, s44, 77824
    s_add_u32 s49, s41, 135168
    buffer_load_dwordx4 v3, s[12:15], s49 offen sc1 lds
    s_add_u32 m0, s44, 73728
    s_add_u32 s49, s41, 139264
    buffer_load_dwordx4 v3, s[12:15], s49 offen sc1 lds
    s_add_u32 m0, s44, 69632
    s_add_u32 s49, s41, 143360
    buffer_load_dwordx4 v3, s[12:15], s49 offen sc1 lds
    s_add_u32 m0, s44, 65536
    s_add_u32 s49, s41, 147456
    buffer_load_dwordx4 v3, s[12:15], s49 offen sc1 lds
    s_waitcnt vmcnt(17)
    s_barrier
    s_add_u32 m0, s44, 94208
    s_add_u32 s49, s41, 151552
    buffer_load_dwordx4 v3, s[12:15], s49 offen sc1 lds
    s_add_u32 m0, s44, 90112
    s_add_u32 s49, s41, 155648
    buffer_load_dwordx4 v3, s[12:15], s49 offen sc1 lds
    s_add_u32 m0, s44, 86016
    s_add_u32 s49, s41, 159744
    buffer_load_dwordx4 v3, s[12:15], s49 offen sc1 lds
    s_waitcnt vmcnt(10)
    s_barrier
    s_add_u32 m0, s44, 155648
    s_add_u32 s49, s41, 163840
    buffer_load_dwordx4 v3, s[12:15], s49 offen sc1 lds
    s_add_u32 m0, s44, 151552
    s_add_u32 s49, s41, 167936
    buffer_load_dwordx4 v3, s[12:15], s49 offen sc1 lds
    s_add_u32 m0, s44, 147456
    s_add_u32 s49, s41, 172032
    buffer_load_dwordx4 v3, s[12:15], s49 offen sc1 lds
    s_add_u32 m0, s44, 61440
    s_add_u32 s49, s41, 176128
    buffer_load_dwordx4 v3, s[12:15], s49 offen sc1 lds
    s_add_u32 m0, s44, 57344
    s_add_u32 s49, s41, 180224
    buffer_load_dwordx4 v3, s[12:15], s49 offen sc1 lds
    s_add_u32 m0, s44, 53248
    s_add_u32 s49, s41, 184320
    buffer_load_dwordx4 v3, s[12:15], s49 offen sc1 lds
    s_add_u32 m0, s44, 49152
    s_add_u32 s49, s41, 188416
    buffer_load_dwordx4 v3, s[12:15], s49 offen sc1 lds
    s_add_u32 m0, s44, 45056
    s_add_u32 s49, s41, 192512
    buffer_load_dwordx4 v3, s[12:15], s49 offen sc1 lds
    s_add_u32 m0, s44, 40960
    s_add_u32 s49, s41, 196608
    buffer_load_dwordx4 v3, s[12:15], s49 offen sc1 lds
    s_add_u32 m0, s44, 36864
    s_add_u32 s49, s41, 200704
    buffer_load_dwordx4 v3, s[12:15], s49 offen sc1 lds
    s_waitcnt vmcnt(10)
    s_barrier
    s_add_u32 m0, s44, 143360
    s_add_u32 s49, s41, 204800
    buffer_load_dwordx4 v3, s[12:15], s49 offen sc1 lds
    s_add_u32 m0, s44, 139264
    s_add_u32 s49, s41, 208896
    buffer_load_dwordx4 v3, s[12:15], s49 offen sc1 lds
    s_add_u32 m0, s44, 135168
    s_add_u32 s49, s41, 212992
    buffer_load_dwordx4 v3, s[12:15], s49 offen sc1 lds
    s_add_u32 m0, s44, 131072
    s_add_u32 s49, s41, 217088
    buffer_load_dwordx4 v3, s[12:15], s49 offen sc1 lds
    s_add_u32 m0, s44, 126976
    s_add_u32 s49, s41, 221184
    buffer_load_dwordx4 v3, s[12:15], s49 offen sc1 lds
    s_add_u32 m0, s44, 102400
    s_add_u32 s49, s41, 225280
    buffer_load_dwordx4 v3, s[12:15], s49 offen sc1 lds
    s_add_u32 m0, s44, 81920
    s_add_u32 s49, s41, 229376
    buffer_load_dwordx4 v3, s[12:15], s49 offen sc1 lds
    s_add_u32 m0, s44, 32768
    s_add_u32 s49, s41, 233472
    buffer_load_dwordx4 v3, s[12:15], s49 offen sc1 lds
    s_add_u32 m0, s44, 28672
    s_add_u32 s49, s41, 237568
    buffer_load_dwordx4 v3, s[12:15], s49 offen sc1 lds
    s_add_u32 m0, s44, 24576
    s_add_u32 s49, s41, 241664
    buffer_load_dwordx4 v3, s[12:15], s49 offen sc1 lds
    s_waitcnt vmcnt(10)
    s_barrier
    s_add_u32 m0, s44, 122880
    s_add_u32 s49, s41, 245760
    buffer_load_dwordx4 v3, s[12:15], s49 offen sc1 lds
    s_add_u32 m0, s44, 118784
    s_add_u32 s49, s41, 249856
    buffer_load_dwordx4 v3, s[12:15], s49 offen sc1 lds
    s_add_u32 m0, s44, 114688
    s_add_u32 s49, s41, 253952
    buffer_load_dwordx4 v3, s[12:15], s49 offen sc1 lds
    s_add_u32 m0, s44, 110592
    s_add_u32 s49, s41, 258048
    buffer_load_dwordx4 v3, s[12:15], s49 offen sc1 lds
    s_add_u32 m0, s44, 106496
    s_add_u32 s49, s41, 262144
    buffer_load_dwordx4 v3, s[12:15], s49 offen sc1 lds
    s_add_u32 m0, s44, 98304
    s_add_u32 s49, s41, 266240
    buffer_load_dwordx4 v3, s[12:15], s49 offen sc1 lds
    s_add_u32 m0, s44, 77824
    s_add_u32 s49, s41, 270336
    buffer_load_dwordx4 v3, s[12:15], s49 offen sc1 lds
    s_add_u32 m0, s44, 73728
    s_add_u32 s49, s41, 274432
    buffer_load_dwordx4 v3, s[12:15], s49 offen sc1 lds
    s_waitcnt vmcnt(8)
    s_barrier
    s_waitcnt vmcnt(0)
    s_barrier
    s_barrier
L_fin:
    s_endpgm
L_rissue:
    s_cmp_lt_u32 s29, 296
    s_cbranch_scc1 rib_117
    s_sub_u32 s48, s29, 296
    s_and_b32 s49, s48, 15
    s_lshr_b32 s48, s48, 4
    s_mul_i32 s51, s48, 13
    s_lshr_b32 s51, s51, 7
    s_mul_i32 s50, s51, 10
    s_sub_u32 s50, s48, s50
    s_lshr_b32 s58, s51, 1
    s_and_b32 s51, s51, 1
    s_and_b32 s52, s49, 7
    s_mul_i32 s53, s52, 224
    s_lshr_b32 s54, s49, 3
    s_mul_i32 s54, s54, 1728
    s_add_u32 s53, s53, s54
    s_mul_i32 s54, s58, 10
    s_add_u32 s54, s54, s50
    s_mul_i32 s54, s54, 110592
    s_add_u32 s53, s53, s54
    s_cmp_eq_u32 s51, 0
    s_cselect_b32 s20, s32, s34
    s_cselect_b32 s21, s33, s35
    s_and_b32 s21, s21, 0xffff
    s_mov_b32 s22, 2211840
    v_and_b32 v30, 15, v2
    v_min_u32 v30, 13, v30
    v_lshrrev_b32 v31, 4, v2
    v_mul_u32_u24 v31, 3456, v31
    v_lshl_add_u32 v30, v30, 4, v31
    s_add_u32 m0, s47, 0
    s_add_u32 s54, s53, 0
    buffer_load_dwordx4 v30, s[20:23], s54 offen nt lds
    s_add_u32 m0, s47, 1024
    s_add_u32 s54, s53, 13824
    buffer_load_dwordx4 v30, s[20:23], s54 offen nt lds
    s_add_u32 m0, s47, 2048
    s_add_u32 s54, s53, 27648
    buffer_load_dwordx4 v30, s[20:23], s54 offen nt lds
    s_add_u32 m0, s47, 3072
    s_add_u32 s54, s53, 41472
    buffer_load_dwordx4 v30, s[20:23], s54 offen nt lds
    s_add_u32 m0, s47, 4096
    s_add_u32 s54, s53, 55296
    buffer_load_dwordx4 v30, s[20:23], s54 offen nt lds
    s_add_u32 m0, s47, 5120
    s_add_u32 s54, s53, 69120
    buffer_load_dwordx4 v30, s[20:23], s54 offen nt lds
    s_add_u32 m0, s47, 6144
    s_add_u32 s54, s53, 82944
    buffer_load_dwordx4 v30, s[20:23], s54 offen nt lds
    s_add_u32 m0, s47, 7168
    s_add_u32 s54, s53, 96768
    buffer_load_dwordx4 v30, s[20:23], s54 offen nt lds
    s_branch rid_118
rib_117:
    s_cmp_lt_u32 s29, 80
    s_cselect_b32 s48, 0, 80
    s_cselect_b32 s51, 20, 54
    s_cselect_b32 s52, 1, 0
    s_sub_u32 s48, s29, s48
    s_lshr_b32 s49, s48, 2
    s_and_b32 s50, s48, 3
    s_cmp_eq_u32 s52, 1
    s_cselect_b32 s20, s30, s36
    s_cselect_b32 s21, s31, s37
    s_mov_b32 s22, 2211840
    s_cselect_b32 s22, 819200, s22
    s_and_b32 s21, s21, 0xffff
    s_and_b32 s53, s49, 15
    s_lshr_b32 s54, s49, 4
    s_cmp_ge_u32 s49, 39
    s_cselect_b32 s55, 1, 0
    s_add_u32 s53, s53, s55
    s_sub_u32 s55, s49, 46
    s_lshl_b32 s55, s55, 1
    s_cmp_ge_u32 s49, 46
    s_cselect_b32 s53, s55, s53
    s_cselect_b32 s54, 3, s54
    s_cselect_b32 s56, 112, 16
    s_and_b32 s55, s53, 7
    s_mul_i32 s57, s55, 112
    s_lshr_b32 s53, s53, 3
    s_mul_i32 s53, s53, 864
    s_add_u32 s53, s53, s57
    s_lshl_b32 s54, s54, 5
    s_add_u32 s53, s53, s54
    s_cmp_eq_u32 s55, 6
    s_cselect_b32 s57, 80, s56
    s_min_u32 s56, s56, s57
    s_lshl_b32 s57, s49, 5
    s_cmp_eq_u32 s52, 1
    s_cselect_b32 s53, s57, s53
    s_add_u32 s54, s53, s56
    s_mul_i32 s57, s50, 320
    s_mul_i32 s53, s53, 1280
    s_mul_i32 s54, s54, 1280
    s_add_u32 s53, s53, s57
    s_add_u32 s54, s54, s57
    s_mov_b32 s55, 214748365
    v_add_u32 v30, 0, v2
    v_mul_hi_u32 v31, s55, v30
    v_mul_u32_u24 v31, 960, v31
    v_lshl_add_u32 v31, v30, 4, v31
    s_add_u32 m0, s47, 0
    s_nop 0
    buffer_load_dwordx4 v31, s[20:23], s53 offen nt lds
    s_add_u32 m0, s47, 5120
    s_nop 0
    buffer_load_dwordx4 v31, s[20:23], s54 offen nt lds
    v_add_u32 v30, 64, v2
    v_mul_hi_u32 v31, s55, v30
    v_mul_u32_u24 v31, 960, v31
    v_lshl_add_u32 v31, v30, 4, v31
    s_add_u32 m0, s47, 1024
    s_nop 0
    buffer_load_dwordx4 v31, s[20:23], s53 offen nt lds
    s_add_u32 m0, s47, 6144
    s_nop 0
    buffer_load_dwordx4 v31, s[20:23], s54 offen nt lds
    v_add_u32 v30, 128, v2
    v_mul_hi_u32 v31, s55, v30
    v_mul_u32_u24 v31, 960, v31
    v_lshl_add_u32 v31, v30, 4, v31
    s_add_u32 m0, s47, 2048
    s_nop 0
    buffer_load_dwordx4 v31, s[20:23], s53 offen nt lds
    s_add_u32 m0, s47, 7168
    s_nop 0
    buffer_load_dwordx4 v31, s[20:23], s54 offen nt lds
    v_add_u32 v30, 192, v2
    v_mul_hi_u32 v31, s55, v30
    v_mul_u32_u24 v31, 960, v31
    v_lshl_add_u32 v31, v30, 4, v31
    s_add_u32 m0, s47, 3072
    s_nop 0
    buffer_load_dwordx4 v31, s[20:23], s53 offen nt lds
    s_add_u32 m0, s47, 8192
    s_nop 0
    buffer_load_dwordx4 v31, s[20:23], s54 offen nt lds
    v_add_u32 v30, 256, v2
    v_mul_hi_u32 v31, s55, v30
    v_mul_u32_u24 v31, 960, v31
    v_lshl_add_u32 v31, v30, 4, v31
    s_add_u32 m0, s47, 4096
    s_nop 0
    buffer_load_dwordx4 v31, s[20:23], s53 offen nt lds
    s_add_u32 m0, s47, 9216
    s_nop 0
    buffer_load_dwordx4 v31, s[20:23], s54 offen nt lds
rid_118:
    s_setpc_b64 s[0:1]
L_rfinish:
    v_bfe_u32 v176, v2, 2, 2
    v_lshrrev_b32 v177, 4, v2
    v_and_b32 v178, 3, v2
    v_lshl_add_u32 v183, v177, 3, v176
    v_lshlrev_b32 v182, 4, v2
    s_cmp_lt_u32 s29, 296
    s_cbranch_scc1 rfb_119
    s_sub_u32 s48, s29, 296
    s_and_b32 s49, s48, 15
    s_lshr_b32 s48, s48, 4
    s_mul_i32 s51, s48, 13
    s_lshr_b32 s51, s51, 7
    s_mul_i32 s50, s51, 10
    s_sub_u32 s50, s48, s50
    s_lshr_b32 s58, s51, 1
    s_and_b32 s51, s51, 1
    s_and_b32 s52, s49, 7
    v_lshlrev_b32 v179, 8, v183
    v_add_u32 v179, s47, v179
    s_cmp_eq_u32 s52, 7
    s_cselect_b32 s55, 0, 64
    s_add_u32 s55, s55, 128
    v_lshl_add_u32 v180, v178, 3, v179
    v_add_u32 v180, s55, v180
    v_lshl_add_u32 v179, v178, 4, v179
    ds_read_b64_tr_b16 v[128:129], v179 offset:0
    ds_read_b64_tr_b16 v[130:131], v179 offset:1024
    ds_read_b64_tr_b16 v[132:133], v179 offset:8
    ds_read_b64_tr_b16 v[134:135], v179 offset:1032
    ds_read_b64_tr_b16 v[136:137], v179 offset:64
    ds_read_b64_tr_b16 v[138:139], v179 offset:1088
    ds_read_b64_tr_b16 v[140:141], v179 offset:72
    ds_read_b64_tr_b16 v[142:143], v179 offset:1096
    ds_read_b64_tr_b16 v[144:145], v179 offset:128
    ds_read_b64_tr_b16 v[146:147], v179 offset:1152
    ds_read_b64_tr_b16 v[148:149], v179 offset:136
    ds_read_b64_tr_b16 v[150:151], v179 offset:1160
    ds_read_b64_tr_b16 v[152:153], v180 offset:0
    ds_read_b64_tr_b16 v[154:155], v180 offset:1024
    v_mov_b32 v181, 0x3f803f80
    v_cmp_eq_u32 vcc, 0, v176
    s_nop 1
    v_cndmask_b32 v64, 0, v181, vcc
    v_cmp_eq_u32 vcc, 1, v176
    s_nop 1
    v_cndmask_b32 v68, 0, v181, vcc
    v_cmp_eq_u32 vcc, 2, v176
    s_nop 1
    v_cndmask_b32 v72, 0, v181, vcc
    v_cmp_eq_u32 vcc, 3, v176
    s_nop 1
    v_cndmask_b32 v76, 0, v181, vcc
    v_mov_b32 v65, v64
    v_mov_b32 v66, v64
    v_mov_b32 v67, v64
    v_mov_b32 v69, v68
    v_mov_b32 v70, v68
    v_mov_b32 v71, v68
    v_mov_b32 v73, v72
    v_mov_b32 v74, v72
    v_mov_b32 v75, v72
    v_mov_b32 v77, v76
    v_mov_b32 v78, v76
    v_mov_b32 v79, v76
    s_mul_i32 s53, s49, 286720
    s_lshl_b32 s54, s51, 10
    s_add_u32 s53, s53, s54
    s_add_u32 s53, s53, 32505856
    s_mul_i32 s54, s58, 143360
    s_add_u32 s53, s53, s54
    s_lshl_b32 s54, s50, 11
    s_add_u32 s56, s53, s54
    s_add_u32 s56, s56, 40960
    s_lshl_b32 s54, s50, 12
    s_add_u32 s53, s53, s54
    s_lshl_b32 s54, s51, 4
    s_add_u32 s54, s54, s49
    s_lshl_b32 s54, s54, 1
    s_add_u32 s54, s54, s58
    s_mul_i32 s54, s54, 10
    s_add_u32 s54, s54, s50
    s_lshl_b32 s54, s54, 9
    s_add_u32 s54, s54, 262144
    v_lshrrev_b32 v181, 1, v177
    v_lshlrev_b32 v181, 5, v181
    v_lshl_add_u32 v181, v176, 3, v181
    v_and_b32 v177, 1, v177
    v_lshl_add_u32 v181, v177, 2, v181
    v_add_lshl_u32 v181, v181, v178, 2
    s_waitcnt lgkmcnt(12)
    s_add_u32 s57, s53, 0
    buffer_store_dwordx4 v[128:131], v182, s[12:15], s57 offen offset:0 sc1
    v_mfma_f32_16x16x32_bf16 v[168:171], v[64:67], v[128:131], 0
    s_waitcnt lgkmcnt(10)
    buffer_store_dwordx4 v[132:135], v182, s[12:15], s57 offen offset:2048 sc1
    v_mfma_f32_16x16x32_bf16 v[168:171], v[68:71], v[132:135], v[168:171]
    s_waitcnt lgkmcnt(8)
    s_add_u32 s57, s53, 61440
    buffer_store_dwordx4 v[136:139], v182, s[12:15], s57 offen offset:0 sc1
    v_mfma_f32_16x16x32_bf16 v[168:171], v[72:75], v[136:139], v[168:171]
    s_waitcnt lgkmcnt(6)
    buffer_store_dwordx4 v[140:143], v182, s[12:15], s57 offen offset:2048 sc1
    v_mfma_f32_16x16x32_bf16 v[168:171], v[76:79], v[140:143], v[168:171]
    s_waitcnt lgkmcnt(4)
    s_add_u32 s57, s53, 102400
    buffer_store_dwordx4 v[144:147], v182, s[12:15], s57 offen offset:0 sc1
    v_mfma_f32_16x16x32_bf16 v[172:175], v[64:67], v[144:147], 0
    s_waitcnt lgkmcnt(2)
    buffer_store_dwordx4 v[148:151], v182, s[12:15], s57 offen offset:2048 sc1
    v_mfma_f32_16x16x32_bf16 v[172:175], v[68:71], v[148:151], v[172:175]
    s_waitcnt lgkmcnt(0)
    buffer_store_dwordx4 v[152:155], v182, s[12:15], s56 offen sc1
    v_mfma_f32_16x16x32_bf16 v[172:175], v[72:75], v[152:155], v[172:175]
    s_lshl_b32 s55, s48, 2
    s_lshl_b32 s56, s49, 8
    s_add_u32 s55, s55, s56
    s_add_u32 s29, s55, 69632
    buffer_store_dword v168, v181, s[12:15], s54 offen sc1
    s_nop 2
    buffer_store_dword v172, v181, s[12:15], s54 offen offset:256 sc1
    s_branch rfd_120
rfb_119:
    s_cmp_lt_u32 s29, 80
    s_cselect_b32 s48, 0, 80
    s_cselect_b32 s51, 20, 54
    s_cselect_b32 s52, 1, 0
    s_sub_u32 s48, s29, s48
    s_lshr_b32 s49, s48, 2
    s_and_b32 s50, s48, 3
    v_mul_u32_u24 v179, 320, v183
    v_add_u32 v179, s47, v179
    v_lshl_add_u32 v180, v178, 3, v179
    v_lshl_add_u32 v179, v178, 4, v179
    ds_read_b64_tr_b16 v[128:129], v179 offset:0
    ds_read_b64_tr_b16 v[130:131], v179 offset:1280
    ds_read_b64_tr_b16 v[132:133], v179 offset:8
    ds_read_b64_tr_b16 v[134:135], v179 offset:1288
    ds_read_b64_tr_b16 v[136:137], v179 offset:64
    ds_read_b64_tr_b16 v[138:139], v179 offset:1344
    ds_read_b64_tr_b16 v[140:141], v179 offset:72
    ds_read_b64_tr_b16 v[142:143], v179 offset:1352
    ds_read_b64_tr_b16 v[144:145], v180 offset:128
    ds_read_b64_tr_b16 v[146:147], v180 offset:1408
    ds_read_b64_tr_b16 v[148:149], v179 offset:160
    ds_read_b64_tr_b16 v[150:151], v179 offset:1440
    ds_read_b64_tr_b16 v[152:153], v179 offset:168
    ds_read_b64_tr_b16 v[154:155], v179 offset:1448
    ds_read_b64_tr_b16 v[156:157], v179 offset:224
    ds_read_b64_tr_b16 v[158:159], v179 offset:1504
    ds_read_b64_tr_b16 v[160:161], v179 offset:232
    ds_read_b64_tr_b16 v[162:163], v179 offset:1512
    ds_read_b64_tr_b16 v[164:165], v180 offset:288
    ds_read_b64_tr_b16 v[166:167], v180 offset:1568
    s_lshl_b32 s53, s50, 1
    s_mul_i32 s53, s53, s51
    s_and_b32 s54, s49, 0xfe
    s_add_u32 s53, s53, s54
    s_mul_i32 s53, s53, 5120
    s_and_b32 s54, s49, 1
    s_lshl_b32 s54, s54, 10
    s_add_u32 s53, s53, s54
    s_mov_b32 s54, 29360128
    s_cmp_eq_u32 s52, 1
    s_cselect_b32 s54, 28311552, s54
    s_cselect_b32 s57, 7, 8
    s_mov_b32 s58, 41472
    s_cselect_b32 s58, 40960, s58
    s_add_u32 s53, s53, s54
    s_mul_i32 s55, s51, 5120
    s_sub_u32 s55, s55, 8192
    s_lshl_b32 s57, s50, s57
    s_add_u32 s57, s57, s58
    s_lshl_b32 s58, s49, 2
    s_add_u32 s29, s57, s58
    s_waitcnt lgkmcnt(10)
    buffer_store_dwordx4 v[128:131], v182, s[12:15], s53 offen offset:0 sc1
    buffer_store_dwordx4 v[132:135], v182, s[12:15], s53 offen offset:2048 sc1
    s_add_u32 s53, s53, 4096
    buffer_store_dwordx4 v[136:139], v182, s[12:15], s53 offen offset:0 sc1
    buffer_store_dwordx4 v[140:143], v182, s[12:15], s53 offen offset:2048 sc1
    s_add_u32 s53, s53, 4096
    buffer_store_dwordx4 v[144:147], v182, s[12:15], s53 offen offset:0 sc1
    s_add_u32 s53, s53, s55
    s_waitcnt lgkmcnt(0)
    buffer_store_dwordx4 v[148:151], v182, s[12:15], s53 offen offset:0 sc1
    buffer_store_dwordx4 v[152:155], v182, s[12:15], s53 offen offset:2048 sc1
    s_add_u32 s53, s53, 4096
    buffer_store_dwordx4 v[156:159], v182, s[12:15], s53 offen offset:0 sc1
    buffer_store_dwordx4 v[160:163], v182, s[12:15], s53 offen offset:2048 sc1
    s_add_u32 s53, s53, 4096
    buffer_store_dwordx4 v[164:167], v182, s[12:15], s53 offen offset:0 sc1
rfd_120:
    s_nop 1
    s_setpc_b64 s[0:1]
L_pref:
    s_cmp_lt_u32 s3, 4
    s_cbranch_scc1 L_pref_c
    s_cmp_le_u32 s29, 9999
    s_cbranch_scc1 L_pref_n
    v_mov_b32 v1, s26
    s_waitcnt vmcnt(10)
    s_mov_b64 exec, 1
    buffer_store_dword v1, off, s[12:15], s29 sc1
    s_mov_b64 exec, -1
    s_mov_b32 s29, 9999
L_pref_n:
    s_setpc_b64 s[0:1]
L_pref_c:
    s_lshl_b32 s46, s24, 2
    s_and_b32 s47, s25, 3
    s_add_u32 s46, s46, s47
    s_lshl_b32 s46, s46, 2
    s_add_u32 s46, s46, s3
    s_mul_i32 s46, s46, 20480
    s_lshr_b32 s47, s25, 2
    s_mul_i32 s47, s47, 160
    s_add_u32 s46, s46, s47
    v_and_b32 v16, 15, v2
    v_lshrrev_b32 v17, 4, v2
    v_mul_u32_u24 v16, 1280, v16
    v_lshl_add_u32 v1, v17, 3, v16
    v_lshl_add_u32 v16, v17, 4, v16
    buffer_load_dwordx4 v[48:51], v16, s[4:7], s46 offen
    buffer_load_dwordx4 v[52:55], v16, s[4:7], s46 offen offset:64
    buffer_load_dwordx2 v[56:57], v1, s[4:7], s46 offen offset:128
    s_setpc_b64 s[0:1]
L_pad0:
    s_setpc_b64 s[0:1]
L_walk_l:
    s_cmp_eq_u32 s40, 0
    s_cbranch_scc1 L_tr0
L_tb0:
    v_exp_f32 v128, v128
    v_exp_f32 v129, v129
    v_exp_f32 v130, v130
    v_exp_f32 v131, v131
    v_cvt_pk_bf16_f32 v176, v128, v129
    v_exp_f32 v132, v132
    v_cvt_pk_bf16_f32 v177, v130, v131
    v_exp_f32 v133, v133
    s_waitcnt lgkmcnt(0)
    v_mfma_f32_32x32x16_bf16 v[144:159], v[86:89], v[8:11], 0
    ds_read_b64_tr_b16 v[168:169], v26 offset:512
    ds_read_b64_tr_b16 v[170:171], v26 offset:640
    v_exp_f32 v134, v134
    v_exp_f32 v135, v135
    v_cvt_pk_bf16_f32 v178, v132, v133
    v_exp_f32 v136, v136
    v_cvt_pk_bf16_f32 v179, v134, v135
    v_mfma_f32_32x32x8_bf16 v[144:159], v[90:91], v[12:13], v[144:159]
    ds_read_b64_tr_b16 v[172:173], v26 offset:768
    ds_read_b64_tr_b16 v[174:175], v26 offset:896
    v_exp_f32 v137, v137
    v_exp_f32 v138, v138
    v_exp_f32 v139, v139
    v_mfma_f32_32x32x16_bf16 v[184:199], v[160:163], v[176:179], v[184:199]
    v_cvt_pk_bf16_f32 v180, v136, v137
    v_exp_f32 v140, v140
    v_cvt_pk_bf16_f32 v181, v138, v139
    v_exp_f32 v141, v141
    v_exp_f32 v142, v142
    v_exp_f32 v143, v143
    v_max3_f32 v28, v144, v145, v146
    v_cvt_pk_bf16_f32 v182, v140, v141
    v_max3_f32 v29, v147, v148, v149
    v_cvt_pk_bf16_f32 v183, v142, v143
    s_cmp_eq_u32 s40, 1
    s_cbranch_scc1 L_tr1
L_tb1:
    ds_read_b128 v[80:83], v14 offset:1024
    ds_read_b64 v[84:85], v15 offset:1024
    v_max3_f32 v28, v150, v151, v28
    v_max3_f32 v29, v152, v153, v29
    v_mfma_f32_32x32x16_bf16 v[184:199], v[164:167], v[180:183], v[184:199]
    v_max3_f32 v28, v154, v155, v28
    v_max3_f32 v29, v156, v157, v29
    v_max3_f32 v28, v158, v159, v28
    v_max_f32 v28, v28, v29
    v_cmp_lt_f32 vcc, 1090519040, v28
    s_cbranch_vccnz a_r_50
a_b_51:
    v_exp_f32 v144, v144
    v_exp_f32 v145, v145
    v_exp_f32 v146, v146
    v_exp_f32 v147, v147
    v_cvt_pk_bf16_f32 v176, v144, v145
    v_exp_f32 v148, v148
    v_cvt_pk_bf16_f32 v177, v146, v147
    v_exp_f32 v149, v149
    s_waitcnt lgkmcnt(0)
    v_mfma_f32_32x32x16_bf16 v[128:143], v[80:83], v[8:11], 0
    ds_read_b64_tr_b16 v[160:161], v26 offset:1024
    ds_read_b64_tr_b16 v[162:163], v26 offset:1152
    v_exp_f32 v150, v150
    v_exp_f32 v151, v151
    v_cvt_pk_bf16_f32 v178, v148, v149
    v_exp_f32 v152, v152
    v_cvt_pk_bf16_f32 v179, v150, v151
    v_mfma_f32_32x32x8_bf16 v[128:143], v[84:85], v[12:13], v[128:143]
    ds_read_b64_tr_b16 v[164:165], v26 offset:1280
    ds_read_b64_tr_b16 v[166:167], v26 offset:1408
    v_exp_f32 v153, v153
    v_exp_f32 v154, v154
    v_exp_f32 v155, v155
    v_mfma_f32_32x32x16_bf16 v[184:199], v[168:171], v[176:179], v[184:199]
    v_cvt_pk_bf16_f32 v180, v152, v153
    v_exp_f32 v156, v156
    v_cvt_pk_bf16_f32 v181, v154, v155
    v_exp_f32 v157, v157
    v_exp_f32 v158, v158
    v_exp_f32 v159, v159
    v_max3_f32 v28, v128, v129, v130
    v_cvt_pk_bf16_f32 v182, v156, v157
    v_max3_f32 v29, v131, v132, v133
    v_cvt_pk_bf16_f32 v183, v158, v159
    s_cmp_eq_u32 s40, 2
    s_cbranch_scc1 L_tr2
L_tb2:
    ds_read_b128 v[86:89], v14 offset:1536
    ds_read_b64 v[90:91], v15 offset:1536
    v_max3_f32 v28, v134, v135, v28
    v_max3_f32 v29, v136, v137, v29
    v_mfma_f32_32x32x16_bf16 v[184:199], v[172:175], v[180:183], v[184:199]
    v_max3_f32 v28, v138, v139, v28
    v_max3_f32 v29, v140, v141, v29
    v_max3_f32 v28, v142, v143, v28
    v_max_f32 v28, v28, v29
    v_cmp_lt_f32 vcc, 1090519040, v28
    s_cbranch_vccnz a_r_52
a_b_53:
    v_exp_f32 v128, v128
    v_exp_f32 v129, v129
    v_exp_f32 v130, v130
    v_exp_f32 v131, v131
    v_cvt_pk_bf16_f32 v176, v128, v129
    v_exp_f32 v132, v132
    v_cvt_pk_bf16_f32 v177, v130, v131
    v_exp_f32 v133, v133
    s_waitcnt lgkmcnt(0)
    v_mfma_f32_32x32x16_bf16 v[144:159], v[86:89], v[8:11], 0
    s_mov_b32 m0, s10
    s_add_u32 s10, s10, 3072
    buffer_load_dwordx4 v3, s[12:15], s9 offen offset:0 sc1 lds
    buffer_load_dwordx4 v3, s[12:15], s9 offen offset:1024 sc1 lds
    buffer_load_dwordx4 v3, s[12:15], s9 offen offset:2048 sc1 lds
    s_add_u32 s9, s9, 3072
    ds_read_b64_tr_b16 v[168:169], v26 offset:1536
    ds_read_b64_tr_b16 v[170:171], v26 offset:1664
    v_exp_f32 v134, v134
    v_exp_f32 v135, v135
    v_cvt_pk_bf16_f32 v178, v132, v133
    v_exp_f32 v136, v136
    v_cvt_pk_bf16_f32 v179, v134, v135
    v_mfma_f32_32x32x8_bf16 v[144:159], v[90:91], v[12:13], v[144:159]
    ds_read_b64_tr_b16 v[172:173], v26 offset:1792
    ds_read_b64_tr_b16 v[174:175], v26 offset:1920
    v_exp_f32 v137, v137
    v_exp_f32 v138, v138
    v_exp_f32 v139, v139
    v_mfma_f32_32x32x16_bf16 v[184:199], v[160:163], v[176:179], v[184:199]
    v_cvt_pk_bf16_f32 v180, v136, v137
    v_exp_f32 v140, v140
    v_cvt_pk_bf16_f32 v181, v138, v139
    v_exp_f32 v141, v141
    v_exp_f32 v142, v142
    v_exp_f32 v143, v143
    v_max3_f32 v28, v144, v145, v146
    v_cvt_pk_bf16_f32 v182, v140, v141
    v_max3_f32 v29, v147, v148, v149
    v_cvt_pk_bf16_f32 v183, v142, v143
    s_cmp_eq_u32 s40, 3
    s_cbranch_scc1 L_tr3
L_tb3:
    ds_read_b128 v[80:83], v14 offset:2048
    ds_read_b64 v[84:85], v15 offset:2048
    v_max3_f32 v28, v150, v151, v28
    v_max3_f32 v29, v152, v153, v29
    v_mfma_f32_32x32x16_bf16 v[184:199], v[164:167], v[180:183], v[184:199]
    v_max3_f32 v28, v154, v155, v28
    v_max3_f32 v29, v156, v157, v29
    v_max3_f32 v28, v158, v159, v28
    v_max_f32 v28, v28, v29
    v_cmp_lt_f32 vcc, 1090519040, v28
    s_cbranch_vccnz a_r_54
a_b_55:
    v_exp_f32 v144, v144
    v_exp_f32 v145, v145
    v_exp_f32 v146, v146
    v_exp_f32 v147, v147
    v_cvt_pk_bf16_f32 v176, v144, v145
    v_exp_f32 v148, v148
    v_cvt_pk_bf16_f32 v177, v146, v147
    v_exp_f32 v149, v149
    s_waitcnt lgkmcnt(0)
    v_mfma_f32_32x32x16_bf16 v[128:143], v[80:83], v[8:11], 0
    s_mov_b32 m0, s10
    s_add_u32 s10, s10, 3072
    buffer_load_dwordx4 v3, s[12:15], s9 offen offset:0 sc1 lds
    buffer_load_dwordx4 v3, s[12:15], s9 offen offset:1024 sc1 lds
    buffer_load_dwordx4 v3, s[12:15], s9 offen offset:2048 sc1 lds
    s_add_u32 s9, s9, 3072
    ds_read_b64_tr_b16 v[160:161], v26 offset:2048
    ds_read_b64_tr_b16 v[162:163], v26 offset:2176
    v_exp_f32 v150, v150
    v_exp_f32 v151, v151
    v_cvt_pk_bf16_f32 v178, v148, v149
    v_exp_f32 v152, v152
    v_cvt_pk_bf16_f32 v179, v150, v151
    v_mfma_f32_32x32x8_bf16 v[128:143], v[84:85], v[12:13], v[128:143]
    ds_read_b64_tr_b16 v[164:165], v26 offset:2304
    ds_read_b64_tr_b16 v[166:167], v26 offset:2432
    v_exp_f32 v153, v153
    v_exp_f32 v154, v154
    v_exp_f32 v155, v155
    v_mfma_f32_32x32x16_bf16 v[184:199], v[168:171], v[176:179], v[184:199]
    v_cvt_pk_bf16_f32 v180, v152, v153
    v_exp_f32 v156, v156
    v_cvt_pk_bf16_f32 v181, v154, v155
    v_exp_f32 v157, v157
    v_exp_f32 v158, v158
    v_exp_f32 v159, v159
    v_max3_f32 v28, v128, v129, v130
    v_cvt_pk_bf16_f32 v182, v156, v157
    v_max3_f32 v29, v131, v132, v133
    v_cvt_pk_bf16_f32 v183, v158, v159
    s_cmp_eq_u32 s40, 4
    s_cbranch_scc1 L_tr4
L_tb4:
    ds_read_b128 v[86:89], v14 offset:2560
    ds_read_b64 v[90:91], v15 offset:2560
    v_max3_f32 v28, v134, v135, v28
    v_max3_f32 v29, v136, v137, v29
    v_mfma_f32_32x32x16_bf16 v[184:199], v[172:175], v[180:183], v[184:199]
    v_max3_f32 v28, v138, v139, v28
    v_max3_f32 v29, v140, v141, v29
    v_max3_f32 v28, v142, v143, v28
    v_max_f32 v28, v28, v29
    v_cmp_lt_f32 vcc, 1090519040, v28
    s_cbranch_vccnz a_r_56
a_b_57:
    v_exp_f32 v128, v128
    v_exp_f32 v129, v129
    v_exp_f32 v130, v130
    v_exp_f32 v131, v131
    v_cvt_pk_bf16_f32 v176, v128, v129
    v_exp_f32 v132, v132
    v_cvt_pk_bf16_f32 v177, v130, v131
    v_exp_f32 v133, v133
    s_waitcnt lgkmcnt(0)
    v_mfma_f32_32x32x16_bf16 v[144:159], v[86:89], v[8:11], 0
    s_mov_b32 m0, s10
    s_add_u32 s10, s10, 3072
    buffer_load_dwordx4 v3, s[12:15], s9 offen offset:0 sc1 lds
    buffer_load_dwordx4 v3, s[12:15], s9 offen offset:1024 sc1 lds
    buffer_load_dwordx4 v3, s[12:15], s9 offen offset:2048 sc1 lds
    s_add_u32 s9, s9, 3072
    ds_read_b64_tr_b16 v[168:169], v26 offset:2560
    ds_read_b64_tr_b16 v[170:171], v26 offset:2688
    v_exp_f32 v134, v134
    v_exp_f32 v135, v135
    v_cvt_pk_bf16_f32 v178, v132, v133
    v_exp_f32 v136, v136
    v_cvt_pk_bf16_f32 v179, v134, v135
    v_mfma_f32_32x32x8_bf16 v[144:159], v[90:91], v[12:13], v[144:159]
    ds_read_b64_tr_b16 v[172:173], v26 offset:2816
    ds_read_b64_tr_b16 v[174:175], v26 offset:2944
    v_exp_f32 v137, v137
    v_exp_f32 v138, v138
    v_exp_f32 v139, v139
    v_mfma_f32_32x32x16_bf16 v[184:199], v[160:163], v[176:179], v[184:199]
    v_cvt_pk_bf16_f32 v180, v136, v137
    v_exp_f32 v140, v140
    v_cvt_pk_bf16_f32 v181, v138, v139
    v_exp_f32 v141, v141
    v_exp_f32 v142, v142
    v_exp_f32 v143, v143
    v_max3_f32 v28, v144, v145, v146
    v_cvt_pk_bf16_f32 v182, v140, v141
    v_max3_f32 v29, v147, v148, v149
    v_cvt_pk_bf16_f32 v183, v142, v143
    s_cmp_eq_u32 s40, 5
    s_cbranch_scc1 L_tr5
L_tb5:
    ds_read_b128 v[80:83], v14 offset:3072
    ds_read_b64 v[84:85], v15 offset:3072
    v_max3_f32 v28, v150, v151, v28
    v_max3_f32 v29, v152, v153, v29
    v_mfma_f32_32x32x16_bf16 v[184:199], v[164:167], v[180:183], v[184:199]
    v_max3_f32 v28, v154, v155, v28
    v_max3_f32 v29, v156, v157, v29
    v_max3_f32 v28, v158, v159, v28
    v_max_f32 v28, v28, v29
    v_cmp_lt_f32 vcc, 1090519040, v28
    s_cbranch_vccnz a_r_58
a_b_59:
    v_exp_f32 v144, v144
    v_exp_f32 v145, v145
    v_exp_f32 v146, v146
    v_exp_f32 v147, v147
    v_cvt_pk_bf16_f32 v176, v144, v145
    v_exp_f32 v148, v148
    v_cvt_pk_bf16_f32 v177, v146, v147
    v_exp_f32 v149, v149
    s_waitcnt lgkmcnt(0)
    v_mfma_f32_32x32x16_bf16 v[128:143], v[80:83], v[8:11], 0
    s_mov_b32 m0, s10
    s_add_u32 s10, s10, 3072
    buffer_load_dwordx4 v3, s[12:15], s9 offen offset:0 sc1 lds
    buffer_load_dwordx4 v3, s[12:15], s9 offen offset:1024 sc1 lds
    buffer_load_dwordx4 v3, s[12:15], s9 offen offset:2048 sc1 lds
    s_add_u32 s9, s9, 3072
    ds_read_b64_tr_b16 v[160:161], v26 offset:3072
    ds_read_b64_tr_b16 v[162:163], v26 offset:3200
    v_exp_f32 v150, v150
    v_exp_f32 v151, v151
    v_cvt_pk_bf16_f32 v178, v148, v149
    v_exp_f32 v152, v152
    v_cvt_pk_bf16_f32 v179, v150, v151
    v_mfma_f32_32x32x8_bf16 v[128:143], v[84:85], v[12:13], v[128:143]
    ds_read_b64_tr_b16 v[164:165], v26 offset:3328
    ds_read_b64_tr_b16 v[166:167], v26 offset:3456
    v_exp_f32 v153, v153
    v_exp_f32 v154, v154
    v_exp_f32 v155, v155
    v_mfma_f32_32x32x16_bf16 v[184:199], v[168:171], v[176:179], v[184:199]
    v_cvt_pk_bf16_f32 v180, v152, v153
    v_exp_f32 v156, v156
    v_cvt_pk_bf16_f32 v181, v154, v155
    v_exp_f32 v157, v157
    v_exp_f32 v158, v158
    v_exp_f32 v159, v159
    v_max3_f32 v28, v128, v129, v130
    v_cvt_pk_bf16_f32 v182, v156, v157
    v_max3_f32 v29, v131, v132, v133
    v_cvt_pk_bf16_f32 v183, v158, v159
    s_cmp_eq_u32 s40, 6
    s_cbranch_scc1 L_tr6
L_tb6:
    ds_read_b128 v[86:89], v14 offset:3584
    ds_read_b64 v[90:91], v15 offset:3584
    v_max3_f32 v28, v134, v135, v28
    v_max3_f32 v29, v136, v137, v29
    v_mfma_f32_32x32x16_bf16 v[184:199], v[172:175], v[180:183], v[184:199]
    v_max3_f32 v28, v138, v139, v28
    v_max3_f32 v29, v140, v141, v29
    v_max3_f32 v28, v142, v143, v28
    v_max_f32 v28, v28, v29
    v_cmp_lt_f32 vcc, 1090519040, v28
    s_cbranch_vccnz a_r_60
a_b_61:
    v_exp_f32 v128, v128
    v_exp_f32 v129, v129
    v_exp_f32 v130, v130
    v_exp_f32 v131, v131
    v_cvt_pk_bf16_f32 v176, v128, v129
    v_exp_f32 v132, v132
    v_cvt_pk_bf16_f32 v177, v130, v131
    v_exp_f32 v133, v133
    s_waitcnt lgkmcnt(0)
    v_mfma_f32_32x32x16_bf16 v[144:159], v[86:89], v[8:11], 0
    s_mov_b32 m0, s10
    s_add_u32 s10, s10, 3072
    buffer_load_dwordx4 v3, s[12:15], s9 offen offset:0 sc1 lds
    buffer_load_dwordx4 v3, s[12:15], s9 offen offset:1024 sc1 lds
    buffer_load_dwordx4 v3, s[12:15], s9 offen offset:2048 sc1 lds
    s_add_u32 s9, s9, 3072
    ds_read_b64_tr_b16 v[168:169], v26 offset:3584
    ds_read_b64_tr_b16 v[170:171], v26 offset:3712
    v_exp_f32 v134, v134
    v_exp_f32 v135, v135
    v_cvt_pk_bf16_f32 v178, v132, v133
    v_exp_f32 v136, v136
    v_cvt_pk_bf16_f32 v179, v134, v135
    v_mfma_f32_32x32x8_bf16 v[144:159], v[90:91], v[12:13], v[144:159]
    ds_read_b64_tr_b16 v[172:173], v26 offset:3840
    ds_read_b64_tr_b16 v[174:175], v26 offset:3968
    v_exp_f32 v137, v137
    v_exp_f32 v138, v138
    v_exp_f32 v139, v139
    v_mfma_f32_32x32x16_bf16 v[184:199], v[160:163], v[176:179], v[184:199]
    v_cvt_pk_bf16_f32 v180, v136, v137
    v_exp_f32 v140, v140
    v_cvt_pk_bf16_f32 v181, v138, v139
    v_exp_f32 v141, v141
    v_exp_f32 v142, v142
    v_exp_f32 v143, v143
    v_max3_f32 v28, v144, v145, v146
    v_cvt_pk_bf16_f32 v182, v140, v141
    v_max3_f32 v29, v147, v148, v149
    v_cvt_pk_bf16_f32 v183, v142, v143
    s_cmp_eq_u32 s40, 7
    s_cbranch_scc1 L_tr7
L_tb7:
    ds_read_b128 v[80:83], v14 offset:4096
    ds_read_b64 v[84:85], v15 offset:4096
    v_max3_f32 v28, v150, v151, v28
    v_max3_f32 v29, v152, v153, v29
    v_mfma_f32_32x32x16_bf16 v[184:199], v[164:167], v[180:183], v[184:199]
    v_max3_f32 v28, v154, v155, v28
    v_max3_f32 v29, v156, v157, v29
    v_max3_f32 v28, v158, v159, v28
    v_max_f32 v28, v28, v29
    v_cmp_lt_f32 vcc, 1090519040, v28
    s_cbranch_vccnz a_r_62
a_b_63:
    v_exp_f32 v144, v144
    v_exp_f32 v145, v145
    v_exp_f32 v146, v146
    v_exp_f32 v147, v147
    v_cvt_pk_bf16_f32 v176, v144, v145
    v_exp_f32 v148, v148
    v_cvt_pk_bf16_f32 v177, v146, v147
    v_exp_f32 v149, v149
    s_waitcnt lgkmcnt(0)
    v_mfma_f32_32x32x16_bf16 v[128:143], v[80:83], v[8:11], v[64:79]
    s_mov_b32 m0, s10
    s_add_u32 s10, s10, 3072
    buffer_load_dwordx4 v3, s[12:15], s9 offen offset:0 sc1 lds
    buffer_load_dwordx4 v3, s[12:15], s9 offen offset:1024 sc1 lds
    buffer_load_dwordx4 v3, s[12:15], s9 offen offset:2048 sc1 lds
    s_add_u32 s9, s9, 3072
    ds_read_b64_tr_b16 v[160:161], v26 offset:4096
    ds_read_b64_tr_b16 v[162:163], v26 offset:4224
    v_exp_f32 v150, v150
    v_exp_f32 v151, v151
    v_cvt_pk_bf16_f32 v178, v148, v149
    v_exp_f32 v152, v152
    v_cvt_pk_bf16_f32 v179, v150, v151
    v_mfma_f32_32x32x8_bf16 v[128:143], v[84:85], v[12:13], v[128:143]
    ds_read_b64_tr_b16 v[164:165], v26 offset:4352
    ds_read_b64_tr_b16 v[166:167], v26 offset:4480
    v_exp_f32 v153, v153
    v_exp_f32 v154, v154
    v_exp_f32 v155, v155
    v_mfma_f32_32x32x16_bf16 v[184:199], v[168:171], v[176:179], v[184:199]
    v_cvt_pk_bf16_f32 v180, v152, v153
    v_exp_f32 v156, v156
    v_cvt_pk_bf16_f32 v181, v154, v155
    v_exp_f32 v157, v157
    v_exp_f32 v158, v158
    v_exp_f32 v159, v159
    v_max3_f32 v28, v128, v129, v130
    v_cvt_pk_bf16_f32 v182, v156, v157
    v_max3_f32 v29, v131, v132, v133
    v_cvt_pk_bf16_f32 v183, v158, v159
    v_max3_f32 v28, v134, v135, v28
    v_max3_f32 v29, v136, v137, v29
    v_mfma_f32_32x32x16_bf16 v[184:199], v[172:175], v[180:183], v[184:199]
    v_max3_f32 v28, v138, v139, v28
    v_max3_f32 v29, v140, v141, v29
    v_max3_f32 v28, v142, v143, v28
    v_max_f32 v28, v28, v29
    v_cmp_lt_f32 vcc, 1090519040, v28
    s_cbranch_vccnz a_r_64
a_b_65:
    s_branch L_last0
L_fin1:
    v_max3_f32 v28, v134, v135, v28
    v_max3_f32 v29, v136, v137, v29
    v_mfma_f32_32x32x16_bf16 v[184:199], v[172:175], v[180:183], v[184:199]
    v_max3_f32 v28, v138, v139, v28
    v_max3_f32 v29, v140, v141, v29
    v_max3_f32 v28, v142, v143, v28
    v_max_f32 v28, v28, v29
    v_cmp_lt_f32 vcc, 1090519040, v28
    s_cbranch_vccnz a_r_66
a_b_67:
    s_branch L_last0
L_fin0:
    v_max3_f32 v28, v150, v151, v28
    v_max3_f32 v29, v152, v153, v29
    v_mfma_f32_32x32x16_bf16 v[184:199], v[164:167], v[180:183], v[184:199]
    v_max3_f32 v28, v154, v155, v28
    v_max3_f32 v29, v156, v157, v29
    v_max3_f32 v28, v158, v159, v28
    v_max_f32 v28, v28, v29
    v_cmp_lt_f32 vcc, 1090519040, v28
    s_cbranch_vccnz a_r_68
a_b_69:
    v_exp_f32 v144, v144
    v_exp_f32 v145, v145
    v_exp_f32 v146, v146
    v_exp_f32 v147, v147
    v_cvt_pk_bf16_f32 v176, v144, v145
    v_exp_f32 v148, v148
    v_cvt_pk_bf16_f32 v177, v146, v147
    v_exp_f32 v149, v149
    v_exp_f32 v150, v150
    v_exp_f32 v151, v151
    v_cvt_pk_bf16_f32 v178, v148, v149
    v_exp_f32 v152, v152
    v_cvt_pk_bf16_f32 v179, v150, v151
    v_exp_f32 v153, v153
    s_waitcnt lgkmcnt(0)
    v_mfma_f32_32x32x16_bf16 v[184:199], v[168:171], v[176:179], v[184:199]
    v_exp_f32 v154, v154
    v_exp_f32 v155, v155
    v_cvt_pk_bf16_f32 v180, v152, v153
    v_exp_f32 v156, v156
    v_cvt_pk_bf16_f32 v181, v154, v155
    v_exp_f32 v157, v157
    v_exp_f32 v158, v158
    v_exp_f32 v159, v159
    v_cvt_pk_bf16_f32 v182, v156, v157
    v_cvt_pk_bf16_f32 v183, v158, v159
    s_nop 1
    v_mfma_f32_32x32x16_bf16 v[184:199], v[172:175], v[180:183], v[184:199]
    s_branch a_done_49
L_rare0:
    s_nop 7
    s_nop 7
    v_mov_b32 v29, v28
    s_nop 1
    v_permlane32_swap_b32 v28, v29
    v_max3_f32 v28, v28, v29, 0
    v_sub_f32 v28, v27, v28
    v_cvt_pk_bf16_f32 v16, v28, v28
    v_and_b32 v17, 0xffff0000, v16
    v_sub_f32 v28, v28, v17
    v_cvt_pk_bf16_f32 v16, v17, v28
    v_and_b32 v28, 0xffff0000, v16
    v_add_f32 v17, v17, v28
    v_sub_f32 v18, v17, v27
    v_sub_f32 v19, v17, v27
    v_cndmask_b32_e64 v12, v12, v16, s[42:43]
    v_mov_b32 v27, v17
    v_pk_add_f32 v[128:129], v[128:129], v[18:19]
    v_pk_add_f32 v[130:131], v[130:131], v[18:19]
    v_pk_add_f32 v[132:133], v[132:133], v[18:19]
    v_pk_add_f32 v[134:135], v[134:135], v[18:19]
    v_pk_add_f32 v[136:137], v[136:137], v[18:19]
    v_pk_add_f32 v[138:139], v[138:139], v[18:19]
    v_pk_add_f32 v[140:141], v[140:141], v[18:19]
    v_pk_add_f32 v[142:143], v[142:143], v[18:19]
    v_exp_f32 v16, v18
    v_exp_f32 v17, v18
    s_nop 0
    v_pk_mul_f32 v[184:185], v[184:185], v[16:17]
    v_pk_mul_f32 v[186:187], v[186:187], v[16:17]
    v_pk_mul_f32 v[188:189], v[188:189], v[16:17]
    v_pk_mul_f32 v[190:191], v[190:191], v[16:17]
    v_pk_mul_f32 v[192:193], v[192:193], v[16:17]
    v_pk_mul_f32 v[194:195], v[194:195], v[16:17]
    v_pk_mul_f32 v[196:197], v[196:197], v[16:17]
    s_nop 1
    s_setpc_b64 s[0:1]
L_rare1:
    s_nop 7
    s_nop 7
    v_mov_b32 v29, v28
    s_nop 1
    v_permlane32_swap_b32 v28, v29
    v_max3_f32 v28, v28, v29, 0
    v_sub_f32 v28, v27, v28
    v_cvt_pk_bf16_f32 v16, v28, v28
    v_and_b32 v17, 0xffff0000, v16
    v_sub_f32 v28, v28, v17
    v_cvt_pk_bf16_f32 v16, v17, v28
    v_and_b32 v28, 0xffff0000, v16
    v_add_f32 v17, v17, v28
    v_sub_f32 v18, v17, v27
    v_sub_f32 v19, v17, v27
    v_cndmask_b32_e64 v12, v12, v16, s[42:43]
    v_mov_b32 v27, v17
    v_pk_add_f32 v[144:145], v[144:145], v[18:19]
    v_pk_add_f32 v[146:147], v[146:147], v[18:19]
    v_pk_add_f32 v[148:149], v[148:149], v[18:19]
    v_pk_add_f32 v[150:151], v[150:151], v[18:19]
    v_pk_add_f32 v[152:153], v[152:153], v[18:19]
    v_pk_add_f32 v[154:155], v[154:155], v[18:19]
    v_pk_add_f32 v[156:157], v[156:157], v[18:19]
    v_pk_add_f32 v[158:159], v[158:159], v[18:19]
    v_exp_f32 v16, v18
    v_exp_f32 v17, v18
    s_nop 0
    v_pk_mul_f32 v[184:185], v[184:185], v[16:17]
    v_pk_mul_f32 v[186:187], v[186:187], v[16:17]
    v_pk_mul_f32 v[188:189], v[188:189], v[16:17]
    v_pk_mul_f32 v[190:191], v[190:191], v[16:17]
    v_pk_mul_f32 v[192:193], v[192:193], v[16:17]
    v_pk_mul_f32 v[194:195], v[194:195], v[16:17]
    v_pk_mul_f32 v[196:197], v[196:197], v[16:17]
    s_nop 1
    s_setpc_b64 s[0:1]
a_r_33:
    s_call_b64 s[0:1], L_rare1
    s_branch a_b_34
a_r_35:
    s_call_b64 s[0:1], L_rare0
    s_branch a_b_36
a_r_37:
    s_call_b64 s[0:1], L_rare1
    s_branch a_b_38
L_trc:
    s_call_b64 s[38:39], L_trans
    s_branch L_tbc
a_r_39:
    s_call_b64 s[0:1], L_rare0
    s_branch a_b_40
a_r_41:
    s_call_b64 s[0:1], L_rare1
    s_branch a_b_42
a_r_43:
    s_call_b64 s[0:1], L_rare0
    s_branch a_b_44
a_r_45:
    s_call_b64 s[0:1], L_rare1
    s_branch a_b_46
a_r_47:
    s_call_b64 s[0:1], L_rare0
    s_branch a_b_48
a_r_50:
    s_call_b64 s[0:1], L_rare1
    s_branch a_b_51
a_r_52:
    s_call_b64 s[0:1], L_rare0
    s_branch a_b_53
a_r_54:
    s_call_b64 s[0:1], L_rare1
    s_branch a_b_55
L_tr4:
    s_call_b64 s[38:39], L_trans
    s_cbranch_scc0 L_tb4
    s_branch L_fin1
a_r_56:
    s_call_b64 s[0:1], L_rare0
    s_branch a_b_57
L_tr5:
    s_call_b64 s[38:39], L_trans
    s_cbranch_scc0 L_tb5
    s_branch L_fin0
a_r_58:
    s_call_b64 s[0:1], L_rare1
    s_branch a_b_59
L_tr6:
    s_call_b64 s[38:39], L_trans
    s_cbranch_scc0 L_tb6
    s_branch L_fin1
a_r_60:
    s_call_b64 s[0:1], L_rare0
    s_branch a_b_61
L_tr7:
    s_call_b64 s[38:39], L_trans
    s_cbranch_scc0 L_tb7
    s_branch L_fin0
a_r_62:
    s_call_b64 s[0:1], L_rare1
    s_branch a_b_63
a_r_64:
    s_call_b64 s[0:1], L_rare0
    s_branch a_b_65
a_r_66:
    s_call_b64 s[0:1], L_rare0
    s_branch a_b_67
a_r_68:
    s_call_b64 s[0:1], L_rare1
    s_branch a_b_69
L_pad1:
    s_setpc_b64 s[0:1]
L_tr0:
    s_call_b64 s[38:39], L_trans
    s_cbranch_scc1 L_last0
    ds_read_b128 v[86:89], v14 offset:512
    ds_read_b64 v[90:91], v15 offset:512
    s_branch L_tb0
L_tr1:
    s_call_b64 s[38:39], L_trans
    s_cbranch_scc0 L_tb1
    s_branch L_fin0
L_tr2:
    s_call_b64 s[38:39], L_trans
    s_cbranch_scc0 L_tb2
    s_branch L_fin1
L_tr3:
    s_call_b64 s[38:39], L_trans
    s_cbranch_scc0 L_tb3
    s_branch L_fin0
L_pad2:
    s_setpc_b64 s[0:1]
L_trans:
    v_mov_b32 v16, 160768
    s_cmp_lt_u32 s3, 4
    s_cbranch_scc1 L_a_nlb
    s_mov_b32 s63, 480000
L_a_hil:
    ds_read_b32 v30, v16 offset:8
    s_waitcnt lgkmcnt(0)
    v_readfirstlane_b32 s60, v30
    s_nop 0
    s_cmp_lg_u32 s60, 0
    s_cbranch_scc1 L_a_hi
    s_sleep 1
    s_sub_u32 s63, s63, 1
    s_cbranch_scc0 L_a_hil
L_a_hi:
    s_cmp_eq_u32 s3, 4
    s_cbranch_scc1 L_a_npf
    s_add_u32 s55, s54, 0
    buffer_load_dwordx4 v[200:203], v3, s[12:15], s55 offen sc1
    buffer_load_dwordx4 v[204:207], v0, s[12:15], s55 offen sc1
    s_add_u32 s55, s54, 8192
    buffer_load_dwordx4 v[208:211], v3, s[12:15], s55 offen sc1
    buffer_load_dwordx4 v[212:215], v0, s[12:15], s55 offen sc1
L_a_npf:
    s_cmp_lg_u32 s3, 7
    s_cbranch_scc1 L_a_n7
    s_sub_u32 s48, s3, 5
    s_mul_i32 s48, s48, 10240
    s_lshr_b32 s49, s25, 2
    s_mul_i32 s49, s49, 102400
    s_add_u32 s49, s49, s48
    s_add_u32 s49, s49, 28385280
    s_add_u32 s48, s48, 131072
    s_add_u32 m0, s48, 0
    s_add_u32 s50, s49, 0
    buffer_load_dwordx4 v3, s[12:15], s50 offen offset:0 sc1 lds
    buffer_load_dwordx4 v3, s[12:15], s50 offen offset:1024 sc1 lds
    buffer_load_dwordx4 v3, s[12:15], s50 offen offset:2048 sc1 lds
    buffer_load_dwordx4 v3, s[12:15], s50 offen offset:3072 sc1 lds
    s_add_u32 m0, s48, 4096
    s_add_u32 s50, s49, 4096
    buffer_load_dwordx4 v3, s[12:15], s50 offen offset:0 sc1 lds
    buffer_load_dwordx4 v3, s[12:15], s50 offen offset:1024 sc1 lds
    buffer_load_dwordx4 v3, s[12:15], s50 offen offset:2048 sc1 lds
    buffer_load_dwordx4 v3, s[12:15], s50 offen offset:3072 sc1 lds
L_a_n7:
    s_sub_u32 s48, s3, 5
    s_cmp_gt_u32 s48, 1
    s_cbranch_scc1 L_a_nri
    s_lshl_b32 s49, s48, 8
    s_add_u32 s49, s49, s2
    s_cmp_ge_u32 s49, 512
    s_cbranch_scc1 L_a_nri
    s_cmp_lt_u32 s49, 216
    s_cselect_b32 s50, 0, 320
    s_add_u32 s49, s49, 80
    s_add_u32 s29, s49, s50
    s_mul_i32 s47, s48, 10240
    s_add_u32 s47, s47, 131072
    s_mov_b32 s46, s54
    s_call_b64 s[0:1], L_rissue
    s_mov_b32 s54, s46
L_a_nri:
L_a_nlb:
    s_cmp_eq_u32 s24, 0
    s_cbranch_scc1 L_a_tx
    s_mov_b32 s63, 480000
    s_cmp_eq_u32 s11, 0
    s_cbranch_scc1 L_a_hw
    v_mov_b32 v17, 1
    s_lshl_b32 s60, s24, 7
    s_lshl_b32 s63, s25, 2
    s_add_u32 s60, s60, s63
    s_add_u32 s60, s60, 45056
    v_mov_b32 v18, s26
    s_waitcnt vmcnt(4)
    ds_write_b32 v16, v17 offset:4
    s_mov_b64 exec, 1
    buffer_store_dword v18, off, s[12:15], s60 sc1
    s_mov_b64 exec, -1
    s_branch L_a_ty
L_pad3:
    s_setpc_b64 s[0:1]
L_a_hw:
    ds_read_b32 v17, v16 offset:4
    s_waitcnt lgkmcnt(0)
    v_readfirstlane_b32 s60, v17
    s_nop 0
    s_cmp_lg_u32 s60, 0
    s_cbranch_scc1 L_a_ty
    s_sleep 1
    s_sub_u32 s63, s63, 1
    s_cbranch_scc0 L_a_hw
L_a_ty:
    s_cmp_eq_u32 s24, 0
L_a_tx:
    s_setpc_b64 s[38:39]
L_end:
    s_endpgm
.section .rodata,"a"
.p2align 6
.amdhsa_kernel sequential_preLN__sliding_block__glu_gated_reglu__prompt_kernel
  .amdhsa_next_free_vgpr 256
  .amdhsa_next_free_sgpr 102
  .amdhsa_accum_offset 256
  .amdhsa_group_segment_fixed_size 0
  .amdhsa_kernarg_size 80
  .amdhsa_user_sgpr_count 2
  .amdhsa_user_sgpr_kernarg_segment_ptr 1
  .amdhsa_system_sgpr_workgroup_id_x 1
.end_amdhsa_kernel
```
